```python
import torch

def _softmax(x, axis=-1):
    return torch.softmax(x, dim=axis)

def _gelu(x):
    return torch.nn.functional.gelu(x, approximate='tanh')

def _silu(x):
    return torch.nn.functional.silu(x)

def _sigmoid(x):
    return torch.sigmoid(x)

def _layernorm(x, axis=-1, eps=1e-05):
    m = x.mean(dim=axis, keepdim=True)
    v = x.var(dim=axis, keepdim=True, unbiased=False)
    return (x - m) / torch.sqrt(v + eps)

def _scatter_add(tgt, idx, src, axis=0):
    return tgt.clone().index_add_(axis, idx, src)

def _segment_sum(src, seg, n):
    out = torch.zeros((n,) + src.shape[1:], dtype=src.dtype)
    return out.index_add_(0, seg, src)

def _pad(x, pw):
    flat = tuple((v for pair in reversed(pw) for v in pair))
    return torch.nn.functional.pad(x, flat)
kernel_name = 'sequential_preLN__grouped_kv_mqa__mixer_gmlp__prompt'

def setup_inputs():

    _w = lambda a: (lambda t: t.to(torch.bfloat16) if t.is_floating_point() else t)(torch.as_tensor(a))

    def _A_setup():
        B, S, D, H = (1, 2048, 1024, 32)
        Dh = D // H
        return {'x': _w((lambda *s: torch.randn(*s, dtype=torch.bfloat16) * 0.05)(B, S, D)), 'wq': _w((lambda *s: torch.randn(*s, dtype=torch.bfloat16) * 0.05)(D, H * Dh)), 'wk': _w((lambda *s: torch.randn(*s, dtype=torch.bfloat16) * 0.05)(D, Dh)), 'wv': _w((lambda *s: torch.randn(*s, dtype=torch.bfloat16) * 0.05)(D, Dh)), 'wo': _w((lambda *s: torch.randn(*s, dtype=torch.bfloat16) * 0.05)(H * Dh, D))}
    _A_in = _A_setup()

    def _B_setup():
        B, S, D, F = (1, 2048, 1024, 3584)
        Fh = F // 2
        return {'x': _w((lambda *s: torch.randn(*s, dtype=torch.bfloat16) * 0.05)(B, S, D)), 'w_in': _w((lambda *s: torch.randn(*s, dtype=torch.bfloat16) * 1.6)(D, 2 * Fh)), 'w_sp': _w(0.01 * (lambda *s: torch.randn(*s, dtype=torch.bfloat16) * 1.6)(S, S)), 'b_sp': _w(1.0 + 0.01 * (lambda *s: torch.randn(*s, dtype=torch.bfloat16) * 0.05)(S)), 'w_out': _w((lambda *s: torch.randn(*s, dtype=torch.bfloat16) * 0.05)(Fh, D))}
    _B_in = _B_setup()
    return {'A_x': _A_in['x'], 'A_wq': _A_in['wq'], 'A_wk': _A_in['wk'], 'A_wv': _A_in['wv'], 'A_wo': _A_in['wo'], 'B_x': _B_in['x'], 'B_w_in': _B_in['w_in'], 'B_w_sp': _B_in['w_sp'], 'B_b_sp': _B_in['b_sp'], 'B_w_out': _B_in['w_out']}

def reference(A_x, A_wq, A_wk, A_wv, A_wo, B_x, B_w_in, B_w_sp, B_b_sp, B_w_out):

    def _A_ref(x, wq, wk, wv, wo):
        B, S, D = x.shape
        H = 32
        Dh = D // H
        q = (lambda x, *d: x.permute(*d))((x @ wq).reshape(B, S, H, Dh), 0, 2, 1, 3)
        k = x @ wk
        v = x @ wv
        scores = torch.einsum('bhqd,bkd->bhqk', q, k) * Dh ** (-0.5)
        p = _softmax(scores, axis=-1)
        o = torch.einsum('bhqk,bkd->bhqd', p, v)
        return (lambda x, *d: x.permute(*d))(o, 0, 2, 1, 3).reshape(B, S, H * Dh) @ wo

    def _B_ref(x, w_in, w_sp, b_sp, w_out):
        B, S, D = x.shape
        F = w_in.shape[-1]
        Fh = F // 2
        z = _gelu(torch.einsum('bsd,df->bsf', x, w_in))
        z1 = z[..., :Fh].clone()
        z2 = _layernorm(z[..., Fh:], axis=-1)
        g = torch.einsum('ts,bsf->btf', w_sp, z2) + b_sp[None, :, None]
        return torch.einsum('bsf,fd->bsd', z1 * g, w_out)
    x = A_x
    h = x + _A_ref(_layernorm(x, axis=-1), A_wq, A_wk, A_wv, A_wo)
    h2 = h + _B_ref(_layernorm(h, axis=-1), B_w_in, B_w_sp, B_b_sp, B_w_out)
    return h2
```

```asm
; @launch grid=(256,1,1) block=(512,1,1) lds=163840
.amdgcn_target "amdgcn-amd-amdhsa--gfx950"
.text
.globl sequential_preLN__grouped_kv_mqa__mixer_gmlp__prompt_kernel
.p2align 8
.type sequential_preLN__grouped_kv_mqa__mixer_gmlp__prompt_kernel,@function
sequential_preLN__grouped_kv_mqa__mixer_gmlp__prompt_kernel:
    s_cmp_ge_u32 s2, 256
    s_cbranch_scc1 L_end
    s_load_dwordx16 s[64:79], s[0:1], 0
    s_load_dwordx8 s[80:87], s[0:1], 64
    s_load_dwordx2 s[88:89], s[0:1], 96
    s_getpc_b64 s[32:33]
L_pc:
    s_lshl_b32 s31, s2, 10
    v_lshlrev_b32 v1, 4, v0
    s_and_b32 s31, s31, 0xe000
    v_add_u32 v1, s31, v1
    v_min_u32 v1, L_end-L_pc-16, v1
    global_load_dwordx4 v[248:251], v1, s[32:33]
    v_readfirstlane_b32 s3, v0
    v_and_b32 v0, 63, v0
    s_lshr_b32 s3, s3, 6
    v_lshlrev_b32 v1, 4, v0
    s_and_b32 s26, s2, 7
    s_lshr_b32 s27, s2, 3
    s_lshl_b32 s28, s26, 2
    s_lshr_b32 s29, s27, 3
    s_add_u32 s28, s28, s29
    s_and_b32 s29, s27, 7
    s_cmp_ge_u32 s3, 4
    s_cbranch_scc1 LA_hi
    v_and_b32 v13, 15, v0
    v_lshrrev_b32 v12, 4, v0
    v_lshlrev_b32 v4, 11, v13
    v_lshl_add_u32 v4, v12, 4, v4
    s_lshl_b32 s30, s28, 2
    s_lshr_b32 s31, s29, 1
    s_add_u32 s30, s30, s31
    s_lshl_b32 s30, s30, 15
    s_lshl_b32 s31, s3, 9
    s_add_u32 s30, s30, s31
    s_lshl_b32 s31, s3, 14
    s_mov_b32 m0, s31
    s_and_b32 s32, s29, 1
    s_waitcnt lgkmcnt(0)
    s_mov_b32 s12, s64
    s_and_b32 s13, s65, 0xffff
    s_mov_b32 s14, 0x400000
    s_mov_b32 s15, 0x20000
    s_cmp_eq_u32 s32, 0
    s_cselect_b32 s16, s68, s70
    s_cselect_b32 s17, s69, s71
    s_and_b32 s17, s17, 0xffff
    s_mov_b32 s18, 65536
    s_mov_b32 s19, 0x20000
    s_mov_b32 s33, s31
    buffer_load_dwordx4 v[104:107], v4, s[12:15], s30 offen offset:0
    buffer_load_dwordx4 v[108:111], v4, s[12:15], s30 offen offset:64
    buffer_load_dwordx4 v1, s[16:19], s33 offen offset:0 lds
    buffer_load_dwordx4 v1, s[16:19], s33 offen offset:1024 lds
    buffer_load_dwordx4 v1, s[16:19], s33 offen offset:2048 lds
    buffer_load_dwordx4 v1, s[16:19], s33 offen offset:3072 lds
    s_add_u32 m0, m0, 4096
    s_add_u32 s33, s33, 4096
    buffer_load_dwordx4 v[112:115], v4, s[12:15], s30 offen offset:128
    buffer_load_dwordx4 v[116:119], v4, s[12:15], s30 offen offset:192
    buffer_load_dwordx4 v1, s[16:19], s33 offen offset:0 lds
    buffer_load_dwordx4 v1, s[16:19], s33 offen offset:1024 lds
    buffer_load_dwordx4 v1, s[16:19], s33 offen offset:2048 lds
    buffer_load_dwordx4 v1, s[16:19], s33 offen offset:3072 lds
    s_add_u32 m0, m0, 4096
    s_add_u32 s33, s33, 4096
    buffer_load_dwordx4 v[120:123], v4, s[12:15], s30 offen offset:256
    buffer_load_dwordx4 v[124:127], v4, s[12:15], s30 offen offset:320
    buffer_load_dwordx4 v1, s[16:19], s33 offen offset:0 lds
    buffer_load_dwordx4 v1, s[16:19], s33 offen offset:1024 lds
    buffer_load_dwordx4 v1, s[16:19], s33 offen offset:2048 lds
    buffer_load_dwordx4 v1, s[16:19], s33 offen offset:3072 lds
    s_add_u32 m0, m0, 4096
    s_add_u32 s33, s33, 4096
    buffer_load_dwordx4 v[128:131], v4, s[12:15], s30 offen offset:384
    buffer_load_dwordx4 v[132:135], v4, s[12:15], s30 offen offset:448
    buffer_load_dwordx4 v1, s[16:19], s33 offen offset:0 lds
    buffer_load_dwordx4 v1, s[16:19], s33 offen offset:1024 lds
    buffer_load_dwordx4 v1, s[16:19], s33 offen offset:2048 lds
    buffer_load_dwordx4 v1, s[16:19], s33 offen offset:3072 lds
    s_mov_b32 s4, s88
    s_and_b32 s5, s89, 0xffff
    s_mov_b32 s6, 0x10000000
    s_mov_b32 s7, 0x20000
    v_bfe_u32 v7, v0, 2, 2
    v_lshlrev_b32 v5, 9, v12
    v_lshl_add_u32 v5, v7, 6, v5
    v_add_u32 v5, s31, v5
    v_and_b32 v7, 3, v0
    v_lshlrev_b32 v7, 4, v7
    v_bfe_u32 v8, v0, 1, 1
    v_and_b32 v9, 1, v0
    v_lshlrev_b32 v8, 3, v8
    v_lshl_add_u32 v8, v9, 4, v8
    s_cmp_eq_u32 s32, 0
    s_cselect_b64 vcc, -1, 0
    s_cselect_b32 s33, 8, 32
    v_cndmask_b32 v7, v8, v7, vcc
    v_add_u32 v5, v5, v7
    v_add_u32 v6, s33, v5
    v_mov_b32 v8, 0x3f803f80
    v_mov_b32 v9, v8
    v_mov_b32 v10, v8
    v_mov_b32 v11, v8
    v_mov_b32 v64, 0
    v_mov_b32 v65, 0
    v_mov_b32 v66, 0
    v_mov_b32 v67, 0
    v_mov_b32 v68, 0
    v_mov_b32 v69, 0
    v_mov_b32 v70, 0
    v_mov_b32 v71, 0
    v_mov_b32 v72, 0
    v_mov_b32 v73, 0
    v_mov_b32 v74, 0
    v_mov_b32 v75, 0
    v_mov_b32 v76, 0
    v_mov_b32 v77, 0
    v_mov_b32 v78, 0
    v_mov_b32 v79, 0
    v_mov_b32 v80, 0
    v_mov_b32 v81, 0
    v_mov_b32 v82, 0
    v_mov_b32 v83, 0
    v_mov_b32 v176, 0
    v_mov_b32 v177, 0
    v_mov_b32 v178, 0
    v_mov_b32 v179, 0
    v_mov_b32 v180, 0
    v_mov_b32 v181, 0
    v_mov_b32 v182, 0
    v_mov_b32 v183, 0
    v_mov_b32 v184, 0
    v_mov_b32 v185, 0
    v_mov_b32 v186, 0
    v_mov_b32 v187, 0
    v_mov_b32 v188, 0
    v_mov_b32 v189, 0
    v_mov_b32 v190, 0
    v_mov_b32 v191, 0
    v_mov_b32 v192, 0
    v_mov_b32 v193, 0
    v_mov_b32 v194, 0
    v_mov_b32 v195, 0
    v_mov_b32 v196, 0
    v_mov_b32 v197, 0
    v_mov_b32 v198, 0
    v_mov_b32 v199, 0
    v_mov_b32 v200, 0
    v_mov_b32 v201, 0
    v_mov_b32 v202, 0
    v_mov_b32 v203, 0
    v_mov_b32 v204, 0
    v_mov_b32 v205, 0
    v_mov_b32 v206, 0
    v_mov_b32 v207, 0
    v_mov_b32 v208, 0
    v_mov_b32 v209, 0
    v_mov_b32 v210, 0
    v_mov_b32 v211, 0
    v_mov_b32 v212, 0
    v_mov_b32 v213, 0
    v_mov_b32 v214, 0
    v_mov_b32 v215, 0
    v_mov_b32 v216, 0
    v_mov_b32 v217, 0
    v_mov_b32 v218, 0
    v_mov_b32 v219, 0
    v_and_b32 v14, 7, v0
    v_cmp_eq_u32 s[40:41], 0, v14
    v_cmp_eq_u32 s[42:43], 4, v14
    v_mov_b32 v224, 0xdddddddd
    s_nop 0
    v_cndmask_b32 v220, 0, v8, s[40:41]
    v_cndmask_b32 v221, 0, v8, s[40:41]
    v_cndmask_b32 v222, 0, v8, s[42:43]
    v_cndmask_b32 v223, 0, v8, s[42:43]
    s_cmp_eq_u32 s32, 0
    s_cbranch_scc0 LA_a0v
    s_waitcnt vmcnt(18)
    ds_read_b64_tr_b16 v[136:137], v5 offset:0
    ds_read_b64_tr_b16 v[138:139], v5 offset:256
    ds_read_b64_tr_b16 v[140:141], v6 offset:0
    ds_read_b64_tr_b16 v[142:143], v6 offset:256
    ds_read_b64_tr_b16 v[144:145], v5 offset:2048
    ds_read_b64_tr_b16 v[146:147], v5 offset:2304
    ds_read_b64_tr_b16 v[148:149], v6 offset:2048
    ds_read_b64_tr_b16 v[150:151], v6 offset:2304
    v_dot2c_f32_bf16 v80, v104, v8
    v_dot2c_f32_bf16 v81, v104, v104
    v_dot2c_f32_bf16 v82, v105, v8
    v_dot2c_f32_bf16 v83, v105, v105
    v_dot2c_f32_bf16 v80, v106, v8
    v_dot2c_f32_bf16 v81, v106, v106
    v_dot2c_f32_bf16 v82, v107, v8
    v_dot2c_f32_bf16 v83, v107, v107
    v_dot2c_f32_bf16 v80, v108, v8
    v_dot2c_f32_bf16 v81, v108, v108
    v_dot2c_f32_bf16 v82, v109, v8
    v_dot2c_f32_bf16 v83, v109, v109
    v_dot2c_f32_bf16 v80, v110, v8
    v_dot2c_f32_bf16 v81, v110, v110
    v_dot2c_f32_bf16 v82, v111, v8
    v_dot2c_f32_bf16 v83, v111, v111
    s_waitcnt lgkmcnt(0)
    v_mfma_f32_16x16x32_bf16 v[64:67], v[136:139], v[104:107], v[64:67]
    v_mfma_f32_16x16x32_bf16 v[72:75], v[136:139], v[8:11], v[72:75]
    v_mfma_f32_16x16x32_bf16 v[68:71], v[140:143], v[104:107], v[68:71]
    v_mfma_f32_16x16x32_bf16 v[76:79], v[140:143], v[8:11], v[76:79]
    v_mfma_f32_16x16x32_bf16 v[64:67], v[144:147], v[108:111], v[64:67]
    v_mfma_f32_16x16x32_bf16 v[72:75], v[144:147], v[8:11], v[72:75]
    v_mfma_f32_16x16x32_bf16 v[68:71], v[148:151], v[108:111], v[68:71]
    v_mfma_f32_16x16x32_bf16 v[76:79], v[148:151], v[8:11], v[76:79]
    s_waitcnt vmcnt(12)
    ds_read_b64_tr_b16 v[136:137], v5 offset:4096
    ds_read_b64_tr_b16 v[138:139], v5 offset:4352
    ds_read_b64_tr_b16 v[140:141], v6 offset:4096
    ds_read_b64_tr_b16 v[142:143], v6 offset:4352
    ds_read_b64_tr_b16 v[144:145], v5 offset:6144
    ds_read_b64_tr_b16 v[146:147], v5 offset:6400
    ds_read_b64_tr_b16 v[148:149], v6 offset:6144
    ds_read_b64_tr_b16 v[150:151], v6 offset:6400
    v_dot2c_f32_bf16 v80, v112, v8
    v_dot2c_f32_bf16 v81, v112, v112
    v_dot2c_f32_bf16 v82, v113, v8
    v_dot2c_f32_bf16 v83, v113, v113
    v_dot2c_f32_bf16 v80, v114, v8
    v_dot2c_f32_bf16 v81, v114, v114
    v_dot2c_f32_bf16 v82, v115, v8
    v_dot2c_f32_bf16 v83, v115, v115
    v_dot2c_f32_bf16 v80, v116, v8
    v_dot2c_f32_bf16 v81, v116, v116
    v_dot2c_f32_bf16 v82, v117, v8
    v_dot2c_f32_bf16 v83, v117, v117
    v_dot2c_f32_bf16 v80, v118, v8
    v_dot2c_f32_bf16 v81, v118, v118
    v_dot2c_f32_bf16 v82, v119, v8
    v_dot2c_f32_bf16 v83, v119, v119
    s_waitcnt lgkmcnt(0)
    v_mfma_f32_16x16x32_bf16 v[64:67], v[136:139], v[112:115], v[64:67]
    v_mfma_f32_16x16x32_bf16 v[72:75], v[136:139], v[8:11], v[72:75]
    v_mfma_f32_16x16x32_bf16 v[68:71], v[140:143], v[112:115], v[68:71]
    v_mfma_f32_16x16x32_bf16 v[76:79], v[140:143], v[8:11], v[76:79]
    v_mfma_f32_16x16x32_bf16 v[64:67], v[144:147], v[116:119], v[64:67]
    v_mfma_f32_16x16x32_bf16 v[72:75], v[144:147], v[8:11], v[72:75]
    v_mfma_f32_16x16x32_bf16 v[68:71], v[148:151], v[116:119], v[68:71]
    v_mfma_f32_16x16x32_bf16 v[76:79], v[148:151], v[8:11], v[76:79]
    s_waitcnt vmcnt(6)
    ds_read_b64_tr_b16 v[136:137], v5 offset:8192
    ds_read_b64_tr_b16 v[138:139], v5 offset:8448
    ds_read_b64_tr_b16 v[140:141], v6 offset:8192
    ds_read_b64_tr_b16 v[142:143], v6 offset:8448
    ds_read_b64_tr_b16 v[144:145], v5 offset:10240
    ds_read_b64_tr_b16 v[146:147], v5 offset:10496
    ds_read_b64_tr_b16 v[148:149], v6 offset:10240
    ds_read_b64_tr_b16 v[150:151], v6 offset:10496
    v_dot2c_f32_bf16 v80, v120, v8
    v_dot2c_f32_bf16 v81, v120, v120
    v_dot2c_f32_bf16 v82, v121, v8
    v_dot2c_f32_bf16 v83, v121, v121
    v_dot2c_f32_bf16 v80, v122, v8
    v_dot2c_f32_bf16 v81, v122, v122
    v_dot2c_f32_bf16 v82, v123, v8
    v_dot2c_f32_bf16 v83, v123, v123
    v_dot2c_f32_bf16 v80, v124, v8
    v_dot2c_f32_bf16 v81, v124, v124
    v_dot2c_f32_bf16 v82, v125, v8
    v_dot2c_f32_bf16 v83, v125, v125
    v_dot2c_f32_bf16 v80, v126, v8
    v_dot2c_f32_bf16 v81, v126, v126
    v_dot2c_f32_bf16 v82, v127, v8
    v_dot2c_f32_bf16 v83, v127, v127
    s_waitcnt lgkmcnt(0)
    v_mfma_f32_16x16x32_bf16 v[64:67], v[136:139], v[120:123], v[64:67]
    v_mfma_f32_16x16x32_bf16 v[72:75], v[136:139], v[8:11], v[72:75]
    v_mfma_f32_16x16x32_bf16 v[68:71], v[140:143], v[120:123], v[68:71]
    v_mfma_f32_16x16x32_bf16 v[76:79], v[140:143], v[8:11], v[76:79]
    v_mfma_f32_16x16x32_bf16 v[64:67], v[144:147], v[124:127], v[64:67]
    v_mfma_f32_16x16x32_bf16 v[72:75], v[144:147], v[8:11], v[72:75]
    v_mfma_f32_16x16x32_bf16 v[68:71], v[148:151], v[124:127], v[68:71]
    v_mfma_f32_16x16x32_bf16 v[76:79], v[148:151], v[8:11], v[76:79]
    s_waitcnt vmcnt(0)
    ds_read_b64_tr_b16 v[136:137], v5 offset:12288
    ds_read_b64_tr_b16 v[138:139], v5 offset:12544
    ds_read_b64_tr_b16 v[140:141], v6 offset:12288
    ds_read_b64_tr_b16 v[142:143], v6 offset:12544
    ds_read_b64_tr_b16 v[144:145], v5 offset:14336
    ds_read_b64_tr_b16 v[146:147], v5 offset:14592
    ds_read_b64_tr_b16 v[148:149], v6 offset:14336
    ds_read_b64_tr_b16 v[150:151], v6 offset:14592
    v_dot2c_f32_bf16 v80, v128, v8
    v_dot2c_f32_bf16 v81, v128, v128
    v_dot2c_f32_bf16 v82, v129, v8
    v_dot2c_f32_bf16 v83, v129, v129
    v_dot2c_f32_bf16 v80, v130, v8
    v_dot2c_f32_bf16 v81, v130, v130
    v_dot2c_f32_bf16 v82, v131, v8
    v_dot2c_f32_bf16 v83, v131, v131
    v_dot2c_f32_bf16 v80, v132, v8
    v_dot2c_f32_bf16 v81, v132, v132
    v_dot2c_f32_bf16 v82, v133, v8
    v_dot2c_f32_bf16 v83, v133, v133
    v_dot2c_f32_bf16 v80, v134, v8
    v_dot2c_f32_bf16 v81, v134, v134
    v_dot2c_f32_bf16 v82, v135, v8
    v_dot2c_f32_bf16 v83, v135, v135
    s_waitcnt lgkmcnt(0)
    v_mfma_f32_16x16x32_bf16 v[64:67], v[136:139], v[128:131], v[64:67]
    v_mfma_f32_16x16x32_bf16 v[72:75], v[136:139], v[8:11], v[72:75]
    v_mfma_f32_16x16x32_bf16 v[68:71], v[140:143], v[128:131], v[68:71]
    v_mfma_f32_16x16x32_bf16 v[76:79], v[140:143], v[8:11], v[76:79]
    v_mfma_f32_16x16x32_bf16 v[64:67], v[144:147], v[132:135], v[64:67]
    v_mfma_f32_16x16x32_bf16 v[72:75], v[144:147], v[8:11], v[72:75]
    v_mfma_f32_16x16x32_bf16 v[68:71], v[148:151], v[132:135], v[68:71]
    v_mfma_f32_16x16x32_bf16 v[76:79], v[148:151], v[8:11], v[76:79]
    s_branch LA_a0d
LA_a0v:
    s_waitcnt vmcnt(18)
    ds_read_b64_tr_b16 v[136:137], v5 offset:0
    ds_read_b64_tr_b16 v[138:139], v5 offset:256
    ds_read_b64_tr_b16 v[140:141], v6 offset:0
    ds_read_b64_tr_b16 v[142:143], v6 offset:256
    ds_read_b64_tr_b16 v[144:145], v5 offset:2048
    ds_read_b64_tr_b16 v[146:147], v5 offset:2304
    ds_read_b64_tr_b16 v[148:149], v6 offset:2048
    ds_read_b64_tr_b16 v[150:151], v6 offset:2304
    v_dot2c_f32_bf16 v80, v104, v8
    v_dot2c_f32_bf16 v81, v104, v104
    v_dot2c_f32_bf16 v82, v105, v8
    v_dot2c_f32_bf16 v83, v105, v105
    v_dot2c_f32_bf16 v80, v106, v8
    v_dot2c_f32_bf16 v81, v106, v106
    v_dot2c_f32_bf16 v82, v107, v8
    v_dot2c_f32_bf16 v83, v107, v107
    v_dot2c_f32_bf16 v80, v108, v8
    v_dot2c_f32_bf16 v81, v108, v108
    v_dot2c_f32_bf16 v82, v109, v8
    v_dot2c_f32_bf16 v83, v109, v109
    v_dot2c_f32_bf16 v80, v110, v8
    v_dot2c_f32_bf16 v81, v110, v110
    v_dot2c_f32_bf16 v82, v111, v8
    v_dot2c_f32_bf16 v83, v111, v111
    s_waitcnt lgkmcnt(0)
    v_mfma_f32_16x16x32_bf16 v[64:67], v[104:107], v[136:139], v[64:67]
    v_mfma_f32_16x16x32_bf16 v[72:75], v[8:11], v[136:139], v[72:75]
    v_mfma_f32_16x16x32_bf16 v[68:71], v[104:107], v[140:143], v[68:71]
    v_mfma_f32_16x16x32_bf16 v[76:79], v[8:11], v[140:143], v[76:79]
    v_mfma_f32_16x16x32_bf16 v[64:67], v[108:111], v[144:147], v[64:67]
    v_mfma_f32_16x16x32_bf16 v[72:75], v[8:11], v[144:147], v[72:75]
    v_mfma_f32_16x16x32_bf16 v[68:71], v[108:111], v[148:151], v[68:71]
    v_mfma_f32_16x16x32_bf16 v[76:79], v[8:11], v[148:151], v[76:79]
    s_waitcnt vmcnt(12)
    ds_read_b64_tr_b16 v[136:137], v5 offset:4096
    ds_read_b64_tr_b16 v[138:139], v5 offset:4352
    ds_read_b64_tr_b16 v[140:141], v6 offset:4096
    ds_read_b64_tr_b16 v[142:143], v6 offset:4352
    ds_read_b64_tr_b16 v[144:145], v5 offset:6144
    ds_read_b64_tr_b16 v[146:147], v5 offset:6400
    ds_read_b64_tr_b16 v[148:149], v6 offset:6144
    ds_read_b64_tr_b16 v[150:151], v6 offset:6400
    v_dot2c_f32_bf16 v80, v112, v8
    v_dot2c_f32_bf16 v81, v112, v112
    v_dot2c_f32_bf16 v82, v113, v8
    v_dot2c_f32_bf16 v83, v113, v113
    v_dot2c_f32_bf16 v80, v114, v8
    v_dot2c_f32_bf16 v81, v114, v114
    v_dot2c_f32_bf16 v82, v115, v8
    v_dot2c_f32_bf16 v83, v115, v115
    v_dot2c_f32_bf16 v80, v116, v8
    v_dot2c_f32_bf16 v81, v116, v116
    v_dot2c_f32_bf16 v82, v117, v8
    v_dot2c_f32_bf16 v83, v117, v117
    v_dot2c_f32_bf16 v80, v118, v8
    v_dot2c_f32_bf16 v81, v118, v118
    v_dot2c_f32_bf16 v82, v119, v8
    v_dot2c_f32_bf16 v83, v119, v119
    s_waitcnt lgkmcnt(0)
    v_mfma_f32_16x16x32_bf16 v[64:67], v[112:115], v[136:139], v[64:67]
    v_mfma_f32_16x16x32_bf16 v[72:75], v[8:11], v[136:139], v[72:75]
    v_mfma_f32_16x16x32_bf16 v[68:71], v[112:115], v[140:143], v[68:71]
    v_mfma_f32_16x16x32_bf16 v[76:79], v[8:11], v[140:143], v[76:79]
    v_mfma_f32_16x16x32_bf16 v[64:67], v[116:119], v[144:147], v[64:67]
    v_mfma_f32_16x16x32_bf16 v[72:75], v[8:11], v[144:147], v[72:75]
    v_mfma_f32_16x16x32_bf16 v[68:71], v[116:119], v[148:151], v[68:71]
    v_mfma_f32_16x16x32_bf16 v[76:79], v[8:11], v[148:151], v[76:79]
    s_waitcnt vmcnt(6)
    ds_read_b64_tr_b16 v[136:137], v5 offset:8192
    ds_read_b64_tr_b16 v[138:139], v5 offset:8448
    ds_read_b64_tr_b16 v[140:141], v6 offset:8192
    ds_read_b64_tr_b16 v[142:143], v6 offset:8448
    ds_read_b64_tr_b16 v[144:145], v5 offset:10240
    ds_read_b64_tr_b16 v[146:147], v5 offset:10496
    ds_read_b64_tr_b16 v[148:149], v6 offset:10240
    ds_read_b64_tr_b16 v[150:151], v6 offset:10496
    v_dot2c_f32_bf16 v80, v120, v8
    v_dot2c_f32_bf16 v81, v120, v120
    v_dot2c_f32_bf16 v82, v121, v8
    v_dot2c_f32_bf16 v83, v121, v121
    v_dot2c_f32_bf16 v80, v122, v8
    v_dot2c_f32_bf16 v81, v122, v122
    v_dot2c_f32_bf16 v82, v123, v8
    v_dot2c_f32_bf16 v83, v123, v123
    v_dot2c_f32_bf16 v80, v124, v8
    v_dot2c_f32_bf16 v81, v124, v124
    v_dot2c_f32_bf16 v82, v125, v8
    v_dot2c_f32_bf16 v83, v125, v125
    v_dot2c_f32_bf16 v80, v126, v8
    v_dot2c_f32_bf16 v81, v126, v126
    v_dot2c_f32_bf16 v82, v127, v8
    v_dot2c_f32_bf16 v83, v127, v127
    s_waitcnt lgkmcnt(0)
    v_mfma_f32_16x16x32_bf16 v[64:67], v[120:123], v[136:139], v[64:67]
    v_mfma_f32_16x16x32_bf16 v[72:75], v[8:11], v[136:139], v[72:75]
    v_mfma_f32_16x16x32_bf16 v[68:71], v[120:123], v[140:143], v[68:71]
    v_mfma_f32_16x16x32_bf16 v[76:79], v[8:11], v[140:143], v[76:79]
    v_mfma_f32_16x16x32_bf16 v[64:67], v[124:127], v[144:147], v[64:67]
    v_mfma_f32_16x16x32_bf16 v[72:75], v[8:11], v[144:147], v[72:75]
    v_mfma_f32_16x16x32_bf16 v[68:71], v[124:127], v[148:151], v[68:71]
    v_mfma_f32_16x16x32_bf16 v[76:79], v[8:11], v[148:151], v[76:79]
    s_waitcnt vmcnt(0)
    ds_read_b64_tr_b16 v[136:137], v5 offset:12288
    ds_read_b64_tr_b16 v[138:139], v5 offset:12544
    ds_read_b64_tr_b16 v[140:141], v6 offset:12288
    ds_read_b64_tr_b16 v[142:143], v6 offset:12544
    ds_read_b64_tr_b16 v[144:145], v5 offset:14336
    ds_read_b64_tr_b16 v[146:147], v5 offset:14592
    ds_read_b64_tr_b16 v[148:149], v6 offset:14336
    ds_read_b64_tr_b16 v[150:151], v6 offset:14592
    v_dot2c_f32_bf16 v80, v128, v8
    v_dot2c_f32_bf16 v81, v128, v128
    v_dot2c_f32_bf16 v82, v129, v8
    v_dot2c_f32_bf16 v83, v129, v129
    v_dot2c_f32_bf16 v80, v130, v8
    v_dot2c_f32_bf16 v81, v130, v130
    v_dot2c_f32_bf16 v82, v131, v8
    v_dot2c_f32_bf16 v83, v131, v131
    v_dot2c_f32_bf16 v80, v132, v8
    v_dot2c_f32_bf16 v81, v132, v132
    v_dot2c_f32_bf16 v82, v133, v8
    v_dot2c_f32_bf16 v83, v133, v133
    v_dot2c_f32_bf16 v80, v134, v8
    v_dot2c_f32_bf16 v81, v134, v134
    v_dot2c_f32_bf16 v82, v135, v8
    v_dot2c_f32_bf16 v83, v135, v135
    s_waitcnt lgkmcnt(0)
    v_mfma_f32_16x16x32_bf16 v[64:67], v[128:131], v[136:139], v[64:67]
    v_mfma_f32_16x16x32_bf16 v[72:75], v[8:11], v[136:139], v[72:75]
    v_mfma_f32_16x16x32_bf16 v[68:71], v[128:131], v[140:143], v[68:71]
    v_mfma_f32_16x16x32_bf16 v[76:79], v[8:11], v[140:143], v[76:79]
    v_mfma_f32_16x16x32_bf16 v[64:67], v[132:135], v[144:147], v[64:67]
    v_mfma_f32_16x16x32_bf16 v[72:75], v[8:11], v[144:147], v[72:75]
    v_mfma_f32_16x16x32_bf16 v[68:71], v[132:135], v[148:151], v[68:71]
    v_mfma_f32_16x16x32_bf16 v[76:79], v[8:11], v[148:151], v[76:79]
LA_a0d:
    v_add_u32 v7, s31, v1
    v_pk_add_f32 v[80:81], v[80:81], v[82:83]
    v_lshlrev_b32 v5, 3, v0
    v_add_u32 v5, s31, v5
    v_and_b32 v14, 31, v0
    v_lshrrev_b32 v15, 5, v0
    v_bfe_u32 v12, v0, 1, 3
    v_xor_b32 v12, v12, v15
    ds_write_b64 v5, v[80:81] offset:4096
    ds_write_b128 v7, v[64:67] offset:0
    ds_write_b128 v7, v[68:71] offset:1024
    ds_write_b128 v7, v[72:75] offset:2048
    ds_write_b128 v7, v[76:79] offset:3072
    v_lshlrev_b32 v152, 7, v14
    v_lshl_add_u32 v152, v12, 4, v152
    v_add_u32 v152, 40960, v152
    v_bfe_u32 v12, v0, 2, 1
    v_bfe_u32 v13, v0, 4, 1
    v_cmp_eq_u32 vcc, v12, v13
    v_xor_b32 v153, 32, v152
    v_xor_b32 v154, 64, v152
    v_xor_b32 v155, 96, v152
    v_cndmask_b32 v100, 0, v8, vcc
    v_mov_b32 v101, v100
    v_mov_b32 v102, v100
    v_mov_b32 v103, v100
    v_lshrrev_b32 v156, 5, v0
    v_mul_u32_u24 v156, 1024, v156
    v_bfe_u32 v12, v0, 2, 2
    v_lshl_add_u32 v156, v12, 6, v156
    v_bfe_u32 v12, v0, 4, 1
    v_lshl_add_u32 v156, v12, 5, v156
    v_bfe_u32 v12, v0, 1, 1
    v_lshl_add_u32 v156, v12, 3, v156
    v_and_b32 v12, 1, v0
    v_lshl_add_u32 v156, v12, 4, v156
    s_lshr_b32 s31, s3, 1
    s_lshl_b32 s31, s31, 13
    s_and_b32 s32, s3, 1
    s_lshl_b32 s32, s32, 9
    s_add_u32 s31, s31, s32
    s_add_u32 s31, s31, 49152
    v_add_u32 v156, s31, v156
    s_waitcnt lgkmcnt(0)
    v_mov_b32 v64, 0
    v_mov_b32 v65, 0
    v_mov_b32 v66, 0
    v_mov_b32 v67, 0
    v_mov_b32 v68, 0
    v_mov_b32 v69, 0
    v_mov_b32 v70, 0
    v_mov_b32 v71, 0
    v_mov_b32 v72, 0
    v_mov_b32 v73, 0
    v_mov_b32 v74, 0
    v_mov_b32 v75, 0
    v_mov_b32 v76, 0
    v_mov_b32 v77, 0
    v_mov_b32 v78, 0
    v_mov_b32 v79, 0
    v_mov_b32 v80, 0
    v_mov_b32 v81, 0
    v_mov_b32 v82, 0
    v_mov_b32 v83, 0
    v_mov_b32 v84, 0
    v_mov_b32 v85, 0
    v_mov_b32 v86, 0
    v_mov_b32 v87, 0
    v_mov_b32 v88, 0
    v_mov_b32 v89, 0
    v_mov_b32 v90, 0
    v_mov_b32 v91, 0
    v_mov_b32 v92, 0
    v_mov_b32 v93, 0
    v_mov_b32 v94, 0
    v_mov_b32 v95, 0
    v_mov_b32 v96, 0
    v_mov_b32 v97, 0
    v_mov_b32 v98, 0
    v_mov_b32 v99, 0
    s_mov_b32 s36, 16
    s_mov_b32 s37, 24576
    v_add_u32 v2, s37, v152
    v_add_u32 v3, s37, v153
    v_add_u32 v4, s37, v154
    v_add_u32 v5, s37, v155
    v_add_u32 v6, s37, v156
    s_barrier
    ds_read_b64_tr_b16 v[104:105], v6 offset:0
    ds_read_b64_tr_b16 v[106:107], v6 offset:256
    ds_read_b128 v[108:111], v2 offset:0
    ds_read_b128 v[112:115], v2 offset:4096
    ds_read_b64_tr_b16 v[116:117], v6 offset:2048
    ds_read_b64_tr_b16 v[118:119], v6 offset:2304
    ds_read_b128 v[120:123], v3 offset:0
    ds_read_b128 v[124:127], v3 offset:4096
.p2align 4
Lcl1:
    s_waitcnt  lgkmcnt(0)
    v_mfma_f32_32x32x16_bf16 v[64:79], v[104:107], v[108:111], v[64:79]
    ds_read_b64_tr_b16 v[128:129], v6 offset:4096
    ds_read_b64_tr_b16 v[130:131], v6 offset:4352
    ds_read_b128 v[132:135], v4 offset:0
    v_mfma_f32_16x16x32_bf16 v[96:99], v[100:103], v[104:107], v[96:99]
    ds_read_b128 v[136:139], v4 offset:4096
    v_mfma_f32_32x32x16_bf16 v[80:95], v[104:107], v[112:115], v[80:95]
    ds_read_b64_tr_b16 v[140:141], v6 offset:6144
    ds_read_b64_tr_b16 v[142:143], v6 offset:6400
    ds_read_b128 v[144:147], v5 offset:0
    v_mfma_f32_32x32x16_bf16 v[64:79], v[116:119], v[120:123], v[64:79]
    ds_read_b128 v[148:151], v5 offset:4096
    s_add_u32 s37, s37, 24576
    s_cmp_eq_u32 s37, 122880
    s_cselect_b32 s37, 0, s37
    v_mfma_f32_16x16x32_bf16 v[96:99], v[100:103], v[116:119], v[96:99]
    v_add_u32 v2, s37, v152
    v_mfma_f32_32x32x16_bf16 v[80:95], v[116:119], v[124:127], v[80:95]
    v_add_u32 v3, s37, v153
    v_add_u32 v4, s37, v154
    v_add_u32 v5, s37, v155
    v_add_u32 v6, s37, v156
    s_waitcnt  lgkmcnt(0)
    s_barrier
    v_mfma_f32_32x32x16_bf16 v[64:79], v[128:131], v[132:135], v[64:79]
    ds_read_b64_tr_b16 v[104:105], v6 offset:0
    ds_read_b64_tr_b16 v[106:107], v6 offset:256
    ds_read_b128 v[108:111], v2 offset:0
    v_mfma_f32_16x16x32_bf16 v[96:99], v[100:103], v[128:131], v[96:99]
    ds_read_b128 v[112:115], v2 offset:4096
    v_mfma_f32_32x32x16_bf16 v[80:95], v[128:131], v[136:139], v[80:95]
    ds_read_b64_tr_b16 v[116:117], v6 offset:2048
    ds_read_b64_tr_b16 v[118:119], v6 offset:2304
    ds_read_b128 v[120:123], v3 offset:0
    v_mfma_f32_32x32x16_bf16 v[64:79], v[140:143], v[144:147], v[64:79]
    ds_read_b128 v[124:127], v3 offset:4096
    s_sub_u32 s36, s36, 1
    s_cmp_lg_u32 s36, 0
    v_mfma_f32_16x16x32_bf16 v[96:99], v[100:103], v[140:143], v[96:99]
    v_mfma_f32_32x32x16_bf16 v[80:95], v[140:143], v[148:151], v[80:95]
    s_cbranch_scc1 Lcl1
    s_waitcnt lgkmcnt(0)
    s_lshl_b32 s31, s3, 12
    s_add_u32 s31, s31, 131072
    v_lshl_add_u32 v13, v14, 2, s31
    v_lshlrev_b32 v12, 3, v14
    ds_read_b64 v[10:11], v12 offset:38912
    ds_read_b64 v[6:7], v12 offset:39168
    ds_write_b32 v13, v96
    v_lshl_add_u32 v13, v15, 4, s31
    s_waitcnt lgkmcnt(0)
    ds_read_b128 v[104:107], v13 offset:0
    ds_read_b128 v[108:111], v13 offset:32
    ds_read_b128 v[112:115], v13 offset:64
    ds_read_b128 v[116:119], v13 offset:96
    v_mul_f32 v12, 0x3e8293ee, v11
    v_mul_f32 v8, 0x3e8293ee, v7
    s_waitcnt lgkmcnt(0)
    s_barrier
    ds_read_b128 v[144:147], v1
    ds_read_b128 v[148:151], v1 offset:1024
    ds_read_b128 v[164:167], v1 offset:2048
    ds_read_b128 v[172:175], v1 offset:3072
    ds_read_b128 v[152:155], v1 offset:4096
    ds_read_b128 v[156:159], v1 offset:5120
    v_pk_fma_f32 v[64:65], v[104:105], v[10:11], v[64:65] op_sel_hi:[1,0,1]
    v_pk_fma_f32 v[66:67], v[106:107], v[10:11], v[66:67] op_sel_hi:[1,0,1]
    v_pk_fma_f32 v[68:69], v[108:109], v[10:11], v[68:69] op_sel_hi:[1,0,1]
    v_pk_fma_f32 v[70:71], v[110:111], v[10:11], v[70:71] op_sel_hi:[1,0,1]
    v_pk_fma_f32 v[72:73], v[112:113], v[10:11], v[72:73] op_sel_hi:[1,0,1]
    v_pk_fma_f32 v[74:75], v[114:115], v[10:11], v[74:75] op_sel_hi:[1,0,1]
    v_pk_fma_f32 v[76:77], v[116:117], v[10:11], v[76:77] op_sel_hi:[1,0,1]
    v_pk_fma_f32 v[78:79], v[118:119], v[10:11], v[78:79] op_sel_hi:[1,0,1]
    v_pk_mul_f32 v[64:65], v[64:65], v[12:13] op_sel_hi:[1,0]
    v_pk_mul_f32 v[66:67], v[66:67], v[12:13] op_sel_hi:[1,0]
    v_pk_mul_f32 v[68:69], v[68:69], v[12:13] op_sel_hi:[1,0]
    v_pk_mul_f32 v[70:71], v[70:71], v[12:13] op_sel_hi:[1,0]
    v_pk_mul_f32 v[72:73], v[72:73], v[12:13] op_sel_hi:[1,0]
    v_pk_mul_f32 v[74:75], v[74:75], v[12:13] op_sel_hi:[1,0]
    v_pk_mul_f32 v[76:77], v[76:77], v[12:13] op_sel_hi:[1,0]
    v_pk_mul_f32 v[78:79], v[78:79], v[12:13] op_sel_hi:[1,0]
    v_cvt_pk_bf16_f32 v16, v64, v65
    v_cvt_pk_bf16_f32 v17, v66, v67
    v_cvt_pk_bf16_f32 v18, v68, v69
    v_cvt_pk_bf16_f32 v19, v70, v71
    v_cvt_pk_bf16_f32 v20, v72, v73
    v_cvt_pk_bf16_f32 v21, v74, v75
    v_cvt_pk_bf16_f32 v22, v76, v77
    v_cvt_pk_bf16_f32 v23, v78, v79
    s_waitcnt lgkmcnt(4)
    s_nop 0
    v_mfma_f32_32x32x16_bf16 v[64:79], v[144:147], v[16:19], 0
    v_mfma_f32_32x32x16_bf16 v[64:79], v[148:151], v[20:23], v[64:79]
    v_pk_fma_f32 v[80:81], v[104:105], v[6:7], v[80:81] op_sel_hi:[1,0,1]
    v_pk_fma_f32 v[82:83], v[106:107], v[6:7], v[82:83] op_sel_hi:[1,0,1]
    v_pk_fma_f32 v[84:85], v[108:109], v[6:7], v[84:85] op_sel_hi:[1,0,1]
    v_pk_fma_f32 v[86:87], v[110:111], v[6:7], v[86:87] op_sel_hi:[1,0,1]
    v_pk_fma_f32 v[88:89], v[112:113], v[6:7], v[88:89] op_sel_hi:[1,0,1]
    v_pk_fma_f32 v[90:91], v[114:115], v[6:7], v[90:91] op_sel_hi:[1,0,1]
    v_pk_fma_f32 v[92:93], v[116:117], v[6:7], v[92:93] op_sel_hi:[1,0,1]
    v_pk_fma_f32 v[94:95], v[118:119], v[6:7], v[94:95] op_sel_hi:[1,0,1]
    v_pk_mul_f32 v[80:81], v[80:81], v[8:9] op_sel_hi:[1,0]
    v_pk_mul_f32 v[82:83], v[82:83], v[8:9] op_sel_hi:[1,0]
    v_pk_mul_f32 v[84:85], v[84:85], v[8:9] op_sel_hi:[1,0]
    v_pk_mul_f32 v[86:87], v[86:87], v[8:9] op_sel_hi:[1,0]
    v_pk_mul_f32 v[88:89], v[88:89], v[8:9] op_sel_hi:[1,0]
    v_pk_mul_f32 v[90:91], v[90:91], v[8:9] op_sel_hi:[1,0]
    v_pk_mul_f32 v[92:93], v[92:93], v[8:9] op_sel_hi:[1,0]
    v_pk_mul_f32 v[94:95], v[94:95], v[8:9] op_sel_hi:[1,0]
    v_cvt_pk_bf16_f32 v24, v80, v81
    v_cvt_pk_bf16_f32 v25, v82, v83
    v_cvt_pk_bf16_f32 v26, v84, v85
    v_cvt_pk_bf16_f32 v27, v86, v87
    v_cvt_pk_bf16_f32 v28, v88, v89
    v_cvt_pk_bf16_f32 v29, v90, v91
    v_cvt_pk_bf16_f32 v30, v92, v93
    v_cvt_pk_bf16_f32 v31, v94, v95
    s_branch LB_comp
LA_hi:
    s_cmp_ge_u32 s3, 6
    s_cbranch_scc1 LA_67
    s_sub_u32 s31, s3, 4
    s_lshl_b32 s30, s31, 16
    v_bfe_u32 v2, v0, 2, 3
    v_mul_u32_u24 v4, 2048, v2
    v_lshrrev_b32 v2, 5, v0
    v_lshl_add_u32 v4, v2, 6, v4
    v_and_b32 v2, 3, v0
    v_lshl_add_u32 v4, v2, 4, v4
    v_add_u32 v4, s30, v4
    v_add_u32 v5, 15360, v4
    v_add_u32 v6, 30720, v4
    v_add_u32 v7, 46080, v4
    v_lshrrev_b32 v2, 3, v0
    v_mul_u32_u24 v8, 2048, v2
    v_lshrrev_b32 v2, 4, v0
    v_and_b32 v3, 7, v0
    v_xor_b32 v2, v2, v3
    v_lshl_add_u32 v8, v2, 4, v8
    v_xor_b32 v9, 64, v8
    v_add_u32 v9, 15360, v9
    v_add_u32 v10, 30720, v8
    v_xor_b32 v11, 64, v8
    v_add_u32 v11, 46080, v11
    s_lshl_b32 s32, s28, 17
    s_add_u32 s30, s30, s32
    s_lshl_b32 s33, s31, 12
    s_add_u32 s33, s33, 40960
    s_add_u32 s31, s29, 0
    s_and_b32 s31, s31, 7
    s_lshl_b32 s31, s31, 8
    s_mul_i32 s40, s26, 2
    s_mul_i32 s41, s28, 0
    s_add_u32 s40, s40, s41
    s_mul_i32 s41, s29, 0
    s_add_u32 s40, s40, s41
    s_and_b32 s40, s40, 15
    s_mov_b32 s36, 0
    s_mov_b32 s37, 24576
    s_waitcnt lgkmcnt(0)
    s_mov_b32 s12, s64
    s_and_b32 s13, s65, 0xffff
    s_mov_b32 s14, 0x400000
    s_mov_b32 s15, 0x20000
    s_mov_b32 s8, s66
    s_and_b32 s9, s67, 0xffff
    s_mov_b32 s10, 0x200000
    s_mov_b32 s11, 0x20000
LA_ld:
    s_cmp_lt_u32 s36, 4
    s_cbranch_scc1 LA_ld_issue
    s_cmp_eq_u32 s36, 5
    s_cbranch_scc1 LA_ld_issue
    s_cmp_gt_u32 s36, 5
    s_cbranch_scc1 LA_ld_w
    s_waitcnt vmcnt(24)
LA_ld_w:
    s_waitcnt vmcnt(36)
    s_barrier
LA_ld_issue:
    s_add_u32 m0, s37, s33
    s_lshl_b32 s35, s40, 7
    s_add_u32 s35, s35, s30
    buffer_load_dwordx4 v8, s[12:15], s35 offen offset:0 lds
    buffer_load_dwordx4 v9, s[12:15], s35 offen offset:1024 lds
    buffer_load_dwordx4 v10, s[12:15], s35 offen offset:2048 lds
    buffer_load_dwordx4 v11, s[12:15], s35 offen offset:3072 lds
    s_add_u32 m0, m0, 8192
    s_lshl_b32 s35, s40, 17
    s_add_u32 s35, s35, s31
    buffer_load_dwordx4 v4, s[8:11], s35 offen offset:0 lds
    buffer_load_dwordx4 v5, s[8:11], s35 offen offset:1024 lds
    buffer_load_dwordx4 v6, s[8:11], s35 offen offset:2048 lds
    buffer_load_dwordx4 v7, s[8:11], s35 offen offset:3072 lds
    s_add_u32 m0, m0, 8192
    s_add_u32 s35, s35, 128
    s_add_u32 s40, s40, 1
    s_and_b32 s40, s40, 15
    buffer_load_dwordx4 v4, s[8:11], s35 offen offset:0 lds
    buffer_load_dwordx4 v5, s[8:11], s35 offen offset:1024 lds
    buffer_load_dwordx4 v6, s[8:11], s35 offen offset:2048 lds
    buffer_load_dwordx4 v7, s[8:11], s35 offen offset:3072 lds
    s_add_u32 s36, s36, 1
    s_add_u32 s37, s37, 24576
    s_cmp_eq_u32 s37, 122880
    s_cselect_b32 s37, 0, s37
    s_cmp_lg_u32 s36, 2
    s_cbranch_scc1 LA_ld_nb
    s_waitcnt vmcnt(12)
    s_barrier
LA_ld_nb:
    s_cmp_lt_u32 s36, 16
    s_cbranch_scc1 LA_ld
    s_mov_b32 s4, s88
    s_and_b32 s5, s89, 0xffff
    s_mov_b32 s6, 0x10000000
    s_mov_b32 s7, 0x20000
    s_waitcnt vmcnt(36)
    s_barrier
    s_waitcnt vmcnt(24)
    s_barrier
    s_waitcnt vmcnt(12)
    s_barrier
    s_waitcnt vmcnt(0)
    s_barrier
    s_waitcnt vmcnt(0)
    s_barrier
    s_branch LA_getq
LA_67:
    s_waitcnt lgkmcnt(0)
    s_mov_b32 s8, s66
    s_and_b32 s9, s67, 0xffff
    s_mov_b32 s10, 0x200000
    s_mov_b32 s11, 0x20000
    s_lshl_b32 s31, s2, 1
    s_add_u32 s31, s31, s3
    s_sub_u32 s31, s31, 6
    s_lshl_b32 s31, s31, 12
    buffer_load_dwordx4 v[248:251], v1, s[8:11], s31 offen offset:0
    buffer_load_dwordx4 v[248:251], v1, s[8:11], s31 offen offset:1024
    buffer_load_dwordx4 v[248:251], v1, s[8:11], s31 offen offset:2048
    buffer_load_dwordx4 v[248:251], v1, s[8:11], s31 offen offset:3072
    s_mov_b32 s4, s88
    s_and_b32 s5, s89, 0xffff
    s_mov_b32 s6, 0x10000000
    s_mov_b32 s7, 0x20000
    s_mov_b32 s35, 14548992
    buffer_load_dword v11, off, s[4:7], s35 sc1
    s_mov_b32 s34, 0x9e3779b1
    s_cmp_eq_u32 s3, 6
    s_cbranch_scc1 LA_6
    v_mov_b32 v4, -1
    v_mov_b32 v5, -1
    v_mov_b32 v6, -1
    v_mov_b32 v7, -1
    v_mov_b32 v8, 0
    v_lshlrev_b32 v9, 7, v0
    s_lshl_b32 s31, s2, 10
    s_add_u32 s31, s31, 15204352
    buffer_store_dwordx4 v[4:7], v1, s[4:7], s31 offen sc1
    s_lshl_b32 s31, s2, 14
    s_add_u32 s31, s31, 5242880
    s_lshl_b32 s31, s2, 8
    s_add_u32 s31, s31, 14680064
    s_mov_b64 exec, 0xffff
    buffer_store_dwordx4 v[4:7], v1, s[4:7], s31 offen sc1
    s_lshl_b32 s31, s2, 9
    s_add_u32 s31, s31, 15728640
    s_mov_b64 exec, 15
    buffer_store_dword v8, v9, s[4:7], s31 offen sc1
    s_mov_b64 exec, -1
    s_lshl_b32 s31, s2, 13
    s_barrier
    s_waitcnt vmcnt(0)
    v_mul_lo_u32 v11, v11, s34
    v_add_u32 v11, 0x7f4a7c15, v11
    s_barrier
    s_nop 0
    s_mov_b32 s36, 8
Lbar2:
    s_barrier
    s_sub_u32 s36, s36, 1
    s_cmp_lg_u32 s36, 0
    s_cbranch_scc1 Lbar2
    s_mov_b32 s92, 300000
    v_lshlrev_b32 v9, 4, v0
    s_mov_b32 s31, 14483456
    s_add_u32 s32, s31, 1024
    s_add_u32 s33, s31, 2048
    s_add_u32 s34, s31, 3072
    buffer_load_dword v4, v9, s[4:7], s31 offen sc1
    buffer_load_dword v5, v9, s[4:7], s32 offen sc1
    buffer_load_dword v6, v9, s[4:7], s33 offen sc1
    buffer_load_dword v7, v9, s[4:7], s34 offen sc1
    s_barrier
    s_barrier
    s_branch Lkvp3c
Lkvp3:
    buffer_load_dword v4, v9, s[4:7], s31 offen sc1
    buffer_load_dword v5, v9, s[4:7], s32 offen sc1
    buffer_load_dword v6, v9, s[4:7], s33 offen sc1
    buffer_load_dword v7, v9, s[4:7], s34 offen sc1
Lkvp3c:
    s_sub_u32 s92, s92, 1
    s_cbranch_scc1 Lkvx4
    s_waitcnt vmcnt(0)
    v_xor_b32 v4, v4, v11
    v_xor_b32 v5, v5, v11
    v_xor_b32 v6, v6, v11
    v_xor_b32 v7, v7, v11
    v_or_b32 v4, v4, v5
    v_or3_b32 v4, v4, v6, v7
    v_cmp_ne_u32 vcc, 0, v4
    s_nop 0
    s_cmp_lg_u64 vcc, 0
    s_cbranch_scc1 Lkvp3
Lkvx4:
    v_lshlrev_b32 v10, 3, v0
    s_lshl_b32 s31, s28, 9
    s_add_u32 s31, s31, 14417920
    s_cmp_lg_u32 s2, 0
    s_cbranch_scc1 LA_noep
    s_mov_b64 exec, 1
    buffer_store_dword v11, off, s[4:7], s35 sc1
    s_mov_b64 exec, -1
LA_noep:
    buffer_load_dwordx2 v[4:5], v10, s[4:7], s31 offen sc1
    s_mov_b32 m0, 0
    s_mov_b32 s31, 4194304
    s_mov_b32 s36, 4
LA_kv0:
    buffer_load_dwordx4 v1, s[4:7], s31 offen offset:0 sc1 lds
    buffer_load_dwordx4 v1, s[4:7], s31 offen offset:1024 sc1 lds
    buffer_load_dwordx4 v1, s[4:7], s31 offen offset:2048 sc1 lds
    buffer_load_dwordx4 v1, s[4:7], s31 offen offset:3072 sc1 lds
    s_add_u32 m0, m0, 4096
    s_add_u32 s31, s31, 4096
    buffer_load_dwordx4 v1, s[4:7], s31 offen offset:0 sc1 lds
    buffer_load_dwordx4 v1, s[4:7], s31 offen offset:1024 sc1 lds
    buffer_load_dwordx4 v1, s[4:7], s31 offen offset:2048 sc1 lds
    buffer_load_dwordx4 v1, s[4:7], s31 offen offset:3072 sc1 lds
    s_add_u32 m0, m0, 4096
    s_add_u32 s31, s31, 4096
    s_sub_u32 s36, s36, 1
    s_cmp_lg_u32 s36, 0
    s_barrier
    s_cbranch_scc1 LA_kv0
    s_waitcnt vmcnt(32)
    ds_write_b64 v10, v[4:5] offset:38912
    s_waitcnt lgkmcnt(0)
    s_barrier
    s_waitcnt vmcnt(0)
    s_branch LA_getq
LA_6:
    v_and_b32 v13, 15, v0
    v_lshrrev_b32 v12, 4, v0
    v_lshlrev_b32 v4, 3, v13
    v_lshl_add_u32 v4, v12, 14, v4
    s_lshl_b32 s30, s28, 3
    s_add_u32 s30, s30, s29
    s_lshr_b32 s31, s30, 2
    s_lshl_b32 s31, s31, 12
    s_add_u32 s31, s31, 4194304
    s_bfe_u32 s32, s29, 0x10001
    s_lshr_b32 s33, s30, 1
    s_lshl_b32 s33, s33, 7
    s_add_u32 s33, s33, 14417920
    s_barrier
    ds_read_b64 v[16:17], v4 offset:4096
    ds_read_b64 v[18:19], v4 offset:4224
    ds_read_b64 v[20:21], v4 offset:4352
    ds_read_b64 v[22:23], v4 offset:4480
    ds_read_b128 v[64:67], v1 offset:0
    ds_read_b128 v[68:71], v1 offset:1024
    ds_read_b128 v[72:75], v1 offset:2048
    ds_read_b128 v[76:79], v1 offset:3072
    ds_read_b128 v[80:83], v1 offset:16384
    ds_read_b128 v[84:87], v1 offset:17408
    ds_read_b128 v[88:91], v1 offset:18432
    ds_read_b128 v[92:95], v1 offset:19456
    ds_read_b128 v[96:99], v1 offset:32768
    ds_read_b128 v[100:103], v1 offset:33792
    ds_read_b128 v[104:107], v1 offset:34816
    ds_read_b128 v[108:111], v1 offset:35840
    ds_read_b128 v[112:115], v1 offset:49152
    ds_read_b128 v[116:119], v1 offset:50176
    ds_read_b128 v[120:123], v1 offset:51200
    ds_read_b128 v[124:127], v1 offset:52224
    s_waitcnt lgkmcnt(15)
    s_waitcnt lgkmcnt(0)
    v_pk_add_f32 v[16:17], v[16:17], v[18:19]
    v_pk_add_f32 v[20:21], v[20:21], v[22:23]
    v_pk_add_f32 v[16:17], v[16:17], v[20:21]
    v_mov_b32 v18, v16
    v_mov_b32 v19, v17
    s_nop 1
    v_permlane32_swap_b32 v16, v18
    v_permlane32_swap_b32 v17, v19
    s_nop 1
    v_pk_add_f32 v[16:17], v[16:17], v[18:19]
    v_mov_b32 v18, v16
    v_mov_b32 v19, v17
    s_nop 1
    v_permlane16_swap_b32 v16, v18
    v_permlane16_swap_b32 v17, v19
    s_nop 1
    v_pk_add_f32 v[16:17], v[16:17], v[18:19]
    v_pk_add_f32 v[64:65], v[64:65], v[80:81]
    v_pk_add_f32 v[66:67], v[66:67], v[82:83]
    v_pk_add_f32 v[68:69], v[68:69], v[84:85]
    v_pk_add_f32 v[70:71], v[70:71], v[86:87]
    v_pk_add_f32 v[72:73], v[72:73], v[88:89]
    v_pk_add_f32 v[74:75], v[74:75], v[90:91]
    v_pk_add_f32 v[76:77], v[76:77], v[92:93]
    v_pk_add_f32 v[78:79], v[78:79], v[94:95]
    v_pk_add_f32 v[96:97], v[96:97], v[112:113]
    v_pk_add_f32 v[98:99], v[98:99], v[114:115]
    v_pk_add_f32 v[100:101], v[100:101], v[116:117]
    v_pk_add_f32 v[102:103], v[102:103], v[118:119]
    v_pk_add_f32 v[104:105], v[104:105], v[120:121]
    v_pk_add_f32 v[106:107], v[106:107], v[122:123]
    v_pk_add_f32 v[108:109], v[108:109], v[124:125]
    v_pk_add_f32 v[110:111], v[110:111], v[126:127]
    v_pk_add_f32 v[64:65], v[64:65], v[96:97]
    v_pk_add_f32 v[66:67], v[66:67], v[98:99]
    v_pk_add_f32 v[68:69], v[68:69], v[100:101]
    v_pk_add_f32 v[70:71], v[70:71], v[102:103]
    v_pk_add_f32 v[72:73], v[72:73], v[104:105]
    v_pk_add_f32 v[74:75], v[74:75], v[106:107]
    v_pk_add_f32 v[76:77], v[76:77], v[108:109]
    v_pk_add_f32 v[78:79], v[78:79], v[110:111]
    s_barrier
    v_mul_f32 v16, 0x3a800000, v16
    v_mul_f32 v20, v16, v16
    v_mov_b32 v21, 0x3a800000
    v_fma_f32 v17, v17, v21, -v20
    v_max_f32 v17, 0, v17
    v_cvt_pk_bf16_f32 v17, v17, v17
    v_lshlrev_b32 v17, 16, v17
    v_add_f32 v17, 0x3727c5ac, v17
    v_cvt_pk_bf16_f32 v17, v17, v17
    v_lshlrev_b32 v17, 16, v17
    v_sqrt_f32 v17, v17
    v_cvt_pk_bf16_f32 v16, v16, v16
    v_lshlrev_b32 v16, 16, v16
    v_cvt_pk_bf16_f32 v17, v17, v17
    v_lshlrev_b32 v17, 16, v17
    v_rcp_f32 v17, v17
    v_sub_f32 v16, 0, v16
    s_bitcmp1_b32 s29, 0
    s_cbranch_scc1 LA_6v
    v_mov_b32 v18, v17
    v_lshlrev_b32 v5, 3, v13
    s_mov_b64 exec, 0xffff
    buffer_store_dwordx2 v[16:17], v5, s[4:7], s33 offen sc1
    s_mov_b64 exec, -1
    v_lshlrev_b32 v5, 9, v12
    v_lshl_add_u32 v5, v13, 4, v5
    s_lshl_b32 s32, s32, 8
    s_add_u32 s31, s31, s32
    v_pk_fma_f32 v[64:65], v[72:73], v[16:17], v[64:65] op_sel_hi:[1,0,1]
    v_pk_fma_f32 v[66:67], v[74:75], v[16:17], v[66:67] op_sel_hi:[1,0,1]
    v_pk_fma_f32 v[68:69], v[76:77], v[16:17], v[68:69] op_sel_hi:[1,0,1]
    v_pk_fma_f32 v[70:71], v[78:79], v[16:17], v[70:71] op_sel_hi:[1,0,1]
    v_pk_mul_f32 v[64:65], v[64:65], v[18:19] op_sel_hi:[1,0]
    v_pk_mul_f32 v[66:67], v[66:67], v[18:19] op_sel_hi:[1,0]
    v_pk_mul_f32 v[68:69], v[68:69], v[18:19] op_sel_hi:[1,0]
    v_pk_mul_f32 v[70:71], v[70:71], v[18:19] op_sel_hi:[1,0]
    v_cvt_pk_bf16_f32 v64, v64, v65
    v_cvt_pk_bf16_f32 v65, v66, v67
    v_cvt_pk_bf16_f32 v66, v68, v69
    v_cvt_pk_bf16_f32 v67, v70, v71
    buffer_store_dwordx4 v[64:67], v5, s[4:7], s31 offen sc1
    s_branch LA_6d
LA_6v:
    v_lshlrev_b32 v5, 2, v13
    ds_write_b32 v5, v16 offset:8192
    ds_write_b32 v5, v17 offset:8256
    v_lshlrev_b32 v5, 4, v12
    s_waitcnt lgkmcnt(0)
    ds_read_b128 v[20:23], v5 offset:8192
    ds_read_b128 v[24:27], v5 offset:8256
    v_lshrrev_b32 v6, 1, v12
    v_lshlrev_b32 v5, 9, v6
    v_lshl_add_u32 v5, v13, 4, v5
    v_and_b32 v6, 1, v12
    v_lshl_add_u32 v5, v6, 3, v5
    s_lshl_b32 s32, s32, 10
    s_add_u32 s31, s31, s32
    s_waitcnt lgkmcnt(0)
    v_pk_fma_f32 v[64:65], v[72:73], v[20:21], v[64:65]
    v_pk_fma_f32 v[66:67], v[74:75], v[22:23], v[66:67]
    v_pk_fma_f32 v[68:69], v[76:77], v[20:21], v[68:69]
    v_pk_fma_f32 v[70:71], v[78:79], v[22:23], v[70:71]
    v_pk_mul_f32 v[64:65], v[64:65], v[24:25]
    v_pk_mul_f32 v[66:67], v[66:67], v[26:27]
    v_pk_mul_f32 v[68:69], v[68:69], v[24:25]
    v_pk_mul_f32 v[70:71], v[70:71], v[26:27]
    v_cvt_pk_bf16_f32 v64, v64, v65
    v_cvt_pk_bf16_f32 v65, v66, v67
    v_cvt_pk_bf16_f32 v66, v68, v69
    v_cvt_pk_bf16_f32 v67, v70, v71
    buffer_store_dwordx2 v[64:65], v5, s[4:7], s31 offen offset:2048 sc1
    buffer_store_dwordx2 v[66:67], v5, s[4:7], s31 offen offset:2304 sc1
LA_6d:
    s_barrier
    s_barrier
    s_barrier
    s_lshl_b32 s30, s2, 4
    s_add_u32 s30, s30, 14483456
    s_waitcnt vmcnt(0)
    v_mul_lo_u32 v11, v11, s34
    v_add_u32 v11, 0x7f4a7c15, v11
    s_mov_b64 exec, 1
    buffer_store_dword v11, off, s[4:7], s30 sc1
    s_mov_b64 exec, -1
    s_mov_b32 s36, 12
Lbar5:
    s_barrier
    s_sub_u32 s36, s36, 1
    s_cmp_lg_u32 s36, 0
    s_cbranch_scc1 Lbar5
LA_getq:
    s_barrier
    s_sub_u32 s33, s3, 4
    s_lshl_b32 s35, s33, 13
    s_add_u32 m0, s35, 131072
    s_add_u32 s38, s35, 4227072
    buffer_load_dwordx4 v1, s[4:7], s38 offen offset:0 sc1 lds
    buffer_load_dwordx4 v1, s[4:7], s38 offen offset:1024 sc1 lds
    buffer_load_dwordx4 v1, s[4:7], s38 offen offset:2048 sc1 lds
    buffer_load_dwordx4 v1, s[4:7], s38 offen offset:3072 sc1 lds
    s_add_u32 m0, s35, 135168
    s_add_u32 s38, s35, 4231168
    buffer_load_dwordx4 v1, s[4:7], s38 offen offset:0 sc1 lds
    buffer_load_dwordx4 v1, s[4:7], s38 offen offset:1024 sc1 lds
    buffer_load_dwordx4 v1, s[4:7], s38 offen offset:2048 sc1 lds
    buffer_load_dwordx4 v1, s[4:7], s38 offen offset:3072 sc1 lds
    s_and_b32 s26, s2, 7
    s_lshr_b32 s27, s2, 3
    s_lshr_b32 s24, s26, 2
    s_mul_i32 s24, s24, 8
    s_lshr_b32 s25, s27, 2
    s_add_u32 s24, s24, s25
    s_and_b32 s25, s26, 3
    s_lshl_b32 s25, s25, 2
    s_and_b32 s27, s27, 3
    s_add_u32 s25, s25, s27
    s_lshl_b32 s48, s25, 7
    s_and_b32 s26, s2, 7
    s_lshr_b32 s27, s2, 3
    s_lshr_b32 s24, s26, 0
    s_mul_i32 s24, s24, 2
    s_lshr_b32 s25, s27, 4
    s_add_u32 s24, s24, s25
    s_and_b32 s25, s26, 0
    s_lshl_b32 s25, s25, 4
    s_and_b32 s27, s27, 15
    s_add_u32 s25, s25, s27
    s_mov_b32 s8, s76
    s_and_b32 s9, s77, 0xffff
    s_mov_b32 s10, 0x700000
    s_mov_b32 s11, 0x20000
    s_mov_b32 s12, s72
    s_and_b32 s13, s73, 0xffff
    s_mov_b32 s14, 0x200000
    s_mov_b32 s15, 0x20000
    s_mov_b32 s16, s78
    s_and_b32 s17, s79, 0xffff
    s_mov_b32 s18, 0x800000
    s_mov_b32 s19, 0x20000
    s_mov_b32 s20, s82
    s_and_b32 s21, s83, 0xffff
    s_mov_b32 s22, 0x380000
    s_mov_b32 s23, 0x20000
    s_and_b32 s47, s2, 3
    s_lshr_b32 s46, s2, 2
    s_cmp_ge_u32 s2, 224
    s_cselect_b32 s10, 0, s10
    s_lshl_b32 s40, s47, 2
    s_add_u32 s40, s40, s33
    s_mul_i32 s40, s40, 458752
    s_lshl_b32 s41, s46, 7
    s_add_u32 s40, s40, s41
    v_lshrrev_b32 v4, 3, v0
    v_mul_u32_u24 v4, 7168, v4
    v_and_b32 v5, 7, v0
    v_lshl_add_u32 v4, v5, 4, v4
    s_mov_b32 s44, s40
    s_lshl_b32 s40, s33, 17
    v_bfe_u32 v5, v0, 2, 3
    v_mul_u32_u24 v8, 2048, v5
    v_lshrrev_b32 v5, 5, v0
    v_lshl_add_u32 v8, v5, 6, v8
    v_and_b32 v5, 3, v0
    v_lshl_add_u32 v8, v5, 4, v8
    v_add_u32 v8, s40, v8
    v_add_u32 v9, 15360, v8
    v_add_u32 v10, 30720, v8
    v_add_u32 v11, 46080, v8
    s_lshl_b32 s40, s33, 15
    v_bfe_u32 v5, v0, 2, 3
    v_mul_u32_u24 v26, 2048, v5
    v_lshrrev_b32 v5, 5, v0
    v_lshl_add_u32 v26, v5, 6, v26
    v_and_b32 v5, 3, v0
    v_lshl_add_u32 v26, v5, 4, v26
    v_add_u32 v26, s40, v26
    v_add_u32 v27, 15360, v26
    s_lshl_b32 s49, s25, 7
    s_lshl_b32 s45, s33, 8
    s_add_u32 s45, s45, s2
    s_lshl_b32 s45, s45, 13
    v_lshlrev_b32 v3, 7, v0
    v_mov_b32 v12, -1
    v_mov_b32 v13, -1
    v_mov_b32 v14, -1
    v_mov_b32 v15, -1
    s_waitcnt vmcnt(0)
    s_barrier
    s_add_u32 m0, s35, 32768
    s_add_u32 s38, s35, 4259840
    buffer_load_dwordx4 v1, s[4:7], s38 offen offset:0 sc1 lds
    buffer_load_dwordx4 v1, s[4:7], s38 offen offset:1024 sc1 lds
    buffer_load_dwordx4 v1, s[4:7], s38 offen offset:2048 sc1 lds
    buffer_load_dwordx4 v1, s[4:7], s38 offen offset:3072 sc1 lds
    s_add_u32 m0, s35, 36864
    s_add_u32 s38, s35, 4263936
    buffer_load_dwordx4 v1, s[4:7], s38 offen offset:0 sc1 lds
    buffer_load_dwordx4 v1, s[4:7], s38 offen offset:1024 sc1 lds
    buffer_load_dwordx4 v1, s[4:7], s38 offen offset:2048 sc1 lds
    buffer_load_dwordx4 v1, s[4:7], s38 offen offset:3072 sc1 lds
    s_add_u32 m0, s35, 65536
    s_add_u32 s38, s35, 4292608
    buffer_load_dwordx4 v1, s[4:7], s38 offen offset:0 sc1 lds
    buffer_load_dwordx4 v1, s[4:7], s38 offen offset:1024 sc1 lds
    buffer_load_dwordx4 v1, s[4:7], s38 offen offset:2048 sc1 lds
    buffer_load_dwordx4 v1, s[4:7], s38 offen offset:3072 sc1 lds
    s_add_u32 m0, s35, 69632
    s_add_u32 s38, s35, 4296704
    buffer_load_dwordx4 v1, s[4:7], s38 offen offset:0 sc1 lds
    buffer_load_dwordx4 v1, s[4:7], s38 offen offset:1024 sc1 lds
    buffer_load_dwordx4 v1, s[4:7], s38 offen offset:2048 sc1 lds
    buffer_load_dwordx4 v1, s[4:7], s38 offen offset:3072 sc1 lds
    s_add_u32 m0, s35, 98304
    s_add_u32 s38, s35, 4325376
    buffer_load_dwordx4 v1, s[4:7], s38 offen offset:0 sc1 lds
    buffer_load_dwordx4 v1, s[4:7], s38 offen offset:1024 sc1 lds
    buffer_load_dwordx4 v1, s[4:7], s38 offen offset:2048 sc1 lds
    buffer_load_dwordx4 v1, s[4:7], s38 offen offset:3072 sc1 lds
    s_add_u32 m0, s35, 102400
    s_add_u32 s38, s35, 4329472
    buffer_load_dwordx4 v1, s[4:7], s38 offen offset:0 sc1 lds
    buffer_load_dwordx4 v1, s[4:7], s38 offen offset:1024 sc1 lds
    buffer_load_dwordx4 v1, s[4:7], s38 offen offset:2048 sc1 lds
    buffer_load_dwordx4 v1, s[4:7], s38 offen offset:3072 sc1 lds
    s_lshl_b32 s38, s2, 2
    s_add_u32 s38, s38, s33
    s_lshl_b32 s39, s38, 11
    s_mul_i32 s38, s38, 3584
    s_mov_b64 exec, 0xffff
    buffer_load_dword v253, v3, s[12:15], s39 offen
    s_mov_b64 exec, 0xfffffff
    buffer_load_dword v253, v3, s[20:23], s38 offen
    s_mov_b64 exec, -1
    s_waitcnt vmcnt(18)
    s_barrier
    s_add_u32 m0, s35, 0
    s_add_u32 s38, s35, 4358144
    buffer_load_dwordx4 v1, s[4:7], s38 offen offset:0 sc1 lds
    buffer_load_dwordx4 v1, s[4:7], s38 offen offset:1024 sc1 lds
    buffer_load_dwordx4 v1, s[4:7], s38 offen offset:2048 sc1 lds
    buffer_load_dwordx4 v1, s[4:7], s38 offen offset:3072 sc1 lds
    s_add_u32 m0, s35, 4096
    s_add_u32 s38, s35, 4362240
    buffer_load_dwordx4 v1, s[4:7], s38 offen offset:0 sc1 lds
    buffer_load_dwordx4 v1, s[4:7], s38 offen offset:1024 sc1 lds
    buffer_load_dwordx4 v1, s[4:7], s38 offen offset:2048 sc1 lds
    buffer_load_dwordx4 v1, s[4:7], s38 offen offset:3072 sc1 lds
    buffer_load_dwordx4 v[32:35], v4, s[8:11], s44 offen
    s_add_u32 s44, s44, 57344
    buffer_load_dwordx4 v[36:39], v4, s[8:11], s44 offen
    s_add_u32 s44, s44, 57344
    s_mov_b64 exec, 0xff
    buffer_load_dword v253, v3, s[16:19], s45 offen
    s_mov_b64 exec, -1
    s_add_u32 s38, s45, 33554432
    buffer_store_dwordx4 v[12:15], v1, s[4:7], s38 offen sc1
    s_add_u32 s45, s45, 1024
    s_mov_b64 exec, 0xff
    buffer_load_dword v253, v3, s[16:19], s45 offen
    s_mov_b64 exec, -1
    s_add_u32 s38, s45, 33554432
    buffer_store_dwordx4 v[12:15], v1, s[4:7], s38 offen sc1
    s_add_u32 s45, s45, 1024
    s_waitcnt vmcnt(24)
    s_barrier
    s_add_u32 m0, s35, 131072
    s_add_u32 s38, s35, 4423680
    buffer_load_dwordx4 v1, s[4:7], s38 offen offset:0 sc1 lds
    buffer_load_dwordx4 v1, s[4:7], s38 offen offset:1024 sc1 lds
    buffer_load_dwordx4 v1, s[4:7], s38 offen offset:2048 sc1 lds
    buffer_load_dwordx4 v1, s[4:7], s38 offen offset:3072 sc1 lds
    s_add_u32 m0, s35, 135168
    s_add_u32 s38, s35, 4427776
    buffer_load_dwordx4 v1, s[4:7], s38 offen offset:0 sc1 lds
    buffer_load_dwordx4 v1, s[4:7], s38 offen offset:1024 sc1 lds
    buffer_load_dwordx4 v1, s[4:7], s38 offen offset:2048 sc1 lds
    buffer_load_dwordx4 v1, s[4:7], s38 offen offset:3072 sc1 lds
    s_add_u32 s38, s49, 3538944
    buffer_load_dwordx4 v[244:247], v26, s[20:23], s38 offen offset:0
    buffer_load_dwordx4 v[248:251], v27, s[20:23], s38 offen offset:1024
    s_add_u32 s38, s49, 3407872
    buffer_load_dwordx4 v[236:239], v26, s[20:23], s38 offen offset:0
    buffer_load_dwordx4 v[240:243], v27, s[20:23], s38 offen offset:1024
    s_add_u32 s38, s49, 3276800
    buffer_load_dwordx4 v[228:231], v26, s[20:23], s38 offen offset:0
    buffer_load_dwordx4 v[232:235], v27, s[20:23], s38 offen offset:1024
    s_add_u32 s38, s49, 3145728
    buffer_load_dwordx4 v[220:223], v26, s[20:23], s38 offen offset:0
    buffer_load_dwordx4 v[224:227], v27, s[20:23], s38 offen offset:1024
    buffer_load_dwordx4 v[40:43], v4, s[8:11], s44 offen
    s_add_u32 s44, s44, 57344
    buffer_load_dwordx4 v[44:47], v4, s[8:11], s44 offen
    s_add_u32 s44, s44, 57344
    s_mov_b64 exec, 0xff
    buffer_load_dword v253, v3, s[16:19], s45 offen
    s_mov_b64 exec, -1
    s_add_u32 s38, s45, 33554432
    buffer_store_dwordx4 v[12:15], v1, s[4:7], s38 offen sc1
    s_add_u32 s45, s45, 1024
    s_waitcnt vmcnt(36)
    s_barrier
    s_add_u32 m0, s35, 32768
    s_add_u32 s38, s35, 4390912
    buffer_load_dwordx4 v1, s[4:7], s38 offen offset:0 sc1 lds
    buffer_load_dwordx4 v1, s[4:7], s38 offen offset:1024 sc1 lds
    buffer_load_dwordx4 v1, s[4:7], s38 offen offset:2048 sc1 lds
    buffer_load_dwordx4 v1, s[4:7], s38 offen offset:3072 sc1 lds
    s_add_u32 m0, s35, 36864
    s_add_u32 s38, s35, 4395008
    buffer_load_dwordx4 v1, s[4:7], s38 offen offset:0 sc1 lds
    buffer_load_dwordx4 v1, s[4:7], s38 offen offset:1024 sc1 lds
    buffer_load_dwordx4 v1, s[4:7], s38 offen offset:2048 sc1 lds
    buffer_load_dwordx4 v1, s[4:7], s38 offen offset:3072 sc1 lds
    s_add_u32 s38, s49, 3014656
    buffer_load_dwordx4 v[212:215], v26, s[20:23], s38 offen offset:0
    buffer_load_dwordx4 v[216:219], v27, s[20:23], s38 offen offset:1024
    s_add_u32 s38, s49, 2883584
    buffer_load_dwordx4 v[204:207], v26, s[20:23], s38 offen offset:0
    buffer_load_dwordx4 v[208:211], v27, s[20:23], s38 offen offset:1024
    s_add_u32 s38, s49, 2752512
    buffer_load_dwordx4 v[196:199], v26, s[20:23], s38 offen offset:0
    buffer_load_dwordx4 v[200:203], v27, s[20:23], s38 offen offset:1024
    s_add_u32 s38, s49, 2621440
    buffer_load_dwordx4 v[188:191], v26, s[20:23], s38 offen offset:0
    buffer_load_dwordx4 v[192:195], v27, s[20:23], s38 offen offset:1024
    s_add_u32 s38, s49, 2490368
    buffer_load_dwordx4 v[180:183], v26, s[20:23], s38 offen offset:0
    buffer_load_dwordx4 v[184:187], v27, s[20:23], s38 offen offset:1024
    s_waitcnt vmcnt(40)
    buffer_load_dwordx4 v[48:51], v4, s[8:11], s44 offen
    s_add_u32 s44, s44, 57344
    buffer_load_dwordx4 v[52:55], v4, s[8:11], s44 offen
    s_add_u32 s44, s44, 57344
    s_mov_b64 exec, 0xff
    buffer_load_dword v253, v3, s[16:19], s45 offen
    s_mov_b64 exec, -1
    s_add_u32 s38, s45, 33554432
    buffer_store_dwordx4 v[12:15], v1, s[4:7], s38 offen sc1
    s_add_u32 s45, s45, 1024
    s_barrier
    s_add_u32 m0, s35, 65536
    s_add_u32 s38, s48, 1048576
    buffer_load_dwordx4 v8, s[12:15], s38 offen offset:0 lds
    buffer_load_dwordx4 v9, s[12:15], s38 offen offset:1024 lds
    buffer_load_dwordx4 v10, s[12:15], s38 offen offset:2048 lds
    buffer_load_dwordx4 v11, s[12:15], s38 offen offset:3072 lds
    s_add_u32 m0, s35, 69632
    s_add_u32 s38, s48, 1114112
    buffer_load_dwordx4 v8, s[12:15], s38 offen offset:0 lds
    buffer_load_dwordx4 v9, s[12:15], s38 offen offset:1024 lds
    buffer_load_dwordx4 v10, s[12:15], s38 offen offset:2048 lds
    buffer_load_dwordx4 v11, s[12:15], s38 offen offset:3072 lds
    s_add_u32 s38, s49, 2359296
    buffer_load_dwordx4 v[172:175], v26, s[20:23], s38 offen offset:0
    buffer_load_dwordx4 v[176:179], v27, s[20:23], s38 offen offset:1024
    s_waitcnt vmcnt(40)
    s_add_u32 s38, s49, 2228224
    buffer_load_dwordx4 v[164:167], v26, s[20:23], s38 offen offset:0
    buffer_load_dwordx4 v[168:171], v27, s[20:23], s38 offen offset:1024
    s_add_u32 s38, s49, 2097152
    buffer_load_dwordx4 v[156:159], v26, s[20:23], s38 offen offset:0
    buffer_load_dwordx4 v[160:163], v27, s[20:23], s38 offen offset:1024
    s_add_u32 s38, s49, 1966080
    buffer_load_dwordx4 v[148:151], v26, s[20:23], s38 offen offset:0
    buffer_load_dwordx4 v[152:155], v27, s[20:23], s38 offen offset:1024
    s_add_u32 s38, s49, 1835008
    buffer_load_dwordx4 v[140:143], v26, s[20:23], s38 offen offset:0
    buffer_load_dwordx4 v[144:147], v27, s[20:23], s38 offen offset:1024
    buffer_load_dwordx4 v[56:59], v4, s[8:11], s44 offen
    s_add_u32 s44, s44, 57344
    s_mov_b64 exec, 0xff
    buffer_load_dword v253, v3, s[16:19], s45 offen
    s_mov_b64 exec, -1
    s_add_u32 s38, s45, 33554432
    buffer_store_dwordx4 v[12:15], v1, s[4:7], s38 offen sc1
    s_add_u32 s45, s45, 1024
    s_mov_b64 exec, 0xff
    buffer_load_dword v253, v3, s[16:19], s45 offen
    s_mov_b64 exec, -1
    s_add_u32 s38, s45, 33554432
    buffer_store_dwordx4 v[12:15], v1, s[4:7], s38 offen sc1
    s_add_u32 s45, s45, 1024
    s_waitcnt vmcnt(40)
    s_waitcnt vmcnt(37)
    s_barrier
    s_add_u32 m0, s35, 98304
    s_add_u32 s38, s48, 1572864
    buffer_load_dwordx4 v8, s[12:15], s38 offen offset:0 lds
    buffer_load_dwordx4 v9, s[12:15], s38 offen offset:1024 lds
    buffer_load_dwordx4 v10, s[12:15], s38 offen offset:2048 lds
    buffer_load_dwordx4 v11, s[12:15], s38 offen offset:3072 lds
    s_add_u32 m0, s35, 102400
    s_add_u32 s38, s48, 1638400
    buffer_load_dwordx4 v8, s[12:15], s38 offen offset:0 lds
    buffer_load_dwordx4 v9, s[12:15], s38 offen offset:1024 lds
    buffer_load_dwordx4 v10, s[12:15], s38 offen offset:2048 lds
    buffer_load_dwordx4 v11, s[12:15], s38 offen offset:3072 lds
    s_add_u32 s38, s49, 1703936
    buffer_load_dwordx4 v[132:135], v26, s[20:23], s38 offen offset:0
    buffer_load_dwordx4 v[136:139], v27, s[20:23], s38 offen offset:1024
    s_add_u32 s38, s49, 1572864
    buffer_load_dwordx4 v[124:127], v26, s[20:23], s38 offen offset:0
    buffer_load_dwordx4 v[128:131], v27, s[20:23], s38 offen offset:1024
    s_add_u32 s38, s49, 1441792
    buffer_load_dwordx4 v[116:119], v26, s[20:23], s38 offen offset:0
    buffer_load_dwordx4 v[120:123], v27, s[20:23], s38 offen offset:1024
    s_add_u32 s38, s49, 1310720
    buffer_load_dwordx4 v[108:111], v26, s[20:23], s38 offen offset:0
    buffer_load_dwordx4 v[112:115], v27, s[20:23], s38 offen offset:1024
    s_waitcnt vmcnt(40)
    s_add_u32 s38, s49, 1179648
    buffer_load_dwordx4 v[100:103], v26, s[20:23], s38 offen offset:0
    buffer_load_dwordx4 v[104:107], v27, s[20:23], s38 offen offset:1024
    buffer_load_dwordx4 v[60:63], v4, s[8:11], s44 offen
    s_add_u32 s44, s44, 57344
    s_mov_b64 exec, 0xff
    buffer_load_dword v253, v3, s[16:19], s45 offen
    s_mov_b64 exec, -1
    s_add_u32 s38, s45, 33554432
    buffer_store_dwordx4 v[12:15], v1, s[4:7], s38 offen sc1
    s_add_u32 s45, s45, 1024
    s_mov_b64 exec, 0xff
    buffer_load_dword v253, v3, s[16:19], s45 offen
    s_mov_b64 exec, -1
    s_add_u32 s38, s45, 33554432
    buffer_store_dwordx4 v[12:15], v1, s[4:7], s38 offen sc1
    s_add_u32 s45, s45, 1024
    s_barrier
    s_add_u32 m0, s35, 0
    s_add_u32 s38, s48, 0
    buffer_load_dwordx4 v8, s[12:15], s38 offen offset:0 lds
    buffer_load_dwordx4 v9, s[12:15], s38 offen offset:1024 lds
    buffer_load_dwordx4 v10, s[12:15], s38 offen offset:2048 lds
    buffer_load_dwordx4 v11, s[12:15], s38 offen offset:3072 lds
    s_add_u32 m0, s35, 4096
    s_add_u32 s38, s48, 65536
    buffer_load_dwordx4 v8, s[12:15], s38 offen offset:0 lds
    buffer_load_dwordx4 v9, s[12:15], s38 offen offset:1024 lds
    buffer_load_dwordx4 v10, s[12:15], s38 offen offset:2048 lds
    buffer_load_dwordx4 v11, s[12:15], s38 offen offset:3072 lds
    s_waitcnt vmcnt(40)
    s_add_u32 s38, s49, 1048576
    buffer_load_dwordx4 v[92:95], v26, s[20:23], s38 offen offset:0
    buffer_load_dwordx4 v[96:99], v27, s[20:23], s38 offen offset:1024
    s_add_u32 s38, s49, 917504
    buffer_load_dwordx4 v[84:87], v26, s[20:23], s38 offen offset:0
    buffer_load_dwordx4 v[88:91], v27, s[20:23], s38 offen offset:1024
    s_add_u32 s38, s49, 786432
    buffer_load_dwordx4 v[76:79], v26, s[20:23], s38 offen offset:0
    buffer_load_dwordx4 v[80:83], v27, s[20:23], s38 offen offset:1024
    s_waitcnt vmcnt(18)
    s_mul_i32 s40, s46, 37
    s_lshr_b32 s40, s40, 8
    s_mul_i32 s41, s40, 7
    s_add_u32 s41, s41, 3
    s_cmp_lg_u32 s41, s46
    s_cbranch_scc1 LB_nrp
    s_cmp_ge_u32 s2, 224
    s_cbranch_scc1 LB_nrp
    s_lshl_b32 s41, s47, 2
    s_add_u32 s41, s41, s33
    s_lshl_b32 s39, s40, 4
    s_add_u32 s39, s39, s41
    s_lshl_b32 s39, s39, 7
    s_add_u32 s39, s39, 15826944
    s_lshl_b32 s40, s40, 17
    s_lshl_b32 s41, s41, 12
    s_add_u32 s40, s40, s41
    s_add_u32 s40, s40, 0
    v_lshrrev_b32 v5, 3, v0
    v_lshlrev_b32 v5, 6, v5
    v_bfe_u32 v6, v0, 2, 1
    v_lshl_add_u32 v5, v6, 16, v5
    v_and_b32 v6, 3, v0
    v_lshl_add_u32 v5, v6, 4, v5
    buffer_store_dwordx4 v[32:35], v5, s[4:7], s40 offen offset:0 sc1
    buffer_store_dwordx4 v[36:39], v5, s[4:7], s40 offen offset:512 sc1
    buffer_store_dwordx4 v[40:43], v5, s[4:7], s40 offen offset:1024 sc1
    buffer_store_dwordx4 v[44:47], v5, s[4:7], s40 offen offset:1536 sc1
    buffer_store_dwordx4 v[48:51], v5, s[4:7], s40 offen offset:2048 sc1
    buffer_store_dwordx4 v[52:55], v5, s[4:7], s40 offen offset:2560 sc1
    buffer_store_dwordx4 v[56:59], v5, s[4:7], s40 offen offset:3072 sc1
    buffer_store_dwordx4 v[60:63], v5, s[4:7], s40 offen offset:3584 sc1
    v_mov_b32 v2, 1
    s_waitcnt vmcnt(0)
    s_mov_b64 exec, 1
    buffer_store_dword v2, off, s[4:7], s39 sc1
    s_mov_b64 exec, -1
LB_nrp:
    s_barrier
    s_add_u32 m0, s35, 32768
    s_add_u32 s38, s48, 524288
    buffer_load_dwordx4 v8, s[12:15], s38 offen offset:0 lds
    buffer_load_dwordx4 v9, s[12:15], s38 offen offset:1024 lds
    buffer_load_dwordx4 v10, s[12:15], s38 offen offset:2048 lds
    buffer_load_dwordx4 v11, s[12:15], s38 offen offset:3072 lds
    s_add_u32 m0, s35, 36864
    s_add_u32 s38, s48, 589824
    buffer_load_dwordx4 v8, s[12:15], s38 offen offset:0 lds
    buffer_load_dwordx4 v9, s[12:15], s38 offen offset:1024 lds
    buffer_load_dwordx4 v10, s[12:15], s38 offen offset:2048 lds
    buffer_load_dwordx4 v11, s[12:15], s38 offen offset:3072 lds
    s_barrier
    v_mov_b32 v5, 0x3f80
    v_mov_b32 v6, 0x3f800000
    v_mov_b32 v64, 0
    v_mov_b32 v65, 0
    v_mov_b32 v66, 0
    v_mov_b32 v67, 0
    v_mov_b32 v68, 0
    v_mov_b32 v69, 0
    v_mov_b32 v70, 0
    v_mov_b32 v71, 0
    v_dot2c_f32_bf16 v64, v32, v5
    v_dot2c_f32_bf16 v65, v32, v6
    v_dot2c_f32_bf16 v66, v33, v5
    v_dot2c_f32_bf16 v67, v33, v6
    v_dot2c_f32_bf16 v68, v34, v5
    v_dot2c_f32_bf16 v69, v34, v6
    v_dot2c_f32_bf16 v70, v35, v5
    v_dot2c_f32_bf16 v71, v35, v6
    v_dot2c_f32_bf16 v64, v36, v5
    v_dot2c_f32_bf16 v65, v36, v6
    v_dot2c_f32_bf16 v66, v37, v5
    v_dot2c_f32_bf16 v67, v37, v6
    v_dot2c_f32_bf16 v68, v38, v5
    v_dot2c_f32_bf16 v69, v38, v6
    v_dot2c_f32_bf16 v70, v39, v5
    v_dot2c_f32_bf16 v71, v39, v6
    v_dot2c_f32_bf16 v64, v40, v5
    v_dot2c_f32_bf16 v65, v40, v6
    v_dot2c_f32_bf16 v66, v41, v5
    v_dot2c_f32_bf16 v67, v41, v6
    v_dot2c_f32_bf16 v68, v42, v5
    v_dot2c_f32_bf16 v69, v42, v6
    v_dot2c_f32_bf16 v70, v43, v5
    v_dot2c_f32_bf16 v71, v43, v6
    v_dot2c_f32_bf16 v64, v44, v5
    v_dot2c_f32_bf16 v65, v44, v6
    v_dot2c_f32_bf16 v66, v45, v5
    v_dot2c_f32_bf16 v67, v45, v6
    v_dot2c_f32_bf16 v68, v46, v5
    v_dot2c_f32_bf16 v69, v46, v6
    v_dot2c_f32_bf16 v70, v47, v5
    v_dot2c_f32_bf16 v71, v47, v6
    v_dot2c_f32_bf16 v64, v48, v5
    v_dot2c_f32_bf16 v65, v48, v6
    v_dot2c_f32_bf16 v66, v49, v5
    v_dot2c_f32_bf16 v67, v49, v6
    v_dot2c_f32_bf16 v68, v50, v5
    v_dot2c_f32_bf16 v69, v50, v6
    v_dot2c_f32_bf16 v70, v51, v5
    v_dot2c_f32_bf16 v71, v51, v6
    v_dot2c_f32_bf16 v64, v52, v5
    v_dot2c_f32_bf16 v65, v52, v6
    v_dot2c_f32_bf16 v66, v53, v5
    v_dot2c_f32_bf16 v67, v53, v6
    v_dot2c_f32_bf16 v68, v54, v5
    v_dot2c_f32_bf16 v69, v54, v6
    v_dot2c_f32_bf16 v70, v55, v5
    v_dot2c_f32_bf16 v71, v55, v6
    v_dot2c_f32_bf16 v64, v56, v5
    v_dot2c_f32_bf16 v65, v56, v6
    v_dot2c_f32_bf16 v66, v57, v5
    v_dot2c_f32_bf16 v67, v57, v6
    v_dot2c_f32_bf16 v68, v58, v5
    v_dot2c_f32_bf16 v69, v58, v6
    v_dot2c_f32_bf16 v70, v59, v5
    v_dot2c_f32_bf16 v71, v59, v6
    v_dot2c_f32_bf16 v64, v60, v5
    v_dot2c_f32_bf16 v65, v60, v6
    v_dot2c_f32_bf16 v66, v61, v5
    v_dot2c_f32_bf16 v67, v61, v6
    v_dot2c_f32_bf16 v68, v62, v5
    v_dot2c_f32_bf16 v69, v62, v6
    v_dot2c_f32_bf16 v70, v63, v5
    v_dot2c_f32_bf16 v71, v63, v6
    v_and_b32 v5, 7, v0
    v_lshlrev_b32 v4, 5, v5
    v_lshrrev_b32 v5, 4, v0
    v_permlane32_swap_b32 v64, v68
    v_permlane32_swap_b32 v65, v69
    v_permlane32_swap_b32 v66, v70
    v_permlane32_swap_b32 v67, v71
    v_lshl_add_u32 v4, v5, 3, v4
    v_add_f32 v64, v64, v68
    v_add_f32 v65, v65, v69
    v_add_f32 v66, v66, v70
    v_add_f32 v67, v67, v71
    s_lshl_b32 s38, s33, 8
    v_permlane16_swap_b32 v64, v66
    v_permlane16_swap_b32 v65, v67
    s_add_u32 s38, s38, 131072
    v_add_u32 v4, s38, v4
    v_add_f32 v64, v64, v66
    v_add_f32 v65, v65, v67
    s_nop 1
    v_add_f32_dpp v64, v64, v64 row_ror:8 row_mask:0xf bank_mask:0xf
    v_add_f32_dpp v65, v65, v65 row_ror:8 row_mask:0xf bank_mask:0xf
    ds_write_b64 v4, v[64:65]
    s_waitcnt vmcnt(0) lgkmcnt(0)
    s_barrier
    v_lshlrev_b32 v4, 2, v0
    v_add_u32 v5, 131072, v4
    ds_read_b32 v64, v5 offset:0
    ds_read_b32 v65, v5 offset:256
    ds_read_b32 v66, v5 offset:512
    ds_read_b32 v67, v5 offset:768
    s_mul_i32 s40, s47, 14336
    s_lshl_b32 s41, s46, 8
    s_add_u32 s40, s40, s41
    s_lshl_b32 s41, s2, 2
    s_add_u32 s41, s41, s33
    s_lshl_b32 s41, s41, 8
    s_add_u32 s41, s41, 0x10000
    s_cmp_ge_u32 s2, 224
    s_cselect_b32 s40, s41, s40
    s_cmp_lg_u32 s33, 0
    s_cselect_b32 s40, s41, s40
    s_add_u32 s40, s40, 14680064
    s_waitcnt lgkmcnt(0)
    v_add_f32 v64, v64, v65
    v_add_f32 v64, v64, v66
    v_add_f32 v64, v64, v67
    v_min_u32 v2, -2, v64
    buffer_store_dword v2, v4, s[4:7], s40 offen sc1
    s_branch LC_help
LB_comp:
    v_mov_b32 v12, v1
    v_mfma_f32_32x32x16_bf16 v[80:95], v[144:147], v[24:27], 0
    v_mfma_f32_32x32x16_bf16 v[80:95], v[148:151], v[28:31], v[80:95]
    v_add_u32 v13, 131072, v1
    s_mov_b32 s36, 0
    s_mov_b32 s37, 0x410321
    v_max3_f32 v14, v64, v65, v66
    v_max3_f32 v14, v14, v67, v68
    v_max3_f32 v14, v14, v69, v70
    v_max3_f32 v14, v14, v71, v72
    v_max3_f32 v14, v14, v73, v74
    v_max3_f32 v14, v14, v75, v76
    v_max3_f32 v14, v14, v77, v78
    v_max_f32 v14, v14, v79
    v_mov_b32 v15, v14
    s_nop 1
    v_permlane32_swap_b32 v14, v15
    s_nop 1
    v_max_f32 v14, v14, v15
    v_pk_mul_f32 v[32:33], v[14:15], -1.0 op_sel_hi:[0,0]
    v_pk_mul_f32 v[34:35], v[14:15], -1.0 op_sel_hi:[0,0]
    v_pk_mul_f32 v[36:37], v[14:15], -1.0 op_sel_hi:[0,0]
    v_pk_mul_f32 v[38:39], v[14:15], -1.0 op_sel_hi:[0,0]
    v_pk_mul_f32 v[40:41], v[14:15], -1.0 op_sel_hi:[0,0]
    v_pk_mul_f32 v[42:43], v[14:15], -1.0 op_sel_hi:[0,0]
    v_pk_mul_f32 v[44:45], v[14:15], -1.0 op_sel_hi:[0,0]
    v_pk_mul_f32 v[46:47], v[14:15], -1.0 op_sel_hi:[0,0]
    v_max3_f32 v14, v80, v81, v82
    v_max3_f32 v14, v14, v83, v84
    v_max3_f32 v14, v14, v85, v86
    v_max3_f32 v14, v14, v87, v88
    v_max3_f32 v14, v14, v89, v90
    v_max3_f32 v14, v14, v91, v92
    v_max3_f32 v14, v14, v93, v94
    v_max_f32 v14, v14, v95
    v_pk_add_f32 v[64:65], v[64:65], v[32:33]
    v_pk_add_f32 v[66:67], v[66:67], v[34:35]
    v_pk_add_f32 v[68:69], v[68:69], v[36:37]
    v_pk_add_f32 v[70:71], v[70:71], v[38:39]
    v_pk_add_f32 v[72:73], v[72:73], v[40:41]
    v_pk_add_f32 v[74:75], v[74:75], v[42:43]
    v_pk_add_f32 v[76:77], v[76:77], v[44:45]
    v_pk_add_f32 v[78:79], v[78:79], v[46:47]
    v_mov_b32 v15, v14
    s_nop 1
    v_permlane32_swap_b32 v14, v15
    s_nop 1
    v_max_f32 v14, v14, v15
    v_pk_mul_f32 v[48:49], v[14:15], -1.0 op_sel_hi:[0,0]
    v_pk_mul_f32 v[50:51], v[14:15], -1.0 op_sel_hi:[0,0]
    v_pk_mul_f32 v[52:53], v[14:15], -1.0 op_sel_hi:[0,0]
    v_pk_mul_f32 v[54:55], v[14:15], -1.0 op_sel_hi:[0,0]
    v_pk_mul_f32 v[56:57], v[14:15], -1.0 op_sel_hi:[0,0]
    v_pk_mul_f32 v[58:59], v[14:15], -1.0 op_sel_hi:[0,0]
    v_pk_mul_f32 v[60:61], v[14:15], -1.0 op_sel_hi:[0,0]
    v_pk_mul_f32 v[62:63], v[14:15], -1.0 op_sel_hi:[0,0]
    v_pk_mul_f32 v[88:89], v[180:181], v[180:181]
    v_pk_mul_f32 v[90:91], v[180:181], v[180:181]
    v_pk_mul_f32 v[92:93], v[180:181], v[180:181]
    v_pk_mul_f32 v[94:95], v[180:181], v[180:181]
.p2align 4
LB_loop:
    v_exp_f32 v64, v64
    v_exp_f32 v65, v65
    s_waitcnt lgkmcnt(0)
    v_smfmac_f32_32x32x32_bf16 v[196:211], v[176:179], v[88:95], v224
    ds_read_b128 v[176:179], v12 offset:7168
    v_exp_f32 v66, v66
    v_exp_f32 v67, v67
    v_smfmac_f32_16x16x64_bf16 v[216:219], v[220:223], v[88:95], v224
    ds_read_b128 v[168:171], v12 offset:6144
    v_exp_f32 v68, v68
    v_exp_f32 v69, v69
    v_mfma_f32_32x32x16_bf16 v[80:95], v[144:147], v[24:27], v[48:63]
    v_exp_f32 v70, v70
    v_exp_f32 v71, v71
    v_exp_f32 v72, v72
    v_mfma_f32_32x32x16_bf16 v[80:95], v[148:151], v[28:31], v[80:95]
    v_exp_f32 v73, v73
    v_exp_f32 v74, v74
    v_exp_f32 v75, v75
    v_smfmac_f32_32x32x32_bf16 v[180:195], v[164:167], v[64:71], v224
    v_exp_f32 v76, v76
    v_exp_f32 v77, v77
    v_exp_f32 v78, v78
    v_smfmac_f32_16x16x64_bf16 v[212:215], v[220:223], v[64:71], v224
    v_exp_f32 v79, v79
    v_exp_f32 v80, v80
    v_exp_f32 v81, v81
    v_smfmac_f32_32x32x32_bf16 v[180:195], v[172:175], v[72:79], v224
    ds_read_b128 v[144:147], v12 offset:8192
    v_exp_f32 v82, v82
    v_exp_f32 v83, v83
    v_smfmac_f32_16x16x64_bf16 v[212:215], v[220:223], v[72:79], v224
    ds_read_b128 v[148:151], v12 offset:9216
    v_exp_f32 v84, v84
    v_exp_f32 v85, v85
    v_mfma_f32_32x32x16_bf16 v[64:79], v[152:155], v[16:19], v[32:47]
    v_exp_f32 v86, v86
    v_exp_f32 v87, v87
    v_exp_f32 v88, v88
    v_mfma_f32_32x32x16_bf16 v[64:79], v[156:159], v[20:23], v[64:79]
    v_exp_f32 v89, v89
    v_exp_f32 v90, v90
    v_exp_f32 v91, v91
    v_smfmac_f32_32x32x32_bf16 v[196:211], v[164:167], v[80:87], v224
    v_exp_f32 v92, v92
    v_exp_f32 v93, v93
    v_exp_f32 v94, v94
    v_smfmac_f32_16x16x64_bf16 v[216:219], v[220:223], v[80:87], v224
    v_exp_f32 v95, v95
    v_exp_f32 v64, v64
    v_exp_f32 v65, v65
    s_waitcnt lgkmcnt(0)
    v_smfmac_f32_32x32x32_bf16 v[196:211], v[172:175], v[88:95], v224
    ds_read_b128 v[172:175], v12 offset:11264
    v_exp_f32 v66, v66
    v_exp_f32 v67, v67
    v_smfmac_f32_16x16x64_bf16 v[216:219], v[220:223], v[88:95], v224
    ds_read_b128 v[164:167], v12 offset:10240
    v_exp_f32 v68, v68
    v_exp_f32 v69, v69
    v_mfma_f32_32x32x16_bf16 v[80:95], v[152:155], v[24:27], v[48:63]
    v_exp_f32 v70, v70
    v_exp_f32 v71, v71
    v_exp_f32 v72, v72
    v_mfma_f32_32x32x16_bf16 v[80:95], v[156:159], v[28:31], v[80:95]
    v_exp_f32 v73, v73
    v_exp_f32 v74, v74
    v_exp_f32 v75, v75
    v_smfmac_f32_32x32x32_bf16 v[180:195], v[168:171], v[64:71], v224
    v_exp_f32 v76, v76
    v_exp_f32 v77, v77
    v_exp_f32 v78, v78
    v_smfmac_f32_16x16x64_bf16 v[212:215], v[220:223], v[64:71], v224
    v_exp_f32 v79, v79
    v_exp_f32 v80, v80
    v_exp_f32 v81, v81
    v_smfmac_f32_32x32x32_bf16 v[180:195], v[176:179], v[72:79], v224
    ds_read_b128 v[152:155], v12 offset:12288
    v_exp_f32 v82, v82
    v_exp_f32 v83, v83
    v_smfmac_f32_16x16x64_bf16 v[212:215], v[220:223], v[72:79], v224
    ds_read_b128 v[156:159], v12 offset:13312
    v_exp_f32 v84, v84
    v_exp_f32 v85, v85
    v_mfma_f32_32x32x16_bf16 v[64:79], v[144:147], v[16:19], v[32:47]
    v_exp_f32 v86, v86
    v_exp_f32 v87, v87
    v_exp_f32 v88, v88
    v_mfma_f32_32x32x16_bf16 v[64:79], v[148:151], v[20:23], v[64:79]
    v_exp_f32 v89, v89
    v_exp_f32 v90, v90
    v_exp_f32 v91, v91
    v_smfmac_f32_32x32x32_bf16 v[196:211], v[168:171], v[80:87], v224
    v_exp_f32 v92, v92
    v_exp_f32 v93, v93
    v_exp_f32 v94, v94
    v_smfmac_f32_16x16x64_bf16 v[216:219], v[220:223], v[80:87], v224
    v_exp_f32 v95, v95
    v_exp_f32 v64, v64
    v_exp_f32 v65, v65
    s_waitcnt lgkmcnt(0)
    v_smfmac_f32_32x32x32_bf16 v[196:211], v[176:179], v[88:95], v224
    ds_read_b128 v[176:179], v12 offset:15360
    v_exp_f32 v66, v66
    v_exp_f32 v67, v67
    v_smfmac_f32_16x16x64_bf16 v[216:219], v[220:223], v[88:95], v224
    ds_read_b128 v[168:171], v12 offset:14336
    v_exp_f32 v68, v68
    v_exp_f32 v69, v69
    v_mfma_f32_32x32x16_bf16 v[80:95], v[144:147], v[24:27], v[48:63]
    v_exp_f32 v70, v70
    v_exp_f32 v71, v71
    v_exp_f32 v72, v72
    v_mfma_f32_32x32x16_bf16 v[80:95], v[148:151], v[28:31], v[80:95]
    v_exp_f32 v73, v73
    v_exp_f32 v74, v74
    v_exp_f32 v75, v75
    v_smfmac_f32_32x32x32_bf16 v[180:195], v[164:167], v[64:71], v224
    v_exp_f32 v76, v76
    v_exp_f32 v77, v77
    v_exp_f32 v78, v78
    v_smfmac_f32_16x16x64_bf16 v[212:215], v[220:223], v[64:71], v224
    v_exp_f32 v79, v79
    v_exp_f32 v80, v80
    v_exp_f32 v81, v81
    v_smfmac_f32_32x32x32_bf16 v[180:195], v[172:175], v[72:79], v224
    ds_read_b128 v[144:147], v12 offset:16384
    v_exp_f32 v82, v82
    v_exp_f32 v83, v83
    v_smfmac_f32_16x16x64_bf16 v[212:215], v[220:223], v[72:79], v224
    ds_read_b128 v[148:151], v12 offset:17408
    v_exp_f32 v84, v84
    v_exp_f32 v85, v85
    v_mfma_f32_32x32x16_bf16 v[64:79], v[152:155], v[16:19], v[32:47]
    v_exp_f32 v86, v86
    v_exp_f32 v87, v87
    v_exp_f32 v88, v88
    v_mfma_f32_32x32x16_bf16 v[64:79], v[156:159], v[20:23], v[64:79]
    v_exp_f32 v89, v89
    v_exp_f32 v90, v90
    v_exp_f32 v91, v91
    v_smfmac_f32_32x32x32_bf16 v[196:211], v[164:167], v[80:87], v224
    v_exp_f32 v92, v92
    v_exp_f32 v93, v93
    v_exp_f32 v94, v94
    v_smfmac_f32_16x16x64_bf16 v[216:219], v[220:223], v[80:87], v224
    v_exp_f32 v95, v95
    v_exp_f32 v64, v64
    v_exp_f32 v65, v65
    s_waitcnt lgkmcnt(0)
    v_smfmac_f32_32x32x32_bf16 v[196:211], v[172:175], v[88:95], v224
    ds_read_b128 v[172:175], v12 offset:19456
    v_exp_f32 v66, v66
    v_exp_f32 v67, v67
    v_smfmac_f32_16x16x64_bf16 v[216:219], v[220:223], v[88:95], v224
    ds_read_b128 v[164:167], v12 offset:18432
    v_exp_f32 v68, v68
    v_exp_f32 v69, v69
    v_mfma_f32_32x32x16_bf16 v[80:95], v[152:155], v[24:27], v[48:63]
    v_exp_f32 v70, v70
    v_exp_f32 v71, v71
    v_exp_f32 v72, v72
    v_mfma_f32_32x32x16_bf16 v[80:95], v[156:159], v[28:31], v[80:95]
    v_exp_f32 v73, v73
    v_exp_f32 v74, v74
    v_exp_f32 v75, v75
    v_smfmac_f32_32x32x32_bf16 v[180:195], v[168:171], v[64:71], v224
    v_exp_f32 v76, v76
    v_exp_f32 v77, v77
    v_exp_f32 v78, v78
    v_smfmac_f32_16x16x64_bf16 v[212:215], v[220:223], v[64:71], v224
    v_exp_f32 v79, v79
    v_exp_f32 v80, v80
    v_exp_f32 v81, v81
    v_smfmac_f32_32x32x32_bf16 v[180:195], v[176:179], v[72:79], v224
    ds_read_b128 v[152:155], v12 offset:20480
    v_exp_f32 v82, v82
    v_exp_f32 v83, v83
    v_smfmac_f32_16x16x64_bf16 v[212:215], v[220:223], v[72:79], v224
    ds_read_b128 v[156:159], v12 offset:21504
    v_exp_f32 v84, v84
    v_exp_f32 v85, v85
    v_mfma_f32_32x32x16_bf16 v[64:79], v[144:147], v[16:19], v[32:47]
    v_exp_f32 v86, v86
    v_exp_f32 v87, v87
    v_exp_f32 v88, v88
    v_mfma_f32_32x32x16_bf16 v[64:79], v[148:151], v[20:23], v[64:79]
    v_exp_f32 v89, v89
    v_exp_f32 v90, v90
    v_exp_f32 v91, v91
    v_smfmac_f32_32x32x32_bf16 v[196:211], v[168:171], v[80:87], v224
    v_exp_f32 v92, v92
    v_exp_f32 v93, v93
    v_exp_f32 v94, v94
    v_smfmac_f32_16x16x64_bf16 v[216:219], v[220:223], v[80:87], v224
    v_exp_f32 v95, v95
    v_exp_f32 v64, v64
    v_exp_f32 v65, v65
    s_waitcnt lgkmcnt(0)
    v_smfmac_f32_32x32x32_bf16 v[196:211], v[176:179], v[88:95], v224
    ds_read_b128 v[176:179], v12 offset:23552
    v_exp_f32 v66, v66
    v_exp_f32 v67, v67
    v_smfmac_f32_16x16x64_bf16 v[216:219], v[220:223], v[88:95], v224
    ds_read_b128 v[168:171], v12 offset:22528
    v_exp_f32 v68, v68
    v_exp_f32 v69, v69
    v_mfma_f32_32x32x16_bf16 v[80:95], v[144:147], v[24:27], v[48:63]
    v_exp_f32 v70, v70
    v_exp_f32 v71, v71
    v_exp_f32 v72, v72
    v_mfma_f32_32x32x16_bf16 v[80:95], v[148:151], v[28:31], v[80:95]
    v_exp_f32 v73, v73
    v_exp_f32 v74, v74
    v_exp_f32 v75, v75
    v_smfmac_f32_32x32x32_bf16 v[180:195], v[164:167], v[64:71], v224
    v_exp_f32 v76, v76
    v_exp_f32 v77, v77
    v_exp_f32 v78, v78
    v_smfmac_f32_16x16x64_bf16 v[212:215], v[220:223], v[64:71], v224
    v_exp_f32 v79, v79
    v_exp_f32 v80, v80
    v_exp_f32 v81, v81
    v_smfmac_f32_32x32x32_bf16 v[180:195], v[172:175], v[72:79], v224
    ds_read_b128 v[144:147], v12 offset:24576
    v_exp_f32 v82, v82
    v_exp_f32 v83, v83
    v_smfmac_f32_16x16x64_bf16 v[212:215], v[220:223], v[72:79], v224
    ds_read_b128 v[148:151], v12 offset:25600
    v_exp_f32 v84, v84
    v_exp_f32 v85, v85
    v_mfma_f32_32x32x16_bf16 v[64:79], v[152:155], v[16:19], v[32:47]
    v_exp_f32 v86, v86
    v_exp_f32 v87, v87
    v_exp_f32 v88, v88
    v_mfma_f32_32x32x16_bf16 v[64:79], v[156:159], v[20:23], v[64:79]
    v_exp_f32 v89, v89
    v_exp_f32 v90, v90
    v_exp_f32 v91, v91
    v_smfmac_f32_32x32x32_bf16 v[196:211], v[164:167], v[80:87], v224
    v_exp_f32 v92, v92
    v_exp_f32 v93, v93
    v_exp_f32 v94, v94
    v_smfmac_f32_16x16x64_bf16 v[216:219], v[220:223], v[80:87], v224
    v_exp_f32 v95, v95
    v_exp_f32 v64, v64
    v_exp_f32 v65, v65
    s_waitcnt lgkmcnt(0)
    v_smfmac_f32_32x32x32_bf16 v[196:211], v[172:175], v[88:95], v224
    ds_read_b128 v[172:175], v12 offset:27648
    v_exp_f32 v66, v66
    v_exp_f32 v67, v67
    v_smfmac_f32_16x16x64_bf16 v[216:219], v[220:223], v[88:95], v224
    ds_read_b128 v[164:167], v12 offset:26624
    v_exp_f32 v68, v68
    v_exp_f32 v69, v69
    v_mfma_f32_32x32x16_bf16 v[80:95], v[152:155], v[24:27], v[48:63]
    v_exp_f32 v70, v70
    v_exp_f32 v71, v71
    v_exp_f32 v72, v72
    v_mfma_f32_32x32x16_bf16 v[80:95], v[156:159], v[28:31], v[80:95]
    v_exp_f32 v73, v73
    v_exp_f32 v74, v74
    v_exp_f32 v75, v75
    v_smfmac_f32_32x32x32_bf16 v[180:195], v[168:171], v[64:71], v224
    v_exp_f32 v76, v76
    v_exp_f32 v77, v77
    v_exp_f32 v78, v78
    v_smfmac_f32_16x16x64_bf16 v[212:215], v[220:223], v[64:71], v224
    v_exp_f32 v79, v79
    v_exp_f32 v80, v80
    v_exp_f32 v81, v81
    v_smfmac_f32_32x32x32_bf16 v[180:195], v[176:179], v[72:79], v224
    ds_read_b128 v[152:155], v12 offset:28672
    v_exp_f32 v82, v82
    v_exp_f32 v83, v83
    v_smfmac_f32_16x16x64_bf16 v[212:215], v[220:223], v[72:79], v224
    ds_read_b128 v[156:159], v12 offset:29696
    v_exp_f32 v84, v84
    v_exp_f32 v85, v85
    v_mfma_f32_32x32x16_bf16 v[64:79], v[144:147], v[16:19], v[32:47]
    v_exp_f32 v86, v86
    v_exp_f32 v87, v87
    v_exp_f32 v88, v88
    v_mfma_f32_32x32x16_bf16 v[64:79], v[148:151], v[20:23], v[64:79]
    v_exp_f32 v89, v89
    v_exp_f32 v90, v90
    v_exp_f32 v91, v91
    v_smfmac_f32_32x32x32_bf16 v[196:211], v[168:171], v[80:87], v224
    v_exp_f32 v92, v92
    v_exp_f32 v93, v93
    v_exp_f32 v94, v94
    v_smfmac_f32_16x16x64_bf16 v[216:219], v[220:223], v[80:87], v224
    v_exp_f32 v95, v95
    v_exp_f32 v64, v64
    v_exp_f32 v65, v65
    s_waitcnt lgkmcnt(0)
    v_smfmac_f32_32x32x32_bf16 v[196:211], v[176:179], v[88:95], v224
    ds_read_b128 v[176:179], v12 offset:31744
    v_exp_f32 v66, v66
    v_exp_f32 v67, v67
    v_smfmac_f32_16x16x64_bf16 v[216:219], v[220:223], v[88:95], v224
    ds_read_b128 v[168:171], v12 offset:30720
    v_exp_f32 v68, v68
    v_exp_f32 v69, v69
    v_mfma_f32_32x32x16_bf16 v[80:95], v[144:147], v[24:27], v[48:63]
    v_exp_f32 v70, v70
    v_exp_f32 v71, v71
    v_exp_f32 v72, v72
    v_mfma_f32_32x32x16_bf16 v[80:95], v[148:151], v[28:31], v[80:95]
    v_exp_f32 v73, v73
    v_exp_f32 v74, v74
    v_exp_f32 v75, v75
    v_smfmac_f32_32x32x32_bf16 v[180:195], v[164:167], v[64:71], v224
    v_exp_f32 v76, v76
    v_exp_f32 v77, v77
    v_exp_f32 v78, v78
    v_smfmac_f32_16x16x64_bf16 v[212:215], v[220:223], v[64:71], v224
    v_exp_f32 v79, v79
    v_exp_f32 v80, v80
    v_exp_f32 v81, v81
    v_smfmac_f32_32x32x32_bf16 v[180:195], v[172:175], v[72:79], v224
    s_barrier
    ds_read_b128 v[144:147], v13 offset:0
    v_exp_f32 v82, v82
    v_exp_f32 v83, v83
    v_smfmac_f32_16x16x64_bf16 v[212:215], v[220:223], v[72:79], v224
    ds_read_b128 v[148:151], v13 offset:1024
    v_exp_f32 v84, v84
    v_exp_f32 v85, v85
    v_mfma_f32_32x32x16_bf16 v[64:79], v[152:155], v[16:19], v[32:47]
    v_exp_f32 v86, v86
    v_exp_f32 v87, v87
    v_exp_f32 v88, v88
    v_mfma_f32_32x32x16_bf16 v[64:79], v[156:159], v[20:23], v[64:79]
    v_exp_f32 v89, v89
    v_exp_f32 v90, v90
    v_exp_f32 v91, v91
    v_smfmac_f32_32x32x32_bf16 v[196:211], v[164:167], v[80:87], v224
    v_exp_f32 v92, v92
    v_exp_f32 v93, v93
    v_exp_f32 v94, v94
    v_smfmac_f32_16x16x64_bf16 v[216:219], v[220:223], v[80:87], v224
    v_exp_f32 v95, v95
    v_exp_f32 v64, v64
    v_exp_f32 v65, v65
    s_waitcnt lgkmcnt(0)
    v_smfmac_f32_32x32x32_bf16 v[196:211], v[172:175], v[88:95], v224
    ds_read_b128 v[172:175], v13 offset:3072
    v_exp_f32 v66, v66
    v_exp_f32 v67, v67
    v_smfmac_f32_16x16x64_bf16 v[216:219], v[220:223], v[88:95], v224
    ds_read_b128 v[164:167], v13 offset:2048
    v_exp_f32 v68, v68
    v_exp_f32 v69, v69
    v_mfma_f32_32x32x16_bf16 v[80:95], v[152:155], v[24:27], v[48:63]
    v_exp_f32 v70, v70
    v_exp_f32 v71, v71
    v_exp_f32 v72, v72
    v_mfma_f32_32x32x16_bf16 v[80:95], v[156:159], v[28:31], v[80:95]
    v_exp_f32 v73, v73
    v_exp_f32 v74, v74
    v_exp_f32 v75, v75
    v_smfmac_f32_32x32x32_bf16 v[180:195], v[168:171], v[64:71], v224
    v_exp_f32 v76, v76
    v_exp_f32 v77, v77
    v_exp_f32 v78, v78
    v_smfmac_f32_16x16x64_bf16 v[212:215], v[220:223], v[64:71], v224
    v_exp_f32 v79, v79
    v_exp_f32 v80, v80
    v_exp_f32 v81, v81
    v_smfmac_f32_32x32x32_bf16 v[180:195], v[176:179], v[72:79], v224
    ds_read_b128 v[152:155], v13 offset:4096
    v_exp_f32 v82, v82
    v_exp_f32 v83, v83
    v_smfmac_f32_16x16x64_bf16 v[212:215], v[220:223], v[72:79], v224
    ds_read_b128 v[156:159], v13 offset:5120
    v_exp_f32 v84, v84
    v_exp_f32 v85, v85
    v_mfma_f32_32x32x16_bf16 v[64:79], v[144:147], v[16:19], v[32:47]
    v_exp_f32 v86, v86
    v_exp_f32 v87, v87
    v_exp_f32 v88, v88
    v_mfma_f32_32x32x16_bf16 v[64:79], v[148:151], v[20:23], v[64:79]
    v_mov_b32 v12, v13
    s_and_b32 s38, s37, 15
    s_lshl_b32 s38, s38, 15
    s_lshr_b32 s37, s37, 4
    v_exp_f32 v89, v89
    v_exp_f32 v90, v90
    v_exp_f32 v91, v91
    v_smfmac_f32_32x32x32_bf16 v[196:211], v[168:171], v[80:87], v224
    v_add_u32 v13, s38, v1
    s_add_u32 s36, s36, 1
    s_cmp_lg_u32 s36, 8
    v_exp_f32 v92, v92
    v_exp_f32 v93, v93
    v_exp_f32 v94, v94
    v_smfmac_f32_16x16x64_bf16 v[216:219], v[220:223], v[80:87], v224
    v_exp_f32 v95, v95
    s_cbranch_scc1 LB_loop
    s_nop 0
    v_smfmac_f32_16x16x64_bf16 v[216:219], v[220:223], v[88:95], v224
    v_smfmac_f32_32x32x32_bf16 v[196:211], v[176:179], v[88:95], v224
    s_lshl_b32 s30, s28, 6
    s_lshl_b32 s31, s29, 2
    s_add_u32 s30, s30, s31
    s_add_u32 s30, s30, s3
    s_lshl_b32 s40, s30, 11
    s_add_u32 s40, s40, 5242880
    s_mov_b32 s39, 0
    s_mov_b32 s46, 0
LB_fin0:
    v_rcp_f32 v14, v212
    v_mov_b32 v6, 0x53800000
    v_cmp_nlt_f32 s[44:45], v212, v6
    v_pk_mul_f32 v[180:181], v[180:181], v[14:15] op_sel_hi:[1,0]
    v_pk_mul_f32 v[182:183], v[182:183], v[14:15] op_sel_hi:[1,0]
    v_pk_mul_f32 v[184:185], v[184:185], v[14:15] op_sel_hi:[1,0]
    v_pk_mul_f32 v[186:187], v[186:187], v[14:15] op_sel_hi:[1,0]
    v_pk_mul_f32 v[188:189], v[188:189], v[14:15] op_sel_hi:[1,0]
    v_pk_mul_f32 v[190:191], v[190:191], v[14:15] op_sel_hi:[1,0]
    v_pk_mul_f32 v[192:193], v[192:193], v[14:15] op_sel_hi:[1,0]
    v_pk_mul_f32 v[194:195], v[194:195], v[14:15] op_sel_hi:[1,0]
    v_maximum3_f32 v4, |v180|, |v181|, |v182|
    v_maximum3_f32 v5, |v188|, |v189|, |v190|
    v_maximum3_f32 v4, v4, |v183|, |v184|
    v_maximum3_f32 v5, v5, |v191|, |v192|
    v_maximum3_f32 v4, v4, |v185|, |v186|
    v_maximum3_f32 v5, v5, |v193|, |v194|
    v_maximum3_f32 v4, v4, |v187|, |v195|
    v_mov_b32 v6, 0x7f800000
    v_maximum3_f32 v4, v4, v5, v5
    v_cmp_nlt_f32 s[42:43], v4, v6
    v_cvt_pk_bf16_f32 v48, v180, v181
    v_cvt_pk_bf16_f32 v49, v182, v183
    v_cvt_pk_bf16_f32 v50, v184, v185
    v_cvt_pk_bf16_f32 v51, v186, v187
    v_cvt_pk_bf16_f32 v52, v188, v189
    v_cvt_pk_bf16_f32 v53, v190, v191
    v_cvt_pk_bf16_f32 v54, v192, v193
    v_cvt_pk_bf16_f32 v55, v194, v195
    s_or_b64 s[42:43], s[42:43], s[44:45]
    s_cselect_b32 s42, 1, 0
    s_cmp_gt_u32 s42, s39
    s_cbranch_scc1 LB_slow
    buffer_store_dwordx4 v[48:51], v1, s[4:7], s40 offen offset:0 sc1
    buffer_store_dwordx4 v[52:55], v1, s[4:7], s40 offen offset:1024 sc1
    s_mov_b32 s46, 1
    s_mov_b32 s39, 0
    s_add_u32 s40, s40, 0x10000
LB_fin1:
    v_rcp_f32 v14, v216
    v_mov_b32 v6, 0x53800000
    v_cmp_nlt_f32 s[44:45], v216, v6
    v_pk_mul_f32 v[196:197], v[196:197], v[14:15] op_sel_hi:[1,0]
    v_pk_mul_f32 v[198:199], v[198:199], v[14:15] op_sel_hi:[1,0]
    v_pk_mul_f32 v[200:201], v[200:201], v[14:15] op_sel_hi:[1,0]
    v_pk_mul_f32 v[202:203], v[202:203], v[14:15] op_sel_hi:[1,0]
    v_pk_mul_f32 v[204:205], v[204:205], v[14:15] op_sel_hi:[1,0]
    v_pk_mul_f32 v[206:207], v[206:207], v[14:15] op_sel_hi:[1,0]
    v_pk_mul_f32 v[208:209], v[208:209], v[14:15] op_sel_hi:[1,0]
    v_pk_mul_f32 v[210:211], v[210:211], v[14:15] op_sel_hi:[1,0]
    v_maximum3_f32 v4, |v196|, |v197|, |v198|
    v_maximum3_f32 v5, |v204|, |v205|, |v206|
    v_maximum3_f32 v4, v4, |v199|, |v200|
    v_maximum3_f32 v5, v5, |v207|, |v208|
    v_maximum3_f32 v4, v4, |v201|, |v202|
    v_maximum3_f32 v5, v5, |v209|, |v210|
    v_maximum3_f32 v4, v4, |v203|, |v211|
    v_mov_b32 v6, 0x7f800000
    v_maximum3_f32 v4, v4, v5, v5
    v_cmp_nlt_f32 s[42:43], v4, v6
    v_cvt_pk_bf16_f32 v56, v196, v197
    v_cvt_pk_bf16_f32 v57, v198, v199
    v_cvt_pk_bf16_f32 v58, v200, v201
    v_cvt_pk_bf16_f32 v59, v202, v203
    v_cvt_pk_bf16_f32 v60, v204, v205
    v_cvt_pk_bf16_f32 v61, v206, v207
    v_cvt_pk_bf16_f32 v62, v208, v209
    v_cvt_pk_bf16_f32 v63, v210, v211
    s_or_b64 s[42:43], s[42:43], s[44:45]
    s_cselect_b32 s42, 1, 0
    s_cmp_gt_u32 s42, s39
    s_cbranch_scc1 LB_slow
    buffer_store_dwordx4 v[56:59], v1, s[4:7], s40 offen offset:0 sc1
    buffer_store_dwordx4 v[60:63], v1, s[4:7], s40 offen offset:1024 sc1
    s_lshl_b32 s32, s28, 3
    s_add_u32 s32, s32, s29
    s_lshl_b32 s32, s32, 7
    s_add_u32 s93, s32, 15728640
    s_and_b32 s26, s2, 7
    s_lshr_b32 s27, s2, 3
    s_lshr_b32 s24, s26, 2
    s_mul_i32 s24, s24, 8
    s_lshr_b32 s25, s27, 2
    s_add_u32 s24, s24, s25
    s_and_b32 s25, s26, 3
    s_lshl_b32 s25, s25, 2
    s_and_b32 s27, s27, 3
    s_add_u32 s25, s25, s27
    s_lshl_b32 s18, s24, 2
    s_add_u32 s18, s18, s3
    s_lshl_b32 s23, s18, 4
    s_add_u32 s23, s23, s25
    s_lshl_b32 s20, s23, 12
    s_add_u32 s20, s20, 9437184
    v_and_b32 v14, 31, v0
    v_lshrrev_b32 v15, 5, v0
    v_lshlrev_b32 v6, 11, v14
    v_lshl_add_u32 v6, v15, 4, v6
    s_lshl_b32 s21, s18, 16
    s_lshl_b32 s17, s25, 7
    s_add_u32 s21, s21, s17
    v_lshrrev_b32 v4, 5, v0
    v_mul_u32_u24 v4, 1024, v4
    v_bfe_u32 v5, v0, 2, 2
    v_lshl_add_u32 v4, v5, 6, v4
    v_bfe_u32 v5, v0, 4, 1
    v_lshl_add_u32 v4, v5, 5, v4
    v_bfe_u32 v5, v0, 1, 1
    v_lshl_add_u32 v4, v5, 3, v4
    v_and_b32 v5, 1, v0
    v_lshl_add_u32 v4, v5, 4, v4
    s_mov_b32 s8, s64
    s_and_b32 s9, s65, 0xffff
    s_mov_b32 s10, 0x400000
    s_mov_b32 s11, 0x20000
    buffer_load_dwordx4 v[16:19], v6, s[8:11], s21 offen offset:0
    buffer_load_dwordx4 v[20:23], v6, s[8:11], s21 offen offset:32
    buffer_load_dwordx4 v[24:27], v6, s[8:11], s21 offen offset:64
    buffer_load_dwordx4 v[28:31], v6, s[8:11], s21 offen offset:96
    s_lshl_b32 s16, s18, 16
    s_add_u32 s16, s16, 5242880
    s_lshl_b32 s61, s24, 11
    s_add_u32 s61, s61, 15728640
    s_and_b32 s26, s2, 7
    s_lshr_b32 s27, s2, 3
    s_lshr_b32 s28, s26, 2
    s_mul_i32 s28, s28, 8
    s_lshr_b32 s29, s27, 2
    s_add_u32 s28, s28, s29
    s_and_b32 s29, s26, 3
    s_lshl_b32 s29, s29, 2
    s_and_b32 s27, s27, 3
    s_add_u32 s29, s29, s27
    s_lshr_b32 s30, s29, 1
    s_and_b32 s31, s29, 1
    s_and_b32 s32, s30, 1
    s_mul_i32 s33, s30, 7
    s_cmp_eq_u32 s32, 0
    s_cselect_b32 s34, 0, 5
    s_cselect_b32 s35, 4, 1
    s_cselect_b32 s36, 6, -1
    s_cselect_b32 s42, 2, 3
    s_add_u32 s34, s33, s34
    s_add_u32 s35, s33, s35
    s_add_u32 s36, s33, s36
    s_add_u32 s42, s33, s42
    s_add_u32 s47, s33, 3
    s_cmp_eq_u32 s31, 0
    s_cselect_b32 s40, s35, s34
    s_cselect_b32 s41, s34, s35
    s_cselect_b32 s37, 0, 56
    s_cselect_b32 s38, 56, 0
    s_add_u32 s40, s40, 56
    s_add_u32 s42, s42, s37
    s_add_u32 s47, s47, s37
    s_add_u32 s43, s36, s38
    s_add_u32 s33, s43, s32
    s_add_u32 s34, s42, s32
    s_mov_b32 s44, s40
    s_add_u32 s45, s40, 1
    s_cmp_eq_u32 s31, 0
    s_cselect_b32 s46, s33, s34
    s_cselect_b32 s48, s34, s33
    s_mov_b32 s49, s41
    s_add_u32 s50, s41, 1
    s_mov_b32 s51, s41
    s_lshl_b32 s40, s40, 6
    s_lshl_b32 s41, s41, 6
    s_lshl_b32 s42, s42, 6
    s_lshl_b32 s43, s43, 6
    s_and_b32 s52, s3, 3
    s_lshl_b32 s53, s28, 2
    s_add_u32 s52, s52, s53
    v_mov_b32 v2, 1
    v_lshlrev_b32 v3, 7, v0
    s_waitcnt vmcnt(4) lgkmcnt(0)
    s_barrier
    s_cmp_lg_u32 s3, 0
    s_cbranch_scc1 Lho6f
    s_mov_b64 exec, 1
    buffer_store_dword v2, off, s[4:7], s93 sc1
    s_mov_b64 exec, -1
Lho6f:
    s_cmp_lg_u32 s3, 0
    s_cbranch_scc1 Lho6
    s_mov_b64 exec, 0xffff
    s_mov_b32 s92, 300000
Lpoll7:
    buffer_load_dword v2, v3, s[4:7], s61 offen sc1
    s_sub_u32 s92, s92, 1
    s_cbranch_scc1 Lpollx8
    s_waitcnt vmcnt(0)
    v_cmp_ne_u32 vcc, 1, v2
    s_nop 0
    s_cmp_eq_u64 vcc, 0
    s_cbranch_scc1 Lpollx8
    s_branch Lpoll7
Lpollx8:
    s_mov_b64 exec, -1
Lho6:
    s_barrier
    s_mov_b64 s[56:57], s[4:5]
    s_mov_b64 s[58:59], s[6:7]
    s_mov_b32 s61, s16
    s_mov_b32 s92, 300000
    s_mov_b32 s37, 0
    v_mov_b32 v5, v4
    buffer_load_dwordx4 v[96:99], v1, s[56:59], s16 offen offset:0 sc1
    buffer_load_dwordx4 v[100:103], v1, s[56:59], s16 offen offset:1024 sc1
    buffer_load_dwordx4 v[104:107], v1, s[56:59], s16 offen offset:2048 sc1
    buffer_load_dwordx4 v[108:111], v1, s[56:59], s16 offen offset:3072 sc1
    s_add_u32 s16, s16, 4096
    buffer_load_dwordx4 v[112:115], v1, s[56:59], s16 offen offset:0 sc1
    buffer_load_dwordx4 v[116:119], v1, s[56:59], s16 offen offset:1024 sc1
    buffer_load_dwordx4 v[120:123], v1, s[56:59], s16 offen offset:2048 sc1
    buffer_load_dwordx4 v[124:127], v1, s[56:59], s16 offen offset:3072 sc1
    s_add_u32 s16, s16, 4096
    buffer_load_dwordx4 v[128:131], v1, s[56:59], s16 offen offset:0 sc1
    buffer_load_dwordx4 v[132:135], v1, s[56:59], s16 offen offset:1024 sc1
    buffer_load_dwordx4 v[136:139], v1, s[56:59], s16 offen offset:2048 sc1
    buffer_load_dwordx4 v[140:143], v1, s[56:59], s16 offen offset:3072 sc1
    s_add_u32 s16, s16, 4096
    buffer_load_dwordx4 v[144:147], v1, s[56:59], s16 offen offset:0 sc1
    buffer_load_dwordx4 v[148:151], v1, s[56:59], s16 offen offset:1024 sc1
    buffer_load_dwordx4 v[152:155], v1, s[56:59], s16 offen offset:2048 sc1
    buffer_load_dwordx4 v[156:159], v1, s[56:59], s16 offen offset:3072 sc1
    s_add_u32 s16, s16, 4096
    ds_read_b64_tr_b16 v[64:65], v5 offset:0
    ds_read_b64_tr_b16 v[66:67], v5 offset:256
    ds_read_b64_tr_b16 v[68:69], v5 offset:512
    ds_read_b64_tr_b16 v[70:71], v5 offset:768
    ds_read_b64_tr_b16 v[72:73], v5 offset:2048
    ds_read_b64_tr_b16 v[74:75], v5 offset:2304
    ds_read_b64_tr_b16 v[76:77], v5 offset:2560
    ds_read_b64_tr_b16 v[78:79], v5 offset:2816
    ds_read_b64_tr_b16 v[80:81], v5 offset:4096
    ds_read_b64_tr_b16 v[82:83], v5 offset:4352
    ds_read_b64_tr_b16 v[84:85], v5 offset:4608
    ds_read_b64_tr_b16 v[86:87], v5 offset:4864
    s_mov_b32 s60, 0xffff0000
    s_waitcnt vmcnt(16)
    v_lshlrev_b32 v32, 16, v16
    v_and_b32 v33, s60, v16
    v_lshlrev_b32 v34, 16, v17
    v_and_b32 v35, s60, v17
    v_lshlrev_b32 v36, 16, v18
    v_and_b32 v37, s60, v18
    v_lshlrev_b32 v38, 16, v19
    v_and_b32 v39, s60, v19
    v_lshlrev_b32 v40, 16, v20
    v_and_b32 v41, s60, v20
    v_lshlrev_b32 v42, 16, v21
    v_and_b32 v43, s60, v21
    v_lshlrev_b32 v44, 16, v22
    v_and_b32 v45, s60, v22
    v_lshlrev_b32 v46, 16, v23
    v_and_b32 v47, s60, v23
    v_lshlrev_b32 v48, 16, v24
    v_and_b32 v49, s60, v24
    v_lshlrev_b32 v50, 16, v25
    v_and_b32 v51, s60, v25
    v_lshlrev_b32 v52, 16, v26
    v_and_b32 v53, s60, v26
    v_lshlrev_b32 v54, 16, v27
    v_and_b32 v55, s60, v27
    v_lshlrev_b32 v56, 16, v28
    v_and_b32 v57, s60, v28
    v_lshlrev_b32 v58, 16, v29
    v_and_b32 v59, s60, v29
    v_lshlrev_b32 v60, 16, v30
    v_and_b32 v61, s60, v30
    v_lshlrev_b32 v62, 16, v31
    v_and_b32 v63, s60, v31
    s_waitcnt vmcnt(14)
    s_nop 0
    s_mov_b32 s36, 4
.p2align 4
Lrl9:
    s_waitcnt lgkmcnt(10)
    v_mfma_f32_32x32x16_bf16 v[32:47], v[64:67], v[96:99], v[32:47]
    s_cmp_eq_u32 s36, 1
    s_cselect_b32 s58, 0, s58
    s_waitcnt vmcnt(12)
    ds_read_b64_tr_b16 v[88:89], v5 offset:6144
    ds_read_b64_tr_b16 v[90:91], v5 offset:6400
    s_waitcnt lgkmcnt(10)
    v_mfma_f32_32x32x16_bf16 v[48:63], v[68:71], v[96:99], v[48:63]
    buffer_load_dwordx4 v[96:99], v1, s[56:59], s16 offen offset:0 sc1
    ds_read_b64_tr_b16 v[92:93], v5 offset:6656
    ds_read_b64_tr_b16 v[94:95], v5 offset:6912
    s_waitcnt lgkmcnt(10)
    v_mfma_f32_32x32x16_bf16 v[32:47], v[72:75], v[100:103], v[32:47]
    ds_read_b64_tr_b16 v[64:65], v5 offset:8192
    ds_read_b64_tr_b16 v[66:67], v5 offset:8448
    s_waitcnt lgkmcnt(10)
    v_mfma_f32_32x32x16_bf16 v[48:63], v[76:79], v[100:103], v[48:63]
    buffer_load_dwordx4 v[100:103], v1, s[56:59], s16 offen offset:1024 sc1
    ds_read_b64_tr_b16 v[68:69], v5 offset:8704
    ds_read_b64_tr_b16 v[70:71], v5 offset:8960
    s_waitcnt lgkmcnt(10)
    v_mfma_f32_32x32x16_bf16 v[32:47], v[80:83], v[104:107], v[32:47]
    s_waitcnt vmcnt(12)
    ds_read_b64_tr_b16 v[72:73], v5 offset:10240
    ds_read_b64_tr_b16 v[74:75], v5 offset:10496
    s_waitcnt lgkmcnt(10)
    v_mfma_f32_32x32x16_bf16 v[48:63], v[84:87], v[104:107], v[48:63]
    buffer_load_dwordx4 v[104:107], v1, s[56:59], s16 offen offset:2048 sc1
    ds_read_b64_tr_b16 v[76:77], v5 offset:10752
    ds_read_b64_tr_b16 v[78:79], v5 offset:11008
    s_waitcnt lgkmcnt(10)
    v_mfma_f32_32x32x16_bf16 v[32:47], v[88:91], v[108:111], v[32:47]
    ds_read_b64_tr_b16 v[80:81], v5 offset:12288
    ds_read_b64_tr_b16 v[82:83], v5 offset:12544
    s_waitcnt lgkmcnt(10)
    v_mfma_f32_32x32x16_bf16 v[48:63], v[92:95], v[108:111], v[48:63]
    buffer_load_dwordx4 v[108:111], v1, s[56:59], s16 offen offset:3072 sc1
    s_add_u32 s16, s16, 4096
    ds_read_b64_tr_b16 v[84:85], v5 offset:12800
    ds_read_b64_tr_b16 v[86:87], v5 offset:13056
    s_waitcnt lgkmcnt(10)
    v_mfma_f32_32x32x16_bf16 v[32:47], v[64:67], v[112:115], v[32:47]
    s_waitcnt vmcnt(12)
    ds_read_b64_tr_b16 v[88:89], v5 offset:14336
    ds_read_b64_tr_b16 v[90:91], v5 offset:14592
    s_waitcnt lgkmcnt(10)
    v_mfma_f32_32x32x16_bf16 v[48:63], v[68:71], v[112:115], v[48:63]
    buffer_load_dwordx4 v[112:115], v1, s[56:59], s16 offen offset:0 sc1
    ds_read_b64_tr_b16 v[92:93], v5 offset:14848
    ds_read_b64_tr_b16 v[94:95], v5 offset:15104
    s_waitcnt lgkmcnt(10)
    v_mfma_f32_32x32x16_bf16 v[32:47], v[72:75], v[116:119], v[32:47]
    ds_read_b64_tr_b16 v[64:65], v5 offset:16384
    ds_read_b64_tr_b16 v[66:67], v5 offset:16640
    s_waitcnt lgkmcnt(10)
    v_mfma_f32_32x32x16_bf16 v[48:63], v[76:79], v[116:119], v[48:63]
    buffer_load_dwordx4 v[116:119], v1, s[56:59], s16 offen offset:1024 sc1
    ds_read_b64_tr_b16 v[68:69], v5 offset:16896
    ds_read_b64_tr_b16 v[70:71], v5 offset:17152
    s_waitcnt lgkmcnt(10)
    v_mfma_f32_32x32x16_bf16 v[32:47], v[80:83], v[120:123], v[32:47]
    s_waitcnt vmcnt(12)
    ds_read_b64_tr_b16 v[72:73], v5 offset:18432
    ds_read_b64_tr_b16 v[74:75], v5 offset:18688
    s_waitcnt lgkmcnt(10)
    v_mfma_f32_32x32x16_bf16 v[48:63], v[84:87], v[120:123], v[48:63]
    buffer_load_dwordx4 v[120:123], v1, s[56:59], s16 offen offset:2048 sc1
    ds_read_b64_tr_b16 v[76:77], v5 offset:18944
    ds_read_b64_tr_b16 v[78:79], v5 offset:19200
    s_waitcnt lgkmcnt(10)
    v_mfma_f32_32x32x16_bf16 v[32:47], v[88:91], v[124:127], v[32:47]
    ds_read_b64_tr_b16 v[80:81], v5 offset:20480
    ds_read_b64_tr_b16 v[82:83], v5 offset:20736
    s_waitcnt lgkmcnt(10)
    v_mfma_f32_32x32x16_bf16 v[48:63], v[92:95], v[124:127], v[48:63]
    buffer_load_dwordx4 v[124:127], v1, s[56:59], s16 offen offset:3072 sc1
    s_add_u32 s16, s16, 4096
    ds_read_b64_tr_b16 v[84:85], v5 offset:20992
    ds_read_b64_tr_b16 v[86:87], v5 offset:21248
    s_waitcnt lgkmcnt(10)
    v_mfma_f32_32x32x16_bf16 v[32:47], v[64:67], v[128:131], v[32:47]
    s_waitcnt vmcnt(12)
    ds_read_b64_tr_b16 v[88:89], v5 offset:22528
    ds_read_b64_tr_b16 v[90:91], v5 offset:22784
    s_waitcnt lgkmcnt(10)
    v_mfma_f32_32x32x16_bf16 v[48:63], v[68:71], v[128:131], v[48:63]
    buffer_load_dwordx4 v[128:131], v1, s[56:59], s16 offen offset:0 sc1
    ds_read_b64_tr_b16 v[92:93], v5 offset:23040
    ds_read_b64_tr_b16 v[94:95], v5 offset:23296
    s_waitcnt lgkmcnt(10)
    v_mfma_f32_32x32x16_bf16 v[32:47], v[72:75], v[132:135], v[32:47]
    ds_read_b64_tr_b16 v[64:65], v5 offset:24576
    ds_read_b64_tr_b16 v[66:67], v5 offset:24832
    s_waitcnt lgkmcnt(10)
    v_mfma_f32_32x32x16_bf16 v[48:63], v[76:79], v[132:135], v[48:63]
    buffer_load_dwordx4 v[132:135], v1, s[56:59], s16 offen offset:1024 sc1
    ds_read_b64_tr_b16 v[68:69], v5 offset:25088
    ds_read_b64_tr_b16 v[70:71], v5 offset:25344
    s_waitcnt lgkmcnt(10)
    v_mfma_f32_32x32x16_bf16 v[32:47], v[80:83], v[136:139], v[32:47]
    s_waitcnt vmcnt(12)
    ds_read_b64_tr_b16 v[72:73], v5 offset:26624
    ds_read_b64_tr_b16 v[74:75], v5 offset:26880
    s_waitcnt lgkmcnt(10)
    v_mfma_f32_32x32x16_bf16 v[48:63], v[84:87], v[136:139], v[48:63]
    buffer_load_dwordx4 v[136:139], v1, s[56:59], s16 offen offset:2048 sc1
    ds_read_b64_tr_b16 v[76:77], v5 offset:27136
    ds_read_b64_tr_b16 v[78:79], v5 offset:27392
    s_waitcnt lgkmcnt(10)
    v_mfma_f32_32x32x16_bf16 v[32:47], v[88:91], v[140:143], v[32:47]
    ds_read_b64_tr_b16 v[80:81], v5 offset:28672
    ds_read_b64_tr_b16 v[82:83], v5 offset:28928
    s_waitcnt lgkmcnt(10)
    v_mfma_f32_32x32x16_bf16 v[48:63], v[92:95], v[140:143], v[48:63]
    buffer_load_dwordx4 v[140:143], v1, s[56:59], s16 offen offset:3072 sc1
    s_add_u32 s16, s16, 4096
    ds_read_b64_tr_b16 v[84:85], v5 offset:29184
    ds_read_b64_tr_b16 v[86:87], v5 offset:29440
    s_waitcnt lgkmcnt(10)
    v_mfma_f32_32x32x16_bf16 v[32:47], v[64:67], v[144:147], v[32:47]
    s_waitcnt vmcnt(12)
    ds_read_b64_tr_b16 v[88:89], v5 offset:30720
    ds_read_b64_tr_b16 v[90:91], v5 offset:30976
    s_waitcnt lgkmcnt(10)
    v_mfma_f32_32x32x16_bf16 v[48:63], v[68:71], v[144:147], v[48:63]
    buffer_load_dwordx4 v[144:147], v1, s[56:59], s16 offen offset:0 sc1
    ds_read_b64_tr_b16 v[92:93], v5 offset:31232
    ds_read_b64_tr_b16 v[94:95], v5 offset:31488
    s_waitcnt lgkmcnt(10)
    v_mfma_f32_32x32x16_bf16 v[32:47], v[72:75], v[148:151], v[32:47]
    s_add_u32 s37, s37, 32768
    s_cmp_eq_u32 s37, 131072
    s_cselect_b32 s37, 0, s37
    v_add_u32 v5, s37, v4
    ds_read_b64_tr_b16 v[64:65], v5 offset:0
    ds_read_b64_tr_b16 v[66:67], v5 offset:256
    s_waitcnt lgkmcnt(10)
    v_mfma_f32_32x32x16_bf16 v[48:63], v[76:79], v[148:151], v[48:63]
    buffer_load_dwordx4 v[148:151], v1, s[56:59], s16 offen offset:1024 sc1
    ds_read_b64_tr_b16 v[68:69], v5 offset:512
    ds_read_b64_tr_b16 v[70:71], v5 offset:768
    s_waitcnt lgkmcnt(10)
    v_mfma_f32_32x32x16_bf16 v[32:47], v[80:83], v[152:155], v[32:47]
    s_waitcnt vmcnt(12)
    ds_read_b64_tr_b16 v[72:73], v5 offset:2048
    ds_read_b64_tr_b16 v[74:75], v5 offset:2304
    s_waitcnt lgkmcnt(10)
    v_mfma_f32_32x32x16_bf16 v[48:63], v[84:87], v[152:155], v[48:63]
    buffer_load_dwordx4 v[152:155], v1, s[56:59], s16 offen offset:2048 sc1
    ds_read_b64_tr_b16 v[76:77], v5 offset:2560
    ds_read_b64_tr_b16 v[78:79], v5 offset:2816
    s_waitcnt lgkmcnt(10)
    v_mfma_f32_32x32x16_bf16 v[32:47], v[88:91], v[156:159], v[32:47]
    ds_read_b64_tr_b16 v[80:81], v5 offset:4096
    ds_read_b64_tr_b16 v[82:83], v5 offset:4352
    s_waitcnt lgkmcnt(10)
    v_mfma_f32_32x32x16_bf16 v[48:63], v[92:95], v[156:159], v[48:63]
    buffer_load_dwordx4 v[156:159], v1, s[56:59], s16 offen offset:3072 sc1
    s_add_u32 s16, s16, 4096
    s_add_u32 s61, s61, 16384
    s_sub_u32 s36, s36, 1
    s_cmp_lg_u32 s36, 0
    ds_read_b64_tr_b16 v[84:85], v5 offset:4608
    ds_read_b64_tr_b16 v[86:87], v5 offset:4864
    s_cbranch_scc1 Lrl9
    s_waitcnt lgkmcnt(0)
    s_barrier
    s_nop 7
    v_cvt_pk_bf16_f32 v16, v32, v33
    v_cvt_pk_bf16_f32 v17, v34, v35
    v_cvt_pk_bf16_f32 v18, v36, v37
    v_cvt_pk_bf16_f32 v19, v38, v39
    buffer_store_dwordx4 v[16:19], v1, s[4:7], s20 offen offset:0 sc1
    v_cvt_pk_bf16_f32 v20, v40, v41
    v_cvt_pk_bf16_f32 v21, v42, v43
    v_cvt_pk_bf16_f32 v22, v44, v45
    v_cvt_pk_bf16_f32 v23, v46, v47
    buffer_store_dwordx4 v[20:23], v1, s[4:7], s20 offen offset:1024 sc1
    v_cvt_pk_bf16_f32 v24, v48, v49
    v_cvt_pk_bf16_f32 v25, v50, v51
    v_cvt_pk_bf16_f32 v26, v52, v53
    v_cvt_pk_bf16_f32 v27, v54, v55
    buffer_store_dwordx4 v[24:27], v1, s[4:7], s20 offen offset:2048 sc1
    v_cvt_pk_bf16_f32 v28, v56, v57
    v_cvt_pk_bf16_f32 v29, v58, v59
    v_cvt_pk_bf16_f32 v30, v60, v61
    v_cvt_pk_bf16_f32 v31, v62, v63
    buffer_store_dwordx4 v[28:31], v1, s[4:7], s20 offen offset:3072 sc1
    v_mov_b32 v10, 0x3f803f80
    v_mov_b32 v64, 0
    v_mov_b32 v65, 0
    v_mov_b32 v66, 0
    v_mov_b32 v67, 0
    v_dot2c_f32_bf16 v64, v16, v10
    v_dot2c_f32_bf16 v65, v16, v16
    v_dot2c_f32_bf16 v66, v17, v10
    v_dot2c_f32_bf16 v67, v17, v17
    v_dot2c_f32_bf16 v64, v18, v10
    v_dot2c_f32_bf16 v65, v18, v18
    v_dot2c_f32_bf16 v66, v19, v10
    v_dot2c_f32_bf16 v67, v19, v19
    v_dot2c_f32_bf16 v64, v20, v10
    v_dot2c_f32_bf16 v65, v20, v20
    v_dot2c_f32_bf16 v66, v21, v10
    v_dot2c_f32_bf16 v67, v21, v21
    v_dot2c_f32_bf16 v64, v22, v10
    v_dot2c_f32_bf16 v65, v22, v22
    v_dot2c_f32_bf16 v66, v23, v10
    v_dot2c_f32_bf16 v67, v23, v23
    v_dot2c_f32_bf16 v64, v24, v10
    v_dot2c_f32_bf16 v65, v24, v24
    v_dot2c_f32_bf16 v66, v25, v10
    v_dot2c_f32_bf16 v67, v25, v25
    v_dot2c_f32_bf16 v64, v26, v10
    v_dot2c_f32_bf16 v65, v26, v26
    v_dot2c_f32_bf16 v66, v27, v10
    v_dot2c_f32_bf16 v67, v27, v27
    v_dot2c_f32_bf16 v64, v28, v10
    v_dot2c_f32_bf16 v65, v28, v28
    v_dot2c_f32_bf16 v66, v29, v10
    v_dot2c_f32_bf16 v67, v29, v29
    v_dot2c_f32_bf16 v64, v30, v10
    v_dot2c_f32_bf16 v65, v30, v30
    v_dot2c_f32_bf16 v66, v31, v10
    v_dot2c_f32_bf16 v67, v31, v31
    v_lshlrev_b32 v11, 3, v14
    v_lshl_add_u32 v11, v15, 2, v11
    s_lshl_b32 s17, s23, 8
    v_pk_add_f32 v[8:9], v[64:65], v[66:67]
    s_add_u32 s17, s17, 13631488
    s_lshl_b32 s39, s24, 4
    v_permlane32_swap_b32 v8, v9
    s_add_u32 s39, s39, s25
    s_lshl_b32 s39, s39, 7
    v_add_f32 v8, v8, v9
    buffer_store_dword v8, v11, s[4:7], s17 offen sc1
    s_add_u32 s39, s39, 15761408
    s_lshl_b32 s61, s28, 11
    s_add_u32 s61, s61, 15761408
    s_lshl_b32 s17, s3, 11
    v_add_u32 v7, s17, v1
    ds_write_b128 v7, v[16:19] offset:16896
    ds_write_b128 v7, v[20:23] offset:17920
    ds_write_b128 v7, v[24:27] offset:41984
    ds_write_b128 v7, v[28:31] offset:43008
    s_waitcnt lgkmcnt(0)
    s_branch LD_comp
LC_help:
    s_mov_b32 s60, s49
    s_and_b32 s26, s2, 7
    s_lshr_b32 s27, s2, 3
    s_lshr_b32 s28, s26, 2
    s_mul_i32 s28, s28, 8
    s_lshr_b32 s29, s27, 2
    s_add_u32 s28, s28, s29
    s_and_b32 s29, s26, 3
    s_lshl_b32 s29, s29, 2
    s_and_b32 s27, s27, 3
    s_add_u32 s29, s29, s27
    s_lshr_b32 s30, s29, 1
    s_and_b32 s31, s29, 1
    s_and_b32 s32, s30, 1
    s_mul_i32 s33, s30, 7
    s_cmp_eq_u32 s32, 0
    s_cselect_b32 s34, 0, 5
    s_cselect_b32 s35, 4, 1
    s_cselect_b32 s36, 6, -1
    s_cselect_b32 s42, 2, 3
    s_add_u32 s34, s33, s34
    s_add_u32 s35, s33, s35
    s_add_u32 s36, s33, s36
    s_add_u32 s42, s33, s42
    s_add_u32 s47, s33, 3
    s_cmp_eq_u32 s31, 0
    s_cselect_b32 s40, s35, s34
    s_cselect_b32 s41, s34, s35
    s_cselect_b32 s37, 0, 56
    s_cselect_b32 s38, 56, 0
    s_add_u32 s40, s40, 56
    s_add_u32 s42, s42, s37
    s_add_u32 s47, s47, s37
    s_add_u32 s43, s36, s38
    s_add_u32 s33, s43, s32
    s_add_u32 s34, s42, s32
    s_mov_b32 s44, s40
    s_add_u32 s45, s40, 1
    s_cmp_eq_u32 s31, 0
    s_cselect_b32 s46, s33, s34
    s_cselect_b32 s48, s34, s33
    s_mov_b32 s49, s41
    s_add_u32 s50, s41, 1
    s_mov_b32 s51, s41
    s_lshl_b32 s40, s40, 6
    s_lshl_b32 s41, s41, 6
    s_lshl_b32 s42, s42, 6
    s_lshl_b32 s43, s43, 6
    s_and_b32 s52, s3, 3
    s_lshl_b32 s53, s28, 2
    s_add_u32 s52, s52, s53
    s_mov_b32 s8, s76
    s_and_b32 s9, s77, 0xffff
    s_mov_b32 s10, 0x700000
    s_mov_b32 s11, 0x20000
    s_and_b32 s33, s3, 3
    s_mul_i32 s54, s33, 1056
    s_add_u32 s55, s54, 4224
    s_add_u32 s56, s54, 8448
    s_add_u32 s57, s54, 12672
    s_cmp_eq_u32 s32, 0
    s_cselect_b32 s62, -1, 0
    s_cselect_b32 s63, 0, -1
    s_lshl_b32 s16, s29, 1
    s_add_u32 s17, s16, 2
    s_and_b32 s17, s17, 31
    s_mul_i32 s34, s33, 57344
    v_bfe_u32 v13, v0, 2, 3
    v_mul_u32_u24 v12, 7168, v13
    v_lshrrev_b32 v13, 5, v0
    v_lshl_add_u32 v12, v13, 6, v12
    v_and_b32 v13, 3, v0
    v_lshl_add_u32 v12, v13, 4, v12
    v_add_u32 v12, s34, v12
    v_and_b32 v14, 31, v0
    s_lshl_b32 s53, s33, 11
    s_add_u32 s53, s53, 16896
    s_lshl_b32 s38, s52, 16
    s_add_u32 s38, s38, 9437184
    s_mov_b32 s34, s44
    s_mov_b32 s35, s45
    s_cmp_eq_u32 s33, 1
    s_cselect_b32 s34, s46, s34
    s_cselect_b32 s35, s47, s35
    s_cmp_eq_u32 s33, 2
    s_cselect_b32 s34, s48, s34
    s_cselect_b32 s35, s49, s35
    s_cmp_eq_u32 s33, 3
    s_cselect_b32 s34, s50, s34
    s_cselect_b32 s35, s51, s35
    v_cmp_gt_u32 vcc, 32, v0
    v_mov_b32 v8, s35
    v_mov_b32 v9, s34
    v_cndmask_b32 v9, v8, v9, vcc
    v_lshlrev_b32 v8, 7, v9
    v_lshl_add_u32 v8, v14, 2, v8
    s_nop 0
    s_lshr_b32 s43, s43, 7
    s_mul_i32 s43, s43, 37
    s_lshr_b32 s43, s43, 8
    s_lshl_b32 s61, s43, 11
    s_add_u32 s61, s61, 15826944
    s_lshl_b32 s43, s43, 1
    s_add_u32 s43, s43, s32
    s_lshl_b32 s43, s43, 16
    s_add_u32 s43, s43, 0
    s_lshl_b32 s19, s33, 9
    v_lshl_add_u32 v11, v14, 4, s19
    v_lshlrev_b32 v3, 7, v0
    s_mov_b64 exec, 0xffff
    s_mov_b32 s92, 300000
Lpoll10:
    buffer_load_dword v2, v3, s[4:7], s61 offen sc1
    s_sub_u32 s92, s92, 1
    s_cbranch_scc1 Lpollx11
    s_waitcnt vmcnt(0)
    v_cmp_ne_u32 vcc, 1, v2
    s_nop 0
    s_cmp_eq_u64 vcc, 0
    s_cbranch_scc1 Lpollx11
    s_branch Lpoll10
Lpollx11:
    s_mov_b64 exec, -1
    s_mov_b32 s49, s60
    s_barrier
    s_mul_i32 s18, s16, 229376
    s_add_u32 m0, 0x0, s54
    s_add_u32 s19, s18, s40
    buffer_load_dwordx4 v12, s[8:11], s19 offen  lds
    s_add_u32 m0, 0x0, s55
    s_add_u32 s19, s18, s41
    buffer_load_dwordx4 v12, s[8:11], s19 offen  lds
    s_add_u32 m0, 0x0, s56
    s_add_u32 s19, s18, s42
    buffer_load_dwordx4 v12, s[8:11], s19 offen  lds
    s_lshl_b32 s18, s16, 11
    s_add_u32 m0, 0x0, s57
    s_add_u32 s19, s18, s43
    s_mov_b64 exec, s[62:63]
    buffer_load_dwordx4 v11, s[4:7], s19 offen sc1 lds
    s_mov_b64 exec, -1
    s_add_u32 s16, s16, 1
    s_and_b32 s16, s16, 31
    s_mul_i32 s18, s16, 229376
    s_add_u32 m0, 0x6200, s54
    s_add_u32 s19, s18, s40
    buffer_load_dwordx4 v12, s[8:11], s19 offen  lds
    s_add_u32 m0, 0x6200, s55
    s_add_u32 s19, s18, s41
    buffer_load_dwordx4 v12, s[8:11], s19 offen  lds
    s_add_u32 m0, 0x6200, s56
    s_add_u32 s19, s18, s42
    buffer_load_dwordx4 v12, s[8:11], s19 offen  lds
    s_lshl_b32 s18, s16, 11
    s_add_u32 m0, 0x6200, s57
    s_add_u32 s19, s18, s43
    s_mov_b64 exec, s[62:63]
    buffer_load_dwordx4 v11, s[4:7], s19 offen sc1 lds
    s_mov_b64 exec, -1
    s_add_u32 s16, s16, 1
    s_and_b32 s16, s16, 31
    s_mul_i32 s18, s16, 229376
    s_add_u32 m0, 0xc400, s54
    s_add_u32 s19, s18, s40
    buffer_load_dwordx4 v12, s[8:11], s19 offen  lds
    s_add_u32 m0, 0xc400, s55
    s_add_u32 s19, s18, s41
    buffer_load_dwordx4 v12, s[8:11], s19 offen  lds
    s_add_u32 m0, 0xc400, s56
    s_add_u32 s19, s18, s42
    buffer_load_dwordx4 v12, s[8:11], s19 offen  lds
    s_lshl_b32 s18, s16, 11
    s_add_u32 m0, 0xc400, s57
    s_add_u32 s19, s18, s43
    s_mov_b64 exec, s[62:63]
    buffer_load_dwordx4 v11, s[4:7], s19 offen sc1 lds
    s_mov_b64 exec, -1
    s_add_u32 s16, s16, 1
    s_and_b32 s16, s16, 31
    s_mul_i32 s18, s16, 229376
    s_add_u32 m0, 0x12600, s54
    s_add_u32 s19, s18, s40
    buffer_load_dwordx4 v12, s[8:11], s19 offen  lds
    s_add_u32 m0, 0x12600, s55
    s_add_u32 s19, s18, s41
    buffer_load_dwordx4 v12, s[8:11], s19 offen  lds
    s_add_u32 m0, 0x12600, s56
    s_add_u32 s19, s18, s42
    buffer_load_dwordx4 v12, s[8:11], s19 offen  lds
    s_lshl_b32 s18, s16, 11
    s_add_u32 m0, 0x12600, s57
    s_add_u32 s19, s18, s43
    s_mov_b64 exec, s[62:63]
    buffer_load_dwordx4 v11, s[4:7], s19 offen sc1 lds
    s_mov_b64 exec, -1
    s_add_u32 s16, s16, 1
    s_and_b32 s16, s16, 31
    v_lshlrev_b32 v10, 3, v0
    v_lshlrev_b32 v3, 7, v0
    v_mov_b32 v2, 1
    s_lshl_b32 s34, s52, 12
    s_add_u32 s34, s34, 13631488
    s_lshl_b32 s61, s28, 11
    s_add_u32 s61, s61, 15761408
    s_lshl_b32 s39, s29, 7
    s_add_u32 s39, s39, s61
    s_waitcnt vmcnt(8)
    s_barrier
    s_cmp_lg_u32 s3, 4
    s_cbranch_scc1 LD_nf
    s_mov_b64 exec, 1
    buffer_store_dword v2, off, s[4:7], s39 sc1
    s_mov_b64 exec, -1
LD_nf:
    s_barrier
    s_mov_b64 exec, 0xffff
    s_sub_u32 s92, s39, s61
    v_cmp_ne_u32 vcc, s92, v3
    s_nop 0
    s_mov_b64 exec, vcc
    s_mov_b32 s92, 300000
Lpoll12:
    buffer_load_dword v2, v3, s[4:7], s61 offen sc1
    s_sub_u32 s92, s92, 1
    s_cbranch_scc1 Lpollx13
    s_waitcnt vmcnt(0)
    v_cmp_ne_u32 vcc, 1, v2
    s_nop 0
    s_cmp_eq_u64 vcc, 0
    s_cbranch_scc1 Lpollx13
    s_branch Lpoll12
Lpollx13:
    s_mov_b64 exec, -1
    s_add_u32 m0, 0xc400, s53
    s_lshl_b32 s19, s17, 11
    s_add_u32 s19, s19, s38
    buffer_load_dwordx4 v1, s[4:7], s19 offen offset:0 sc1 lds
    buffer_load_dwordx4 v1, s[4:7], s19 offen offset:1024 sc1 lds
    s_add_u32 s17, s17, 1
    s_and_b32 s17, s17, 31
    s_add_u32 m0, 0x12600, s53
    s_lshl_b32 s19, s17, 11
    s_add_u32 s19, s19, s38
    buffer_load_dwordx4 v1, s[4:7], s19 offen offset:0 sc1 lds
    buffer_load_dwordx4 v1, s[4:7], s19 offen offset:1024 sc1 lds
    s_add_u32 s17, s17, 1
    s_and_b32 s17, s17, 31
    s_mul_i32 s18, s16, 229376
    s_add_u32 m0, 0x18800, s54
    s_add_u32 s19, s18, s40
    buffer_load_dwordx4 v12, s[8:11], s19 offen  lds
    s_add_u32 m0, 0x18800, s55
    s_add_u32 s19, s18, s41
    buffer_load_dwordx4 v12, s[8:11], s19 offen  lds
    s_add_u32 m0, 0x18800, s56
    s_add_u32 s19, s18, s42
    buffer_load_dwordx4 v12, s[8:11], s19 offen  lds
    s_lshl_b32 s18, s16, 11
    s_add_u32 m0, 0x18800, s57
    s_add_u32 s19, s18, s43
    s_mov_b64 exec, s[62:63]
    buffer_load_dwordx4 v11, s[4:7], s19 offen sc1 lds
    s_mov_b64 exec, -1
    s_add_u32 s16, s16, 1
    s_and_b32 s16, s16, 31
    s_add_u32 m0, 0x18800, s53
    s_lshl_b32 s19, s17, 11
    s_add_u32 s19, s19, s38
    buffer_load_dwordx4 v1, s[4:7], s19 offen offset:0 sc1 lds
    buffer_load_dwordx4 v1, s[4:7], s19 offen offset:1024 sc1 lds
    s_add_u32 s17, s17, 1
    s_and_b32 s17, s17, 31
    s_mul_i32 s18, s16, 229376
    s_add_u32 m0, 0x1ea00, s54
    s_add_u32 s19, s18, s40
    buffer_load_dwordx4 v12, s[8:11], s19 offen  lds
    s_add_u32 m0, 0x1ea00, s55
    s_add_u32 s19, s18, s41
    buffer_load_dwordx4 v12, s[8:11], s19 offen  lds
    s_add_u32 m0, 0x1ea00, s56
    s_add_u32 s19, s18, s42
    buffer_load_dwordx4 v12, s[8:11], s19 offen  lds
    s_lshl_b32 s18, s16, 11
    s_add_u32 m0, 0x1ea00, s57
    s_add_u32 s19, s18, s43
    s_mov_b64 exec, s[62:63]
    buffer_load_dwordx4 v11, s[4:7], s19 offen sc1 lds
    s_mov_b64 exec, -1
    s_add_u32 s16, s16, 1
    s_and_b32 s16, s16, 31
    s_add_u32 m0, 0x1ea00, s53
    s_lshl_b32 s19, s17, 11
    s_add_u32 s19, s19, s38
    buffer_load_dwordx4 v1, s[4:7], s19 offen offset:0 sc1 lds
    buffer_load_dwordx4 v1, s[4:7], s19 offen offset:1024 sc1 lds
    s_add_u32 s17, s17, 1
    s_and_b32 s17, s17, 31
    s_waitcnt vmcnt(14)
    s_barrier
    buffer_load_dwordx2 v[28:29], v10, s[4:7], s34 offen offset:0 sc1
    buffer_load_dwordx2 v[30:31], v10, s[4:7], s34 offen offset:512 sc1
    buffer_load_dwordx2 v[32:33], v10, s[4:7], s34 offen offset:1024 sc1
    s_add_u32 m0, 0x0, s53
    s_lshl_b32 s19, s17, 11
    s_add_u32 s19, s19, s38
    buffer_load_dwordx4 v1, s[4:7], s19 offen offset:0 sc1 lds
    buffer_load_dwordx4 v1, s[4:7], s19 offen offset:1024 sc1 lds
    s_add_u32 s17, s17, 1
    s_and_b32 s17, s17, 31
    s_mul_i32 s18, s16, 229376
    s_add_u32 m0, 0x0, s54
    s_add_u32 s19, s18, s40
    buffer_load_dwordx4 v12, s[8:11], s19 offen  lds
    s_add_u32 m0, 0x0, s55
    s_add_u32 s19, s18, s41
    buffer_load_dwordx4 v12, s[8:11], s19 offen  lds
    s_add_u32 m0, 0x0, s56
    s_add_u32 s19, s18, s42
    buffer_load_dwordx4 v12, s[8:11], s19 offen  lds
    s_lshl_b32 s18, s16, 11
    s_add_u32 m0, 0x0, s57
    s_add_u32 s19, s18, s43
    s_mov_b64 exec, s[62:63]
    buffer_load_dwordx4 v11, s[4:7], s19 offen sc1 lds
    s_mov_b64 exec, -1
    s_add_u32 s16, s16, 1
    s_and_b32 s16, s16, 31
    s_waitcnt vmcnt(21)
    s_barrier
    buffer_load_dwordx2 v[34:35], v10, s[4:7], s34 offen offset:1536 sc1
    buffer_load_dwordx2 v[36:37], v10, s[4:7], s34 offen offset:2048 sc1
    buffer_load_dwordx2 v[38:39], v10, s[4:7], s34 offen offset:2560 sc1
    s_add_u32 m0, 0x6200, s53
    s_lshl_b32 s19, s17, 11
    s_add_u32 s19, s19, s38
    buffer_load_dwordx4 v1, s[4:7], s19 offen offset:0 sc1 lds
    buffer_load_dwordx4 v1, s[4:7], s19 offen offset:1024 sc1 lds
    s_add_u32 s17, s17, 1
    s_and_b32 s17, s17, 31
    s_mul_i32 s18, s16, 229376
    s_add_u32 m0, 0x6200, s54
    s_add_u32 s19, s18, s40
    buffer_load_dwordx4 v12, s[8:11], s19 offen  lds
    s_add_u32 m0, 0x6200, s55
    s_add_u32 s19, s18, s41
    buffer_load_dwordx4 v12, s[8:11], s19 offen  lds
    s_add_u32 m0, 0x6200, s56
    s_add_u32 s19, s18, s42
    buffer_load_dwordx4 v12, s[8:11], s19 offen  lds
    s_lshl_b32 s18, s16, 11
    s_add_u32 m0, 0x6200, s57
    s_add_u32 s19, s18, s43
    s_mov_b64 exec, s[62:63]
    buffer_load_dwordx4 v11, s[4:7], s19 offen sc1 lds
    s_mov_b64 exec, -1
    s_add_u32 s16, s16, 1
    s_and_b32 s16, s16, 31
    s_waitcnt vmcnt(24)
    s_barrier
    buffer_load_dwordx2 v[40:41], v10, s[4:7], s34 offen offset:3072 sc1
    buffer_load_dwordx2 v[42:43], v10, s[4:7], s34 offen offset:3584 sc1
    s_add_u32 m0, 0xc400, s53
    s_lshl_b32 s19, s17, 11
    s_add_u32 s19, s19, s38
    buffer_load_dwordx4 v1, s[4:7], s19 offen offset:0 sc1 lds
    buffer_load_dwordx4 v1, s[4:7], s19 offen offset:1024 sc1 lds
    s_add_u32 s17, s17, 1
    s_and_b32 s17, s17, 31
    s_mul_i32 s18, s16, 229376
    s_add_u32 m0, 0xc400, s54
    s_add_u32 s19, s18, s40
    buffer_load_dwordx4 v12, s[8:11], s19 offen  lds
    s_add_u32 m0, 0xc400, s55
    s_add_u32 s19, s18, s41
    buffer_load_dwordx4 v12, s[8:11], s19 offen  lds
    s_add_u32 m0, 0xc400, s56
    s_add_u32 s19, s18, s42
    buffer_load_dwordx4 v12, s[8:11], s19 offen  lds
    s_lshl_b32 s18, s16, 11
    s_add_u32 m0, 0xc400, s57
    s_add_u32 s19, s18, s43
    s_mov_b64 exec, s[62:63]
    buffer_load_dwordx4 v11, s[4:7], s19 offen sc1 lds
    s_mov_b64 exec, -1
    s_add_u32 s16, s16, 1
    s_and_b32 s16, s16, 31
    s_mov_b32 s36, 23
    s_mov_b32 s37, 75264
LD_ld:
    s_waitcnt vmcnt(18)
    s_barrier
    s_add_u32 m0, s37, s53
    s_lshl_b32 s19, s17, 11
    s_add_u32 s19, s19, s38
    buffer_load_dwordx4 v1, s[4:7], s19 offen offset:0 sc1 lds
    buffer_load_dwordx4 v1, s[4:7], s19 offen offset:1024 sc1 lds
    s_add_u32 s17, s17, 1
    s_and_b32 s17, s17, 31
    s_mul_i32 s18, s16, 229376
    s_add_u32 m0, s37, s54
    s_add_u32 s19, s18, s40
    buffer_load_dwordx4 v12, s[8:11], s19 offen  lds
    s_add_u32 m0, s37, s55
    s_add_u32 s19, s18, s41
    buffer_load_dwordx4 v12, s[8:11], s19 offen  lds
    s_add_u32 m0, s37, s56
    s_add_u32 s19, s18, s42
    buffer_load_dwordx4 v12, s[8:11], s19 offen  lds
    s_lshl_b32 s18, s16, 11
    s_add_u32 m0, s37, s57
    s_add_u32 s19, s18, s43
    s_mov_b64 exec, s[62:63]
    buffer_load_dwordx4 v11, s[4:7], s19 offen sc1 lds
    s_mov_b64 exec, -1
    s_add_u32 s16, s16, 1
    s_and_b32 s16, s16, 31
    s_add_u32 s37, s37, 25088
    s_cmp_eq_u32 s37, 150528
    s_cselect_b32 s37, 0, s37
    s_cmp_eq_u32 s36, 8
    s_cbranch_scc1 LD_side
LD_back:
    s_sub_u32 s36, s36, 1
    s_cmp_lg_u32 s36, 0
    s_cbranch_scc1 LD_ld
    s_waitcnt vmcnt(18) lgkmcnt(0)
    s_barrier
    s_mov_b32 s59, 300000
LD_cs:
    v_max_u32 v2, v16, v17
    v_max3_u32 v2, v2, v18, v19
    v_cmp_eq_u32 vcc, -1, v2
    s_sub_u32 s59, s59, 1
    s_cbranch_scc1 LD_csx
    s_cmp_eq_u64 vcc, 0
    s_cbranch_scc1 LD_csx
    s_mov_b32 s58, 14680064
    buffer_load_dword v16, v8, s[4:7], s58 offen sc1
    s_mov_b32 s58, 14694400
    buffer_load_dword v17, v8, s[4:7], s58 offen sc1
    s_mov_b32 s58, 14708736
    buffer_load_dword v18, v8, s[4:7], s58 offen sc1
    s_mov_b32 s58, 14723072
    buffer_load_dword v19, v8, s[4:7], s58 offen sc1
    s_waitcnt vmcnt(0)
    s_branch LD_cs
LD_csx:
    s_lshl_b32 s34, s33, 8
    s_add_u32 s34, s34, 162816
    v_lshl_add_u32 v8, v0, 2, s34
    v_add_f32 v16, v16, v17
    v_add_f32 v16, v16, v18
    v_add_f32 v16, v16, v19
    ds_write_b32 v8, v16
    v_mov_b32 v2, -1
    v_subrev_u32 v8, 3072, v8
    ds_write_b32 v8, v2
    s_waitcnt vmcnt(12) lgkmcnt(0)
    s_barrier
    v_pk_add_f32 v[28:29], v[28:29], v[30:31]
    v_pk_add_f32 v[32:33], v[32:33], v[34:35]
    v_pk_add_f32 v[36:37], v[36:37], v[38:39]
    v_pk_add_f32 v[40:41], v[40:41], v[42:43]
    v_pk_add_f32 v[28:29], v[28:29], v[32:33]
    v_pk_add_f32 v[36:37], v[36:37], v[40:41]
    v_pk_add_f32 v[28:29], v[28:29], v[36:37]
    v_mov_b32 v30, v28
    v_mov_b32 v31, v29
    s_nop 1
    v_permlane32_swap_b32 v28, v30
    v_permlane32_swap_b32 v29, v31
    s_nop 1
    v_add_f32 v20, v28, v30
    v_add_f32 v21, v29, v31
    s_waitcnt vmcnt(6) lgkmcnt(0)
    s_barrier
    v_mul_f32 v20, 0x3a800000, v20
    v_mul_f32 v24, v20, v20
    v_mov_b32 v25, 0x3a800000
    v_fma_f32 v21, v21, v25, -v24
    v_max_f32 v21, 0, v21
    v_cvt_pk_bf16_f32 v21, v21, v21
    v_lshlrev_b32 v21, 16, v21
    v_add_f32 v21, 0x3727c5ac, v21
    v_cvt_pk_bf16_f32 v21, v21, v21
    v_lshlrev_b32 v21, 16, v21
    v_sqrt_f32 v21, v21
    v_cvt_pk_bf16_f32 v20, v20, v20
    v_lshlrev_b32 v20, 16, v20
    v_cvt_pk_bf16_f32 v21, v21, v21
    v_lshlrev_b32 v21, 16, v21
    v_rcp_f32 v24, v21
    v_sub_f32 v20, 0, v20
    v_mul_f32 v22, 0xc0135761, v24
    v_mul_f32 v25, v24, v24
    v_mul_f32 v25, v25, v24
    v_mul_f32 v23, 0xbdd2d3e8, v25
    s_lshl_b32 s34, s33, 9
    s_add_u32 s34, s34, 160768
    v_lshl_add_u32 v9, v14, 4, s34
    ds_write_b128 v9, v[20:23]
    s_waitcnt vmcnt(0) lgkmcnt(0)
    s_barrier
    s_waitcnt vmcnt(0) lgkmcnt(0)
    s_barrier
    s_barrier
    s_add_u32 s38, s49, 0
    buffer_load_dwordx4 v[28:31], v26, s[20:23], s38 offen offset:0
    buffer_load_dwordx4 v[32:35], v27, s[20:23], s38 offen offset:1024
    s_add_u32 s38, s49, 131072
    buffer_load_dwordx4 v[36:39], v26, s[20:23], s38 offen offset:0
    buffer_load_dwordx4 v[40:43], v27, s[20:23], s38 offen offset:1024
    s_add_u32 s38, s49, 262144
    buffer_load_dwordx4 v[44:47], v26, s[20:23], s38 offen offset:0
    buffer_load_dwordx4 v[48:51], v27, s[20:23], s38 offen offset:1024
    s_add_u32 s38, s49, 393216
    buffer_load_dwordx4 v[52:55], v26, s[20:23], s38 offen offset:0
    buffer_load_dwordx4 v[56:59], v27, s[20:23], s38 offen offset:1024
    s_add_u32 s38, s49, 524288
    buffer_load_dwordx4 v[60:63], v26, s[20:23], s38 offen offset:0
    buffer_load_dwordx4 v[64:67], v27, s[20:23], s38 offen offset:1024
    s_add_u32 s38, s49, 655360
    buffer_load_dwordx4 v[68:71], v26, s[20:23], s38 offen offset:0
    buffer_load_dwordx4 v[72:75], v27, s[20:23], s38 offen offset:1024
    s_branch LE_start
LD_side:
    s_mov_b32 s58, 14680064
    buffer_load_dword v16, v8, s[4:7], s58 offen sc1
    s_mov_b32 s58, 14694400
    buffer_load_dword v17, v8, s[4:7], s58 offen sc1
    s_mov_b32 s58, 14708736
    buffer_load_dword v18, v8, s[4:7], s58 offen sc1
    s_mov_b32 s58, 14723072
    buffer_load_dword v19, v8, s[4:7], s58 offen sc1
    s_branch LD_back
LD_comp:
    v_lshrrev_b32 v12, 4, v0
    v_and_b32 v13, 15, v0
    s_and_b32 s34, s3, 1
    s_and_b32 s52, s52, -2
    v_bfe_u32 v9, v0, 2, 2
    v_mul_u32_u24 v57, 1056, v12
    v_lshl_add_u32 v57, v9, 6, v57
    v_and_b32 v10, 3, v0
    v_lshl_add_u32 v57, v10, 3, v57
    s_lshl_b32 s55, s34, 5
    v_add_u32 v57, s55, v57
    v_lshlrev_b32 v56, 9, v12
    v_lshl_add_u32 v56, v13, 4, v56
    s_and_b32 s55, s3, 2
    s_lshl_b32 s55, s55, 11
    s_add_u32 s55, s55, 16896
    v_add_u32 v56, s55, v56
    s_lshl_b32 s54, s32, 9
    s_add_u32 s55, s54, 12672
    s_add_u32 s56, s54, 8448
    s_sub_u32 s54, 8960, s54
    s_cmp_eq_u32 s31, 0
    s_cselect_b32 s57, s55, s56
    s_cselect_b32 s58, s56, s55
    s_cselect_b64 s[62:63], -1, 0
    v_add_u32 v58, s57, v57
    v_add_u32 v60, s58, v57
    v_add_u32 v59, s54, v57
    v_lshlrev_b32 v16, 12, v15
    v_lshl_add_u32 v16, v14, 3, v16
    v_mov_b32 v17, v11
    v_lshlrev_b32 v18, 6, v15
    v_xor_b32 v18, v18, v1
    v_add_u32 v19, 114688, v18
    v_cndmask_b32 v10, v18, v1, s[62:63]
    v_add_u32 v11, 114688, v10
    s_lshl_b32 s53, s52, 12
    s_add_u32 s53, s53, 15204352
    s_mul_i32 s58, s52, 114688
    s_lshl_b32 s59, s34, 10
    s_add_u32 s58, s58, s59
    s_lshl_b32 s44, s44, 11
    s_add_u32 s44, s44, s58
    s_add_u32 s44, s44, 25051136
    s_lshl_b32 s45, s45, 11
    s_add_u32 s45, s45, s58
    s_add_u32 s45, s45, 25051136
    s_lshl_b32 s46, s46, 11
    s_add_u32 s46, s46, s58
    s_add_u32 s46, s46, 25051136
    s_lshl_b32 s47, s47, 11
    s_add_u32 s47, s47, s58
    s_cmp_eq_u32 s31, 0
    s_cselect_b32 s59, 0, 8273920
    s_add_u32 s47, s47, s59
    s_add_u32 s47, s47, 16777216
    v_mov_b32 v64, 0
    v_mov_b32 v65, 0
    v_mov_b32 v66, 0
    v_mov_b32 v67, 0
    v_mov_b32 v68, 0
    v_mov_b32 v69, 0
    v_mov_b32 v70, 0
    v_mov_b32 v71, 0
    v_mov_b32 v72, 0
    v_mov_b32 v73, 0
    v_mov_b32 v74, 0
    v_mov_b32 v75, 0
    v_mov_b32 v76, 0
    v_mov_b32 v77, 0
    v_mov_b32 v78, 0
    v_mov_b32 v79, 0
    v_mov_b32 v80, 0
    v_mov_b32 v81, 0
    v_mov_b32 v82, 0
    v_mov_b32 v83, 0
    v_mov_b32 v84, 0
    v_mov_b32 v85, 0
    v_mov_b32 v86, 0
    v_mov_b32 v87, 0
    v_mov_b32 v88, 0
    v_mov_b32 v89, 0
    v_mov_b32 v90, 0
    v_mov_b32 v91, 0
    v_mov_b32 v92, 0
    v_mov_b32 v93, 0
    v_mov_b32 v94, 0
    v_mov_b32 v95, 0
    v_mov_b32 v96, 0
    v_mov_b32 v97, 0
    v_mov_b32 v98, 0
    v_mov_b32 v99, 0
    v_mov_b32 v100, 0
    v_mov_b32 v101, 0
    v_mov_b32 v102, 0
    v_mov_b32 v103, 0
    v_mov_b32 v104, 0
    v_mov_b32 v105, 0
    v_mov_b32 v106, 0
    v_mov_b32 v107, 0
    v_mov_b32 v108, 0
    v_mov_b32 v109, 0
    v_mov_b32 v110, 0
    v_mov_b32 v111, 0
    v_mov_b32 v112, 0
    v_mov_b32 v113, 0
    v_mov_b32 v114, 0
    v_mov_b32 v115, 0
    v_mov_b32 v116, 0
    v_mov_b32 v117, 0
    v_mov_b32 v118, 0
    v_mov_b32 v119, 0
    v_mov_b32 v120, 0
    v_mov_b32 v121, 0
    v_mov_b32 v122, 0
    v_mov_b32 v123, 0
    v_mov_b32 v124, 0
    v_mov_b32 v125, 0
    v_mov_b32 v126, 0
    v_mov_b32 v127, 0
    v_mov_b32 v128, 0
    v_mov_b32 v129, 0
    v_mov_b32 v130, 0
    v_mov_b32 v131, 0
    v_mov_b32 v132, 0
    v_mov_b32 v133, 0
    v_mov_b32 v134, 0
    v_mov_b32 v135, 0
    v_mov_b32 v136, 0
    v_mov_b32 v137, 0
    v_mov_b32 v138, 0
    v_mov_b32 v139, 0
    v_mov_b32 v140, 0
    v_mov_b32 v141, 0
    v_mov_b32 v142, 0
    v_mov_b32 v143, 0
    v_mov_b32 v144, 0
    v_mov_b32 v145, 0
    v_mov_b32 v146, 0
    v_mov_b32 v147, 0
    v_mov_b32 v148, 0
    v_mov_b32 v149, 0
    v_mov_b32 v150, 0
    v_mov_b32 v151, 0
    v_mov_b32 v152, 0
    v_mov_b32 v153, 0
    v_mov_b32 v154, 0
    v_mov_b32 v155, 0
    v_mov_b32 v156, 0
    v_mov_b32 v157, 0
    v_mov_b32 v158, 0
    v_mov_b32 v159, 0
    v_mov_b32 v160, 0
    v_mov_b32 v161, 0
    v_mov_b32 v162, 0
    v_mov_b32 v163, 0
    v_mov_b32 v164, 0
    v_mov_b32 v165, 0
    v_mov_b32 v166, 0
    v_mov_b32 v167, 0
    v_mov_b32 v168, 0
    v_mov_b32 v169, 0
    v_mov_b32 v170, 0
    v_mov_b32 v171, 0
    v_mov_b32 v172, 0
    v_mov_b32 v173, 0
    v_mov_b32 v174, 0
    v_mov_b32 v175, 0
    s_lshl_b32 s39, s30, 4
    s_add_u32 s39, s39, s28
    s_lshl_b32 s39, s39, 1
    s_add_u32 s39, s39, s31
    s_lshl_b32 s39, s39, 7
    s_add_u32 s39, s39, 15794176
    s_lshl_b32 s61, s30, 12
    s_add_u32 s61, s61, 15794176
    s_mov_b32 s37, 0
    v_mov_b32 v3, v56
    v_mov_b32 v4, v57
    v_mov_b32 v5, v58
    v_mov_b32 v6, v59
    v_mov_b32 v7, v60
    s_waitcnt vmcnt(0) lgkmcnt(0)
    s_barrier
    ds_read_b64_tr_b16 v[176:177], v5 offset:0
    ds_read_b128 v[204:207], v3 offset:0
    ds_read_b64_tr_b16 v[178:179], v5 offset:256
    ds_read_b128 v[208:211], v3 offset:256
    ds_read_b64_tr_b16 v[180:181], v6 offset:0
    ds_read_b128 v[212:215], v3 offset:2048
    ds_read_b64_tr_b16 v[182:183], v6 offset:256
    ds_read_b128 v[216:219], v3 offset:2304
    ds_read_b64_tr_b16 v[184:185], v7 offset:0
    ds_read_b64_tr_b16 v[186:187], v7 offset:256
    s_mov_b32 s36, 8
.p2align 4
Lrl14:
    s_waitcnt lgkmcnt(7)
    v_mfma_f32_16x16x32_bf16 v[96:99], v[176:179], v[204:207], v[96:99]
    ds_read_b64_tr_b16 v[188:189], v4 offset:0
    s_waitcnt lgkmcnt(7)
    v_mfma_f32_16x16x32_bf16 v[100:103], v[176:179], v[208:211], v[100:103]
    s_waitcnt lgkmcnt(5)
    v_mfma_f32_16x16x32_bf16 v[104:107], v[176:179], v[212:215], v[104:107]
    ds_read_b64_tr_b16 v[190:191], v4 offset:256
    s_waitcnt lgkmcnt(4)
    v_mfma_f32_16x16x32_bf16 v[108:111], v[176:179], v[216:219], v[108:111]
    v_mfma_f32_16x16x32_bf16 v[124:127], v[180:183], v[216:219], v[124:127]
    ds_read_b64_tr_b16 v[192:193], v4 offset:512
    v_mfma_f32_16x16x32_bf16 v[120:123], v[180:183], v[212:215], v[120:123]
    v_mfma_f32_16x16x32_bf16 v[116:119], v[180:183], v[208:211], v[116:119]
    ds_read_b64_tr_b16 v[194:195], v4 offset:768
    v_mfma_f32_16x16x32_bf16 v[112:115], v[180:183], v[204:207], v[112:115]
    s_waitcnt lgkmcnt(4)
    v_mfma_f32_16x16x32_bf16 v[128:131], v[184:187], v[204:207], v[128:131]
    ds_read_b64_tr_b16 v[196:197], v4 offset:4224
    v_mfma_f32_16x16x32_bf16 v[132:135], v[184:187], v[208:211], v[132:135]
    v_mfma_f32_16x16x32_bf16 v[136:139], v[184:187], v[212:215], v[136:139]
    ds_read_b64_tr_b16 v[198:199], v4 offset:4480
    v_mfma_f32_16x16x32_bf16 v[140:143], v[184:187], v[216:219], v[140:143]
    s_waitcnt lgkmcnt(4)
    v_mfma_f32_16x16x32_bf16 v[76:79], v[188:191], v[216:219], v[76:79]
    ds_read_b64_tr_b16 v[200:201], v4 offset:4736
    v_mfma_f32_16x16x32_bf16 v[72:75], v[188:191], v[212:215], v[72:75]
    v_mfma_f32_16x16x32_bf16 v[68:71], v[188:191], v[208:211], v[68:71]
    ds_read_b64_tr_b16 v[202:203], v4 offset:4992
    v_mfma_f32_16x16x32_bf16 v[64:67], v[188:191], v[204:207], v[64:67]
    s_waitcnt lgkmcnt(4)
    v_mfma_f32_16x16x32_bf16 v[80:83], v[192:195], v[204:207], v[80:83]
    s_barrier
    ds_read_b64_tr_b16 v[176:177], v5 offset:25088
    v_mfma_f32_16x16x32_bf16 v[84:87], v[192:195], v[208:211], v[84:87]
    ds_read_b128 v[220:223], v3 offset:25088
    v_mfma_f32_16x16x32_bf16 v[88:91], v[192:195], v[212:215], v[88:91]
    ds_read_b64_tr_b16 v[178:179], v5 offset:25344
    v_mfma_f32_16x16x32_bf16 v[92:95], v[192:195], v[216:219], v[92:95]
    ds_read_b128 v[224:227], v3 offset:25344
    s_waitcnt lgkmcnt(6)
    v_mfma_f32_16x16x32_bf16 v[156:159], v[196:199], v[216:219], v[156:159]
    ds_read_b64_tr_b16 v[180:181], v6 offset:25088
    v_mfma_f32_16x16x32_bf16 v[152:155], v[196:199], v[212:215], v[152:155]
    ds_read_b128 v[228:231], v3 offset:27136
    v_mfma_f32_16x16x32_bf16 v[148:151], v[196:199], v[208:211], v[148:151]
    ds_read_b64_tr_b16 v[182:183], v6 offset:25344
    v_mfma_f32_16x16x32_bf16 v[144:147], v[196:199], v[204:207], v[144:147]
    ds_read_b128 v[232:235], v3 offset:27392
    s_waitcnt lgkmcnt(8)
    v_mfma_f32_16x16x32_bf16 v[160:163], v[200:203], v[204:207], v[160:163]
    ds_read_b64_tr_b16 v[184:185], v7 offset:25088
    v_mfma_f32_16x16x32_bf16 v[164:167], v[200:203], v[208:211], v[164:167]
    v_mfma_f32_16x16x32_bf16 v[168:171], v[200:203], v[212:215], v[168:171]
    ds_read_b64_tr_b16 v[186:187], v7 offset:25344
    v_mfma_f32_16x16x32_bf16 v[172:175], v[200:203], v[216:219], v[172:175]
    s_waitcnt lgkmcnt(7)
    v_mfma_f32_16x16x32_bf16 v[96:99], v[176:179], v[220:223], v[96:99]
    ds_read_b64_tr_b16 v[188:189], v4 offset:25088
    s_waitcnt lgkmcnt(7)
    v_mfma_f32_16x16x32_bf16 v[100:103], v[176:179], v[224:227], v[100:103]
    s_add_u32 s37, s37, 50176
    s_cmp_eq_u32 s37, 150528
    s_cselect_b32 s37, 0, s37
    s_waitcnt lgkmcnt(5)
    v_mfma_f32_16x16x32_bf16 v[104:107], v[176:179], v[228:231], v[104:107]
    ds_read_b64_tr_b16 v[190:191], v4 offset:25344
    s_waitcnt lgkmcnt(4)
    v_mfma_f32_16x16x32_bf16 v[108:111], v[176:179], v[232:235], v[108:111]
    v_add_u32 v3, s37, v56
    v_mfma_f32_16x16x32_bf16 v[124:127], v[180:183], v[232:235], v[124:127]
    ds_read_b64_tr_b16 v[192:193], v4 offset:25600
    v_mfma_f32_16x16x32_bf16 v[120:123], v[180:183], v[228:231], v[120:123]
    v_add_u32 v5, s37, v58
    v_mfma_f32_16x16x32_bf16 v[116:119], v[180:183], v[224:227], v[116:119]
    ds_read_b64_tr_b16 v[194:195], v4 offset:25856
    v_mfma_f32_16x16x32_bf16 v[112:115], v[180:183], v[220:223], v[112:115]
    v_add_u32 v6, s37, v59
    s_waitcnt lgkmcnt(4)
    v_mfma_f32_16x16x32_bf16 v[128:131], v[184:187], v[220:223], v[128:131]
    ds_read_b64_tr_b16 v[196:197], v4 offset:29312
    v_mfma_f32_16x16x32_bf16 v[132:135], v[184:187], v[224:227], v[132:135]
    v_add_u32 v7, s37, v60
    v_mfma_f32_16x16x32_bf16 v[136:139], v[184:187], v[228:231], v[136:139]
    ds_read_b64_tr_b16 v[198:199], v4 offset:29568
    v_mfma_f32_16x16x32_bf16 v[140:143], v[184:187], v[232:235], v[140:143]
    s_waitcnt lgkmcnt(4)
    v_mfma_f32_16x16x32_bf16 v[76:79], v[188:191], v[232:235], v[76:79]
    ds_read_b64_tr_b16 v[200:201], v4 offset:29824
    v_mfma_f32_16x16x32_bf16 v[72:75], v[188:191], v[228:231], v[72:75]
    v_mfma_f32_16x16x32_bf16 v[68:71], v[188:191], v[224:227], v[68:71]
    ds_read_b64_tr_b16 v[202:203], v4 offset:30080
    v_mfma_f32_16x16x32_bf16 v[64:67], v[188:191], v[220:223], v[64:67]
    v_add_u32 v4, s37, v57
    s_waitcnt lgkmcnt(4)
    v_mfma_f32_16x16x32_bf16 v[80:83], v[192:195], v[220:223], v[80:83]
    s_barrier
    ds_read_b64_tr_b16 v[176:177], v5 offset:0
    v_mfma_f32_16x16x32_bf16 v[84:87], v[192:195], v[224:227], v[84:87]
    ds_read_b128 v[204:207], v3 offset:0
    v_mfma_f32_16x16x32_bf16 v[88:91], v[192:195], v[228:231], v[88:91]
    ds_read_b64_tr_b16 v[178:179], v5 offset:256
    v_mfma_f32_16x16x32_bf16 v[92:95], v[192:195], v[232:235], v[92:95]
    ds_read_b128 v[208:211], v3 offset:256
    s_waitcnt lgkmcnt(6)
    v_mfma_f32_16x16x32_bf16 v[156:159], v[196:199], v[232:235], v[156:159]
    ds_read_b64_tr_b16 v[180:181], v6 offset:0
    v_mfma_f32_16x16x32_bf16 v[152:155], v[196:199], v[228:231], v[152:155]
    ds_read_b128 v[212:215], v3 offset:2048
    v_mfma_f32_16x16x32_bf16 v[148:151], v[196:199], v[224:227], v[148:151]
    ds_read_b64_tr_b16 v[182:183], v6 offset:256
    v_mfma_f32_16x16x32_bf16 v[144:147], v[196:199], v[220:223], v[144:147]
    ds_read_b128 v[216:219], v3 offset:2304
    s_waitcnt lgkmcnt(8)
    v_mfma_f32_16x16x32_bf16 v[160:163], v[200:203], v[220:223], v[160:163]
    ds_read_b64_tr_b16 v[184:185], v7 offset:0
    v_mfma_f32_16x16x32_bf16 v[164:167], v[200:203], v[224:227], v[164:167]
    v_mfma_f32_16x16x32_bf16 v[168:171], v[200:203], v[228:231], v[168:171]
    ds_read_b64_tr_b16 v[186:187], v7 offset:256
    v_mfma_f32_16x16x32_bf16 v[172:175], v[200:203], v[232:235], v[172:175]
    s_waitcnt lgkmcnt(7)
    v_mfma_f32_16x16x32_bf16 v[96:99], v[176:179], v[204:207], v[96:99]
    ds_read_b64_tr_b16 v[188:189], v4 offset:0
    s_waitcnt lgkmcnt(7)
    v_mfma_f32_16x16x32_bf16 v[100:103], v[176:179], v[208:211], v[100:103]
    s_waitcnt lgkmcnt(5)
    v_mfma_f32_16x16x32_bf16 v[104:107], v[176:179], v[212:215], v[104:107]
    ds_read_b64_tr_b16 v[190:191], v4 offset:256
    s_waitcnt lgkmcnt(4)
    v_mfma_f32_16x16x32_bf16 v[108:111], v[176:179], v[216:219], v[108:111]
    v_mfma_f32_16x16x32_bf16 v[124:127], v[180:183], v[216:219], v[124:127]
    ds_read_b64_tr_b16 v[192:193], v4 offset:512
    v_mfma_f32_16x16x32_bf16 v[120:123], v[180:183], v[212:215], v[120:123]
    v_mfma_f32_16x16x32_bf16 v[116:119], v[180:183], v[208:211], v[116:119]
    ds_read_b64_tr_b16 v[194:195], v4 offset:768
    v_mfma_f32_16x16x32_bf16 v[112:115], v[180:183], v[204:207], v[112:115]
    s_waitcnt lgkmcnt(4)
    v_mfma_f32_16x16x32_bf16 v[128:131], v[184:187], v[204:207], v[128:131]
    ds_read_b64_tr_b16 v[196:197], v4 offset:4224
    v_mfma_f32_16x16x32_bf16 v[132:135], v[184:187], v[208:211], v[132:135]
    v_mfma_f32_16x16x32_bf16 v[136:139], v[184:187], v[212:215], v[136:139]
    ds_read_b64_tr_b16 v[198:199], v4 offset:4480
    v_mfma_f32_16x16x32_bf16 v[140:143], v[184:187], v[216:219], v[140:143]
    s_waitcnt lgkmcnt(4)
    v_mfma_f32_16x16x32_bf16 v[76:79], v[188:191], v[216:219], v[76:79]
    ds_read_b64_tr_b16 v[200:201], v4 offset:4736
    v_mfma_f32_16x16x32_bf16 v[72:75], v[188:191], v[212:215], v[72:75]
    v_mfma_f32_16x16x32_bf16 v[68:71], v[188:191], v[208:211], v[68:71]
    ds_read_b64_tr_b16 v[202:203], v4 offset:4992
    v_mfma_f32_16x16x32_bf16 v[64:67], v[188:191], v[204:207], v[64:67]
    s_waitcnt lgkmcnt(4)
    v_mfma_f32_16x16x32_bf16 v[80:83], v[192:195], v[204:207], v[80:83]
    s_barrier
    ds_read_b64_tr_b16 v[176:177], v5 offset:25088
    v_mfma_f32_16x16x32_bf16 v[84:87], v[192:195], v[208:211], v[84:87]
    ds_read_b128 v[220:223], v3 offset:25088
    v_mfma_f32_16x16x32_bf16 v[88:91], v[192:195], v[212:215], v[88:91]
    ds_read_b64_tr_b16 v[178:179], v5 offset:25344
    v_mfma_f32_16x16x32_bf16 v[92:95], v[192:195], v[216:219], v[92:95]
    ds_read_b128 v[224:227], v3 offset:25344
    s_waitcnt lgkmcnt(6)
    v_mfma_f32_16x16x32_bf16 v[156:159], v[196:199], v[216:219], v[156:159]
    ds_read_b64_tr_b16 v[180:181], v6 offset:25088
    v_mfma_f32_16x16x32_bf16 v[152:155], v[196:199], v[212:215], v[152:155]
    ds_read_b128 v[228:231], v3 offset:27136
    v_mfma_f32_16x16x32_bf16 v[148:151], v[196:199], v[208:211], v[148:151]
    ds_read_b64_tr_b16 v[182:183], v6 offset:25344
    v_mfma_f32_16x16x32_bf16 v[144:147], v[196:199], v[204:207], v[144:147]
    ds_read_b128 v[232:235], v3 offset:27392
    s_waitcnt lgkmcnt(8)
    v_mfma_f32_16x16x32_bf16 v[160:163], v[200:203], v[204:207], v[160:163]
    ds_read_b64_tr_b16 v[184:185], v7 offset:25088
    v_mfma_f32_16x16x32_bf16 v[164:167], v[200:203], v[208:211], v[164:167]
    v_mfma_f32_16x16x32_bf16 v[168:171], v[200:203], v[212:215], v[168:171]
    ds_read_b64_tr_b16 v[186:187], v7 offset:25344
    v_mfma_f32_16x16x32_bf16 v[172:175], v[200:203], v[216:219], v[172:175]
    s_waitcnt lgkmcnt(7)
    v_mfma_f32_16x16x32_bf16 v[96:99], v[176:179], v[220:223], v[96:99]
    ds_read_b64_tr_b16 v[188:189], v4 offset:25088
    s_waitcnt lgkmcnt(7)
    v_mfma_f32_16x16x32_bf16 v[100:103], v[176:179], v[224:227], v[100:103]
    s_add_u32 s37, s37, 50176
    s_cmp_eq_u32 s37, 150528
    s_cselect_b32 s37, 0, s37
    s_waitcnt lgkmcnt(5)
    v_mfma_f32_16x16x32_bf16 v[104:107], v[176:179], v[228:231], v[104:107]
    ds_read_b64_tr_b16 v[190:191], v4 offset:25344
    s_waitcnt lgkmcnt(4)
    v_mfma_f32_16x16x32_bf16 v[108:111], v[176:179], v[232:235], v[108:111]
    v_add_u32 v3, s37, v56
    v_mfma_f32_16x16x32_bf16 v[124:127], v[180:183], v[232:235], v[124:127]
    ds_read_b64_tr_b16 v[192:193], v4 offset:25600
    v_mfma_f32_16x16x32_bf16 v[120:123], v[180:183], v[228:231], v[120:123]
    v_add_u32 v5, s37, v58
    v_mfma_f32_16x16x32_bf16 v[116:119], v[180:183], v[224:227], v[116:119]
    ds_read_b64_tr_b16 v[194:195], v4 offset:25856
    v_mfma_f32_16x16x32_bf16 v[112:115], v[180:183], v[220:223], v[112:115]
    v_add_u32 v6, s37, v59
    s_waitcnt lgkmcnt(4)
    v_mfma_f32_16x16x32_bf16 v[128:131], v[184:187], v[220:223], v[128:131]
    ds_read_b64_tr_b16 v[196:197], v4 offset:29312
    v_mfma_f32_16x16x32_bf16 v[132:135], v[184:187], v[224:227], v[132:135]
    v_add_u32 v7, s37, v60
    v_mfma_f32_16x16x32_bf16 v[136:139], v[184:187], v[228:231], v[136:139]
    ds_read_b64_tr_b16 v[198:199], v4 offset:29568
    v_mfma_f32_16x16x32_bf16 v[140:143], v[184:187], v[232:235], v[140:143]
    s_waitcnt lgkmcnt(4)
    v_mfma_f32_16x16x32_bf16 v[76:79], v[188:191], v[232:235], v[76:79]
    ds_read_b64_tr_b16 v[200:201], v4 offset:29824
    v_mfma_f32_16x16x32_bf16 v[72:75], v[188:191], v[228:231], v[72:75]
    v_mfma_f32_16x16x32_bf16 v[68:71], v[188:191], v[224:227], v[68:71]
    ds_read_b64_tr_b16 v[202:203], v4 offset:30080
    v_mfma_f32_16x16x32_bf16 v[64:67], v[188:191], v[220:223], v[64:67]
    v_add_u32 v4, s37, v57
    s_waitcnt lgkmcnt(4)
    v_mfma_f32_16x16x32_bf16 v[80:83], v[192:195], v[220:223], v[80:83]
    s_barrier
    ds_read_b64_tr_b16 v[176:177], v5 offset:0
    v_mfma_f32_16x16x32_bf16 v[84:87], v[192:195], v[224:227], v[84:87]
    ds_read_b128 v[204:207], v3 offset:0
    v_mfma_f32_16x16x32_bf16 v[88:91], v[192:195], v[228:231], v[88:91]
    ds_read_b64_tr_b16 v[178:179], v5 offset:256
    v_mfma_f32_16x16x32_bf16 v[92:95], v[192:195], v[232:235], v[92:95]
    ds_read_b128 v[208:211], v3 offset:256
    s_waitcnt lgkmcnt(6)
    v_mfma_f32_16x16x32_bf16 v[156:159], v[196:199], v[232:235], v[156:159]
    ds_read_b64_tr_b16 v[180:181], v6 offset:0
    v_mfma_f32_16x16x32_bf16 v[152:155], v[196:199], v[228:231], v[152:155]
    ds_read_b128 v[212:215], v3 offset:2048
    v_mfma_f32_16x16x32_bf16 v[148:151], v[196:199], v[224:227], v[148:151]
    ds_read_b64_tr_b16 v[182:183], v6 offset:256
    v_mfma_f32_16x16x32_bf16 v[144:147], v[196:199], v[220:223], v[144:147]
    ds_read_b128 v[216:219], v3 offset:2304
    s_waitcnt lgkmcnt(8)
    v_mfma_f32_16x16x32_bf16 v[160:163], v[200:203], v[220:223], v[160:163]
    ds_read_b64_tr_b16 v[184:185], v7 offset:0
    v_mfma_f32_16x16x32_bf16 v[164:167], v[200:203], v[224:227], v[164:167]
    s_sub_u32 s36, s36, 1
    s_cmp_lg_u32 s36, 0
    v_mfma_f32_16x16x32_bf16 v[168:171], v[200:203], v[228:231], v[168:171]
    ds_read_b64_tr_b16 v[186:187], v7 offset:256
    v_mfma_f32_16x16x32_bf16 v[172:175], v[200:203], v[232:235], v[172:175]
    s_cbranch_scc1 Lrl14
    s_waitcnt lgkmcnt(0)
    s_barrier
    s_lshl_b32 s55, s34, 6
    s_add_u32 s55, s55, 162816
    v_lshl_add_u32 v38, v12, 4, s55
    s_and_b32 s55, s3, 2
    s_lshl_b32 s55, s55, 9
    s_add_u32 s55, s55, 160768
    v_lshl_add_u32 v39, v13, 4, s55
    ds_read_b128 v[20:23], v39 offset:0
    ds_read_b128 v[24:27], v39 offset:256
    ds_read_b128 v[28:31], v39 offset:512
    ds_read_b128 v[32:35], v39 offset:768
    ds_read_b128 v[56:59], v38 offset:0
    ds_read_b128 v[60:63], v38 offset:128
    s_waitcnt lgkmcnt(1)
    v_pk_fma_f32 v[64:65], v[56:57], v[20:21], v[64:65] op_sel_hi:[1,0,1]
    v_pk_fma_f32 v[66:67], v[58:59], v[20:21], v[66:67] op_sel_hi:[1,0,1]
    v_pk_fma_f32 v[68:69], v[56:57], v[24:25], v[68:69] op_sel_hi:[1,0,1]
    v_pk_fma_f32 v[70:71], v[58:59], v[24:25], v[70:71] op_sel_hi:[1,0,1]
    v_pk_fma_f32 v[72:73], v[56:57], v[28:29], v[72:73] op_sel_hi:[1,0,1]
    v_pk_fma_f32 v[74:75], v[58:59], v[28:29], v[74:75] op_sel_hi:[1,0,1]
    v_pk_fma_f32 v[76:77], v[56:57], v[32:33], v[76:77] op_sel_hi:[1,0,1]
    v_pk_fma_f32 v[78:79], v[58:59], v[32:33], v[78:79] op_sel_hi:[1,0,1]
    v_pk_mul_f32 v[208:209], v[64:65], v[64:65]
    v_pk_mul_f32 v[210:211], v[66:67], v[66:67]
    v_pk_mul_f32 v[212:213], v[68:69], v[68:69]
    v_pk_mul_f32 v[214:215], v[70:71], v[70:71]
    v_pk_mul_f32 v[216:217], v[72:73], v[72:73]
    v_pk_mul_f32 v[218:219], v[74:75], v[74:75]
    v_pk_mul_f32 v[220:221], v[76:77], v[76:77]
    v_pk_mul_f32 v[222:223], v[78:79], v[78:79]
    v_pk_fma_f32 v[208:209], v[208:209], v[22:23], v[22:23] op_sel:[0,1,0] op_sel_hi:[1,1,0]
    v_pk_fma_f32 v[210:211], v[210:211], v[22:23], v[22:23] op_sel:[0,1,0] op_sel_hi:[1,1,0]
    v_pk_fma_f32 v[212:213], v[212:213], v[26:27], v[26:27] op_sel:[0,1,0] op_sel_hi:[1,1,0]
    v_pk_fma_f32 v[214:215], v[214:215], v[26:27], v[26:27] op_sel:[0,1,0] op_sel_hi:[1,1,0]
    v_pk_fma_f32 v[216:217], v[216:217], v[30:31], v[30:31] op_sel:[0,1,0] op_sel_hi:[1,1,0]
    v_pk_fma_f32 v[218:219], v[218:219], v[30:31], v[30:31] op_sel:[0,1,0] op_sel_hi:[1,1,0]
    v_pk_fma_f32 v[220:221], v[220:221], v[34:35], v[34:35] op_sel:[0,1,0] op_sel_hi:[1,1,0]
    v_pk_fma_f32 v[222:223], v[222:223], v[34:35], v[34:35] op_sel:[0,1,0] op_sel_hi:[1,1,0]
    v_pk_mul_f32 v[208:209], v[208:209], v[64:65]
    v_pk_mul_f32 v[210:211], v[210:211], v[66:67]
    v_pk_mul_f32 v[212:213], v[212:213], v[68:69]
    v_pk_mul_f32 v[214:215], v[214:215], v[70:71]
    v_pk_mul_f32 v[216:217], v[216:217], v[72:73]
    v_pk_mul_f32 v[218:219], v[218:219], v[74:75]
    v_pk_mul_f32 v[220:221], v[220:221], v[76:77]
    v_pk_mul_f32 v[222:223], v[222:223], v[78:79]
    v_exp_f32 v208, v208
    v_exp_f32 v209, v209
    v_exp_f32 v210, v210
    v_exp_f32 v211, v211
    v_exp_f32 v212, v212
    v_exp_f32 v213, v213
    v_exp_f32 v214, v214
    v_exp_f32 v215, v215
    v_exp_f32 v216, v216
    v_exp_f32 v217, v217
    v_exp_f32 v218, v218
    v_exp_f32 v219, v219
    v_exp_f32 v220, v220
    v_exp_f32 v221, v221
    v_exp_f32 v222, v222
    v_exp_f32 v223, v223
    v_pk_fma_f32 v[208:209], v[208:209], v[20:21], v[20:21] op_sel:[0,1,1] op_sel_hi:[1,1,1]
    v_pk_fma_f32 v[210:211], v[210:211], v[20:21], v[20:21] op_sel:[0,1,1] op_sel_hi:[1,1,1]
    v_pk_fma_f32 v[212:213], v[212:213], v[24:25], v[24:25] op_sel:[0,1,1] op_sel_hi:[1,1,1]
    v_pk_fma_f32 v[214:215], v[214:215], v[24:25], v[24:25] op_sel:[0,1,1] op_sel_hi:[1,1,1]
    v_pk_fma_f32 v[216:217], v[216:217], v[28:29], v[28:29] op_sel:[0,1,1] op_sel_hi:[1,1,1]
    v_pk_fma_f32 v[218:219], v[218:219], v[28:29], v[28:29] op_sel:[0,1,1] op_sel_hi:[1,1,1]
    v_pk_fma_f32 v[220:221], v[220:221], v[32:33], v[32:33] op_sel:[0,1,1] op_sel_hi:[1,1,1]
    v_pk_fma_f32 v[222:223], v[222:223], v[32:33], v[32:33] op_sel:[0,1,1] op_sel_hi:[1,1,1]
    v_rcp_f32 v208, v208
    v_rcp_f32 v209, v209
    v_rcp_f32 v210, v210
    v_rcp_f32 v211, v211
    v_rcp_f32 v212, v212
    v_rcp_f32 v213, v213
    v_rcp_f32 v214, v214
    v_rcp_f32 v215, v215
    v_rcp_f32 v216, v216
    v_rcp_f32 v217, v217
    v_rcp_f32 v218, v218
    v_rcp_f32 v219, v219
    v_rcp_f32 v220, v220
    v_rcp_f32 v221, v221
    v_rcp_f32 v222, v222
    v_rcp_f32 v223, v223
    v_pk_mul_f32 v[64:65], v[64:65], v[208:209]
    v_pk_mul_f32 v[66:67], v[66:67], v[210:211]
    v_pk_mul_f32 v[68:69], v[68:69], v[212:213]
    v_pk_mul_f32 v[70:71], v[70:71], v[214:215]
    v_pk_mul_f32 v[72:73], v[72:73], v[216:217]
    v_pk_mul_f32 v[74:75], v[74:75], v[218:219]
    v_pk_mul_f32 v[76:77], v[76:77], v[220:221]
    v_pk_mul_f32 v[78:79], v[78:79], v[222:223]
    v_pk_add_f32 v[40:41], v[64:65], v[66:67]
    v_pk_mul_f32 v[42:43], v[64:65], v[64:65]
    v_pk_add_f32 v[44:45], v[68:69], v[70:71]
    v_pk_mul_f32 v[46:47], v[68:69], v[68:69]
    v_pk_add_f32 v[48:49], v[72:73], v[74:75]
    v_pk_mul_f32 v[50:51], v[72:73], v[72:73]
    v_pk_add_f32 v[52:53], v[76:77], v[78:79]
    v_pk_mul_f32 v[54:55], v[76:77], v[76:77]
    v_pk_fma_f32 v[42:43], v[66:67], v[66:67], v[42:43]
    v_pk_fma_f32 v[46:47], v[70:71], v[70:71], v[46:47]
    v_pk_fma_f32 v[50:51], v[74:75], v[74:75], v[50:51]
    v_pk_fma_f32 v[54:55], v[78:79], v[78:79], v[54:55]
    ds_read_b128 v[56:59], v38 offset:256
    s_waitcnt lgkmcnt(1)
    v_pk_fma_f32 v[80:81], v[60:61], v[20:21], v[80:81] op_sel_hi:[1,0,1]
    v_pk_fma_f32 v[82:83], v[62:63], v[20:21], v[82:83] op_sel_hi:[1,0,1]
    v_pk_fma_f32 v[84:85], v[60:61], v[24:25], v[84:85] op_sel_hi:[1,0,1]
    v_pk_fma_f32 v[86:87], v[62:63], v[24:25], v[86:87] op_sel_hi:[1,0,1]
    v_pk_fma_f32 v[88:89], v[60:61], v[28:29], v[88:89] op_sel_hi:[1,0,1]
    v_pk_fma_f32 v[90:91], v[62:63], v[28:29], v[90:91] op_sel_hi:[1,0,1]
    v_pk_fma_f32 v[92:93], v[60:61], v[32:33], v[92:93] op_sel_hi:[1,0,1]
    v_pk_fma_f32 v[94:95], v[62:63], v[32:33], v[94:95] op_sel_hi:[1,0,1]
    v_pk_mul_f32 v[208:209], v[80:81], v[80:81]
    v_pk_mul_f32 v[210:211], v[82:83], v[82:83]
    v_pk_mul_f32 v[212:213], v[84:85], v[84:85]
    v_pk_mul_f32 v[214:215], v[86:87], v[86:87]
    v_pk_mul_f32 v[216:217], v[88:89], v[88:89]
    v_pk_mul_f32 v[218:219], v[90:91], v[90:91]
    v_pk_mul_f32 v[220:221], v[92:93], v[92:93]
    v_pk_mul_f32 v[222:223], v[94:95], v[94:95]
    v_pk_fma_f32 v[208:209], v[208:209], v[22:23], v[22:23] op_sel:[0,1,0] op_sel_hi:[1,1,0]
    v_pk_fma_f32 v[210:211], v[210:211], v[22:23], v[22:23] op_sel:[0,1,0] op_sel_hi:[1,1,0]
    v_pk_fma_f32 v[212:213], v[212:213], v[26:27], v[26:27] op_sel:[0,1,0] op_sel_hi:[1,1,0]
    v_pk_fma_f32 v[214:215], v[214:215], v[26:27], v[26:27] op_sel:[0,1,0] op_sel_hi:[1,1,0]
    v_pk_fma_f32 v[216:217], v[216:217], v[30:31], v[30:31] op_sel:[0,1,0] op_sel_hi:[1,1,0]
    v_pk_fma_f32 v[218:219], v[218:219], v[30:31], v[30:31] op_sel:[0,1,0] op_sel_hi:[1,1,0]
    v_pk_fma_f32 v[220:221], v[220:221], v[34:35], v[34:35] op_sel:[0,1,0] op_sel_hi:[1,1,0]
    v_pk_fma_f32 v[222:223], v[222:223], v[34:35], v[34:35] op_sel:[0,1,0] op_sel_hi:[1,1,0]
    v_pk_mul_f32 v[208:209], v[208:209], v[80:81]
    v_pk_mul_f32 v[210:211], v[210:211], v[82:83]
    v_pk_mul_f32 v[212:213], v[212:213], v[84:85]
    v_pk_mul_f32 v[214:215], v[214:215], v[86:87]
    v_pk_mul_f32 v[216:217], v[216:217], v[88:89]
    v_pk_mul_f32 v[218:219], v[218:219], v[90:91]
    v_pk_mul_f32 v[220:221], v[220:221], v[92:93]
    v_pk_mul_f32 v[222:223], v[222:223], v[94:95]
    v_exp_f32 v208, v208
    v_exp_f32 v209, v209
    v_exp_f32 v210, v210
    v_exp_f32 v211, v211
    v_exp_f32 v212, v212
    v_exp_f32 v213, v213
    v_exp_f32 v214, v214
    v_exp_f32 v215, v215
    v_exp_f32 v216, v216
    v_exp_f32 v217, v217
    v_exp_f32 v218, v218
    v_exp_f32 v219, v219
    v_exp_f32 v220, v220
    v_exp_f32 v221, v221
    v_exp_f32 v222, v222
    v_exp_f32 v223, v223
    v_pk_fma_f32 v[208:209], v[208:209], v[20:21], v[20:21] op_sel:[0,1,1] op_sel_hi:[1,1,1]
    v_pk_fma_f32 v[210:211], v[210:211], v[20:21], v[20:21] op_sel:[0,1,1] op_sel_hi:[1,1,1]
    v_pk_fma_f32 v[212:213], v[212:213], v[24:25], v[24:25] op_sel:[0,1,1] op_sel_hi:[1,1,1]
    v_pk_fma_f32 v[214:215], v[214:215], v[24:25], v[24:25] op_sel:[0,1,1] op_sel_hi:[1,1,1]
    v_pk_fma_f32 v[216:217], v[216:217], v[28:29], v[28:29] op_sel:[0,1,1] op_sel_hi:[1,1,1]
    v_pk_fma_f32 v[218:219], v[218:219], v[28:29], v[28:29] op_sel:[0,1,1] op_sel_hi:[1,1,1]
    v_pk_fma_f32 v[220:221], v[220:221], v[32:33], v[32:33] op_sel:[0,1,1] op_sel_hi:[1,1,1]
    v_pk_fma_f32 v[222:223], v[222:223], v[32:33], v[32:33] op_sel:[0,1,1] op_sel_hi:[1,1,1]
    v_rcp_f32 v208, v208
    v_rcp_f32 v209, v209
    v_rcp_f32 v210, v210
    v_rcp_f32 v211, v211
    v_rcp_f32 v212, v212
    v_rcp_f32 v213, v213
    v_rcp_f32 v214, v214
    v_rcp_f32 v215, v215
    v_rcp_f32 v216, v216
    v_rcp_f32 v217, v217
    v_rcp_f32 v218, v218
    v_rcp_f32 v219, v219
    v_rcp_f32 v220, v220
    v_rcp_f32 v221, v221
    v_rcp_f32 v222, v222
    v_rcp_f32 v223, v223
    v_pk_mul_f32 v[80:81], v[80:81], v[208:209]
    v_pk_mul_f32 v[82:83], v[82:83], v[210:211]
    v_pk_mul_f32 v[84:85], v[84:85], v[212:213]
    v_pk_mul_f32 v[86:87], v[86:87], v[214:215]
    v_pk_mul_f32 v[88:89], v[88:89], v[216:217]
    v_pk_mul_f32 v[90:91], v[90:91], v[218:219]
    v_pk_mul_f32 v[92:93], v[92:93], v[220:221]
    v_pk_mul_f32 v[94:95], v[94:95], v[222:223]
    v_pk_add_f32 v[40:41], v[40:41], v[80:81]
    v_pk_fma_f32 v[42:43], v[80:81], v[80:81], v[42:43]
    v_pk_add_f32 v[44:45], v[44:45], v[84:85]
    v_pk_fma_f32 v[46:47], v[84:85], v[84:85], v[46:47]
    v_pk_add_f32 v[48:49], v[48:49], v[88:89]
    v_pk_fma_f32 v[50:51], v[88:89], v[88:89], v[50:51]
    v_pk_add_f32 v[52:53], v[52:53], v[92:93]
    v_pk_fma_f32 v[54:55], v[92:93], v[92:93], v[54:55]
    v_pk_add_f32 v[40:41], v[40:41], v[82:83]
    v_pk_fma_f32 v[42:43], v[82:83], v[82:83], v[42:43]
    v_pk_add_f32 v[44:45], v[44:45], v[86:87]
    v_pk_fma_f32 v[46:47], v[86:87], v[86:87], v[46:47]
    v_pk_add_f32 v[48:49], v[48:49], v[90:91]
    v_pk_fma_f32 v[50:51], v[90:91], v[90:91], v[50:51]
    v_pk_add_f32 v[52:53], v[52:53], v[94:95]
    v_pk_fma_f32 v[54:55], v[94:95], v[94:95], v[54:55]
    ds_read_b128 v[60:63], v38 offset:384
    s_waitcnt lgkmcnt(1)
    v_pk_fma_f32 v[96:97], v[56:57], v[20:21], v[96:97] op_sel_hi:[1,0,1]
    v_pk_fma_f32 v[98:99], v[58:59], v[20:21], v[98:99] op_sel_hi:[1,0,1]
    v_pk_fma_f32 v[100:101], v[56:57], v[24:25], v[100:101] op_sel_hi:[1,0,1]
    v_pk_fma_f32 v[102:103], v[58:59], v[24:25], v[102:103] op_sel_hi:[1,0,1]
    v_pk_fma_f32 v[104:105], v[56:57], v[28:29], v[104:105] op_sel_hi:[1,0,1]
    v_pk_fma_f32 v[106:107], v[58:59], v[28:29], v[106:107] op_sel_hi:[1,0,1]
    v_pk_fma_f32 v[108:109], v[56:57], v[32:33], v[108:109] op_sel_hi:[1,0,1]
    v_pk_fma_f32 v[110:111], v[58:59], v[32:33], v[110:111] op_sel_hi:[1,0,1]
    v_pk_mul_f32 v[208:209], v[96:97], v[96:97]
    v_pk_mul_f32 v[210:211], v[98:99], v[98:99]
    v_pk_mul_f32 v[212:213], v[100:101], v[100:101]
    v_pk_mul_f32 v[214:215], v[102:103], v[102:103]
    v_pk_mul_f32 v[216:217], v[104:105], v[104:105]
    v_pk_mul_f32 v[218:219], v[106:107], v[106:107]
    v_pk_mul_f32 v[220:221], v[108:109], v[108:109]
    v_pk_mul_f32 v[222:223], v[110:111], v[110:111]
    v_pk_fma_f32 v[208:209], v[208:209], v[22:23], v[22:23] op_sel:[0,1,0] op_sel_hi:[1,1,0]
    v_pk_fma_f32 v[210:211], v[210:211], v[22:23], v[22:23] op_sel:[0,1,0] op_sel_hi:[1,1,0]
    v_pk_fma_f32 v[212:213], v[212:213], v[26:27], v[26:27] op_sel:[0,1,0] op_sel_hi:[1,1,0]
    v_pk_fma_f32 v[214:215], v[214:215], v[26:27], v[26:27] op_sel:[0,1,0] op_sel_hi:[1,1,0]
    v_pk_fma_f32 v[216:217], v[216:217], v[30:31], v[30:31] op_sel:[0,1,0] op_sel_hi:[1,1,0]
    v_pk_fma_f32 v[218:219], v[218:219], v[30:31], v[30:31] op_sel:[0,1,0] op_sel_hi:[1,1,0]
    v_pk_fma_f32 v[220:221], v[220:221], v[34:35], v[34:35] op_sel:[0,1,0] op_sel_hi:[1,1,0]
    v_pk_fma_f32 v[222:223], v[222:223], v[34:35], v[34:35] op_sel:[0,1,0] op_sel_hi:[1,1,0]
    v_pk_mul_f32 v[208:209], v[208:209], v[96:97]
    v_pk_mul_f32 v[210:211], v[210:211], v[98:99]
    v_pk_mul_f32 v[212:213], v[212:213], v[100:101]
    v_pk_mul_f32 v[214:215], v[214:215], v[102:103]
    v_pk_mul_f32 v[216:217], v[216:217], v[104:105]
    v_pk_mul_f32 v[218:219], v[218:219], v[106:107]
    v_pk_mul_f32 v[220:221], v[220:221], v[108:109]
    v_pk_mul_f32 v[222:223], v[222:223], v[110:111]
    v_exp_f32 v208, v208
    v_exp_f32 v209, v209
    v_exp_f32 v210, v210
    v_exp_f32 v211, v211
    v_exp_f32 v212, v212
    v_exp_f32 v213, v213
    v_exp_f32 v214, v214
    v_exp_f32 v215, v215
    v_exp_f32 v216, v216
    v_exp_f32 v217, v217
    v_exp_f32 v218, v218
    v_exp_f32 v219, v219
    v_exp_f32 v220, v220
    v_exp_f32 v221, v221
    v_exp_f32 v222, v222
    v_exp_f32 v223, v223
    v_pk_fma_f32 v[208:209], v[208:209], v[20:21], v[20:21] op_sel:[0,1,1] op_sel_hi:[1,1,1]
    v_pk_fma_f32 v[210:211], v[210:211], v[20:21], v[20:21] op_sel:[0,1,1] op_sel_hi:[1,1,1]
    v_pk_fma_f32 v[212:213], v[212:213], v[24:25], v[24:25] op_sel:[0,1,1] op_sel_hi:[1,1,1]
    v_pk_fma_f32 v[214:215], v[214:215], v[24:25], v[24:25] op_sel:[0,1,1] op_sel_hi:[1,1,1]
    v_pk_fma_f32 v[216:217], v[216:217], v[28:29], v[28:29] op_sel:[0,1,1] op_sel_hi:[1,1,1]
    v_pk_fma_f32 v[218:219], v[218:219], v[28:29], v[28:29] op_sel:[0,1,1] op_sel_hi:[1,1,1]
    v_pk_fma_f32 v[220:221], v[220:221], v[32:33], v[32:33] op_sel:[0,1,1] op_sel_hi:[1,1,1]
    v_pk_fma_f32 v[222:223], v[222:223], v[32:33], v[32:33] op_sel:[0,1,1] op_sel_hi:[1,1,1]
    v_rcp_f32 v208, v208
    v_rcp_f32 v209, v209
    v_rcp_f32 v210, v210
    v_rcp_f32 v211, v211
    v_rcp_f32 v212, v212
    v_rcp_f32 v213, v213
    v_rcp_f32 v214, v214
    v_rcp_f32 v215, v215
    v_rcp_f32 v216, v216
    v_rcp_f32 v217, v217
    v_rcp_f32 v218, v218
    v_rcp_f32 v219, v219
    v_rcp_f32 v220, v220
    v_rcp_f32 v221, v221
    v_rcp_f32 v222, v222
    v_rcp_f32 v223, v223
    v_pk_mul_f32 v[96:97], v[96:97], v[208:209]
    v_pk_mul_f32 v[98:99], v[98:99], v[210:211]
    v_pk_mul_f32 v[100:101], v[100:101], v[212:213]
    v_pk_mul_f32 v[102:103], v[102:103], v[214:215]
    v_pk_mul_f32 v[104:105], v[104:105], v[216:217]
    v_pk_mul_f32 v[106:107], v[106:107], v[218:219]
    v_pk_mul_f32 v[108:109], v[108:109], v[220:221]
    v_pk_mul_f32 v[110:111], v[110:111], v[222:223]
    v_pk_add_f32 v[40:41], v[40:41], v[96:97]
    v_pk_fma_f32 v[42:43], v[96:97], v[96:97], v[42:43]
    v_pk_add_f32 v[44:45], v[44:45], v[100:101]
    v_pk_fma_f32 v[46:47], v[100:101], v[100:101], v[46:47]
    v_pk_add_f32 v[48:49], v[48:49], v[104:105]
    v_pk_fma_f32 v[50:51], v[104:105], v[104:105], v[50:51]
    v_pk_add_f32 v[52:53], v[52:53], v[108:109]
    v_pk_fma_f32 v[54:55], v[108:109], v[108:109], v[54:55]
    v_pk_add_f32 v[40:41], v[40:41], v[98:99]
    v_pk_fma_f32 v[42:43], v[98:99], v[98:99], v[42:43]
    v_pk_add_f32 v[44:45], v[44:45], v[102:103]
    v_pk_fma_f32 v[46:47], v[102:103], v[102:103], v[46:47]
    v_pk_add_f32 v[48:49], v[48:49], v[106:107]
    v_pk_fma_f32 v[50:51], v[106:107], v[106:107], v[50:51]
    v_pk_add_f32 v[52:53], v[52:53], v[110:111]
    v_pk_fma_f32 v[54:55], v[110:111], v[110:111], v[54:55]
    ds_read_b128 v[56:59], v38 offset:512
    s_waitcnt lgkmcnt(1)
    v_pk_fma_f32 v[112:113], v[60:61], v[20:21], v[112:113] op_sel_hi:[1,0,1]
    v_pk_fma_f32 v[114:115], v[62:63], v[20:21], v[114:115] op_sel_hi:[1,0,1]
    v_pk_fma_f32 v[116:117], v[60:61], v[24:25], v[116:117] op_sel_hi:[1,0,1]
    v_pk_fma_f32 v[118:119], v[62:63], v[24:25], v[118:119] op_sel_hi:[1,0,1]
    v_pk_fma_f32 v[120:121], v[60:61], v[28:29], v[120:121] op_sel_hi:[1,0,1]
    v_pk_fma_f32 v[122:123], v[62:63], v[28:29], v[122:123] op_sel_hi:[1,0,1]
    v_pk_fma_f32 v[124:125], v[60:61], v[32:33], v[124:125] op_sel_hi:[1,0,1]
    v_pk_fma_f32 v[126:127], v[62:63], v[32:33], v[126:127] op_sel_hi:[1,0,1]
    v_pk_mul_f32 v[208:209], v[112:113], v[112:113]
    v_pk_mul_f32 v[210:211], v[114:115], v[114:115]
    v_pk_mul_f32 v[212:213], v[116:117], v[116:117]
    v_pk_mul_f32 v[214:215], v[118:119], v[118:119]
    v_pk_mul_f32 v[216:217], v[120:121], v[120:121]
    v_pk_mul_f32 v[218:219], v[122:123], v[122:123]
    v_pk_mul_f32 v[220:221], v[124:125], v[124:125]
    v_pk_mul_f32 v[222:223], v[126:127], v[126:127]
    v_pk_fma_f32 v[208:209], v[208:209], v[22:23], v[22:23] op_sel:[0,1,0] op_sel_hi:[1,1,0]
    v_pk_fma_f32 v[210:211], v[210:211], v[22:23], v[22:23] op_sel:[0,1,0] op_sel_hi:[1,1,0]
    v_pk_fma_f32 v[212:213], v[212:213], v[26:27], v[26:27] op_sel:[0,1,0] op_sel_hi:[1,1,0]
    v_pk_fma_f32 v[214:215], v[214:215], v[26:27], v[26:27] op_sel:[0,1,0] op_sel_hi:[1,1,0]
    v_pk_fma_f32 v[216:217], v[216:217], v[30:31], v[30:31] op_sel:[0,1,0] op_sel_hi:[1,1,0]
    v_pk_fma_f32 v[218:219], v[218:219], v[30:31], v[30:31] op_sel:[0,1,0] op_sel_hi:[1,1,0]
    v_pk_fma_f32 v[220:221], v[220:221], v[34:35], v[34:35] op_sel:[0,1,0] op_sel_hi:[1,1,0]
    v_pk_fma_f32 v[222:223], v[222:223], v[34:35], v[34:35] op_sel:[0,1,0] op_sel_hi:[1,1,0]
    v_pk_mul_f32 v[208:209], v[208:209], v[112:113]
    v_pk_mul_f32 v[210:211], v[210:211], v[114:115]
    v_pk_mul_f32 v[212:213], v[212:213], v[116:117]
    v_pk_mul_f32 v[214:215], v[214:215], v[118:119]
    v_pk_mul_f32 v[216:217], v[216:217], v[120:121]
    v_pk_mul_f32 v[218:219], v[218:219], v[122:123]
    v_pk_mul_f32 v[220:221], v[220:221], v[124:125]
    v_pk_mul_f32 v[222:223], v[222:223], v[126:127]
    v_exp_f32 v208, v208
    v_exp_f32 v209, v209
    v_exp_f32 v210, v210
    v_exp_f32 v211, v211
    v_exp_f32 v212, v212
    v_exp_f32 v213, v213
    v_exp_f32 v214, v214
    v_exp_f32 v215, v215
    v_exp_f32 v216, v216
    v_exp_f32 v217, v217
    v_exp_f32 v218, v218
    v_exp_f32 v219, v219
    v_exp_f32 v220, v220
    v_exp_f32 v221, v221
    v_exp_f32 v222, v222
    v_exp_f32 v223, v223
    v_pk_fma_f32 v[208:209], v[208:209], v[20:21], v[20:21] op_sel:[0,1,1] op_sel_hi:[1,1,1]
    v_pk_fma_f32 v[210:211], v[210:211], v[20:21], v[20:21] op_sel:[0,1,1] op_sel_hi:[1,1,1]
    v_pk_fma_f32 v[212:213], v[212:213], v[24:25], v[24:25] op_sel:[0,1,1] op_sel_hi:[1,1,1]
    v_pk_fma_f32 v[214:215], v[214:215], v[24:25], v[24:25] op_sel:[0,1,1] op_sel_hi:[1,1,1]
    v_pk_fma_f32 v[216:217], v[216:217], v[28:29], v[28:29] op_sel:[0,1,1] op_sel_hi:[1,1,1]
    v_pk_fma_f32 v[218:219], v[218:219], v[28:29], v[28:29] op_sel:[0,1,1] op_sel_hi:[1,1,1]
    v_pk_fma_f32 v[220:221], v[220:221], v[32:33], v[32:33] op_sel:[0,1,1] op_sel_hi:[1,1,1]
    v_pk_fma_f32 v[222:223], v[222:223], v[32:33], v[32:33] op_sel:[0,1,1] op_sel_hi:[1,1,1]
    v_rcp_f32 v208, v208
    v_rcp_f32 v209, v209
    v_rcp_f32 v210, v210
    v_rcp_f32 v211, v211
    v_rcp_f32 v212, v212
    v_rcp_f32 v213, v213
    v_rcp_f32 v214, v214
    v_rcp_f32 v215, v215
    v_rcp_f32 v216, v216
    v_rcp_f32 v217, v217
    v_rcp_f32 v218, v218
    v_rcp_f32 v219, v219
    v_rcp_f32 v220, v220
    v_rcp_f32 v221, v221
    v_rcp_f32 v222, v222
    v_rcp_f32 v223, v223
    v_pk_mul_f32 v[112:113], v[112:113], v[208:209]
    v_pk_mul_f32 v[114:115], v[114:115], v[210:211]
    v_pk_mul_f32 v[116:117], v[116:117], v[212:213]
    v_pk_mul_f32 v[118:119], v[118:119], v[214:215]
    v_pk_mul_f32 v[120:121], v[120:121], v[216:217]
    v_pk_mul_f32 v[122:123], v[122:123], v[218:219]
    v_pk_mul_f32 v[124:125], v[124:125], v[220:221]
    v_pk_mul_f32 v[126:127], v[126:127], v[222:223]
    s_cmp_eq_u32 s31, 0
    s_cbranch_scc1 LD_ns
    v_pk_add_f32 v[40:41], v[40:41], v[112:113]
    v_pk_fma_f32 v[42:43], v[112:113], v[112:113], v[42:43]
    v_pk_add_f32 v[44:45], v[44:45], v[116:117]
    v_pk_fma_f32 v[46:47], v[116:117], v[116:117], v[46:47]
    v_pk_add_f32 v[48:49], v[48:49], v[120:121]
    v_pk_fma_f32 v[50:51], v[120:121], v[120:121], v[50:51]
    v_pk_add_f32 v[52:53], v[52:53], v[124:125]
    v_pk_fma_f32 v[54:55], v[124:125], v[124:125], v[54:55]
    v_pk_add_f32 v[40:41], v[40:41], v[114:115]
    v_pk_fma_f32 v[42:43], v[114:115], v[114:115], v[42:43]
    v_pk_add_f32 v[44:45], v[44:45], v[118:119]
    v_pk_fma_f32 v[46:47], v[118:119], v[118:119], v[46:47]
    v_pk_add_f32 v[48:49], v[48:49], v[122:123]
    v_pk_fma_f32 v[50:51], v[122:123], v[122:123], v[50:51]
    v_pk_add_f32 v[52:53], v[52:53], v[126:127]
    v_pk_fma_f32 v[54:55], v[126:127], v[126:127], v[54:55]
LD_ns:
    v_add_f32 v40, v40, v41
    v_add_f32 v42, v42, v43
    v_add_f32 v44, v44, v45
    v_add_f32 v46, v46, v47
    v_add_f32 v48, v48, v49
    v_add_f32 v50, v50, v51
    v_add_f32 v52, v52, v53
    v_add_f32 v54, v54, v55
    s_lshl_b32 s55, s3, 8
    s_add_u32 s55, s55, 159744
    s_cmp_eq_u32 s34, 0
    s_cselect_b64 vcc, -1, 0
    v_permlane32_swap_b32 v40, v42
    v_permlane32_swap_b32 v44, v46
    v_permlane32_swap_b32 v48, v50
    v_permlane32_swap_b32 v52, v54
    v_lshl_add_u32 v36, v0, 2, s55
    v_add_f32 v40, v40, v42
    v_add_f32 v44, v44, v46
    v_add_f32 v48, v48, v50
    v_add_f32 v52, v52, v54
    v_xor_b32 v37, 0x100, v36
    s_lshl_b32 s55, s29, 8
    v_permlane16_swap_b32 v40, v44
    v_permlane16_swap_b32 v48, v52
    s_lshl_b32 s54, s34, 12
    v_add_f32 v40, v40, v44
    v_add_f32 v48, v48, v52
    s_add_u32 s55, s55, s54
    v_cndmask_b32 v41, v40, v48, vcc
    v_cndmask_b32 v40, v48, v40, vcc
    v_min_u32 v41, -2, v41
    ds_write_b32 v36, v41
    s_add_u32 s55, s55, s53
    s_mov_b32 s54, 4800000
LD_px:
    ds_read_b32 v42, v37
    s_sub_u32 s54, s54, 1
    s_waitcnt lgkmcnt(0)
    s_cbranch_scc1 LD_pxx
    v_cmp_eq_u32 vcc, -1, v42
    s_nop 0
    s_cmp_lg_u64 vcc, 0
    s_cbranch_scc1 LD_px
LD_pxx:
    v_add_f32 v40, v40, v42
    v_min_u32 v40, -2, v40
    buffer_store_dword v40, v17, s[4:7], s55 offen sc1
    ds_read_b128 v[60:63], v38 offset:640
    s_waitcnt lgkmcnt(1)
    v_pk_fma_f32 v[128:129], v[56:57], v[20:21], v[128:129] op_sel_hi:[1,0,1]
    v_pk_fma_f32 v[130:131], v[58:59], v[20:21], v[130:131] op_sel_hi:[1,0,1]
    v_pk_fma_f32 v[132:133], v[56:57], v[24:25], v[132:133] op_sel_hi:[1,0,1]
    v_pk_fma_f32 v[134:135], v[58:59], v[24:25], v[134:135] op_sel_hi:[1,0,1]
    v_pk_fma_f32 v[136:137], v[56:57], v[28:29], v[136:137] op_sel_hi:[1,0,1]
    v_pk_fma_f32 v[138:139], v[58:59], v[28:29], v[138:139] op_sel_hi:[1,0,1]
    v_pk_fma_f32 v[140:141], v[56:57], v[32:33], v[140:141] op_sel_hi:[1,0,1]
    v_pk_fma_f32 v[142:143], v[58:59], v[32:33], v[142:143] op_sel_hi:[1,0,1]
    v_pk_mul_f32 v[208:209], v[128:129], v[128:129]
    v_pk_mul_f32 v[210:211], v[130:131], v[130:131]
    v_pk_mul_f32 v[212:213], v[132:133], v[132:133]
    v_pk_mul_f32 v[214:215], v[134:135], v[134:135]
    v_pk_mul_f32 v[216:217], v[136:137], v[136:137]
    v_pk_mul_f32 v[218:219], v[138:139], v[138:139]
    v_pk_mul_f32 v[220:221], v[140:141], v[140:141]
    v_pk_mul_f32 v[222:223], v[142:143], v[142:143]
    v_pk_fma_f32 v[208:209], v[208:209], v[22:23], v[22:23] op_sel:[0,1,0] op_sel_hi:[1,1,0]
    v_pk_fma_f32 v[210:211], v[210:211], v[22:23], v[22:23] op_sel:[0,1,0] op_sel_hi:[1,1,0]
    v_pk_fma_f32 v[212:213], v[212:213], v[26:27], v[26:27] op_sel:[0,1,0] op_sel_hi:[1,1,0]
    v_pk_fma_f32 v[214:215], v[214:215], v[26:27], v[26:27] op_sel:[0,1,0] op_sel_hi:[1,1,0]
    v_pk_fma_f32 v[216:217], v[216:217], v[30:31], v[30:31] op_sel:[0,1,0] op_sel_hi:[1,1,0]
    v_pk_fma_f32 v[218:219], v[218:219], v[30:31], v[30:31] op_sel:[0,1,0] op_sel_hi:[1,1,0]
    v_pk_fma_f32 v[220:221], v[220:221], v[34:35], v[34:35] op_sel:[0,1,0] op_sel_hi:[1,1,0]
    v_pk_fma_f32 v[222:223], v[222:223], v[34:35], v[34:35] op_sel:[0,1,0] op_sel_hi:[1,1,0]
    v_pk_mul_f32 v[208:209], v[208:209], v[128:129]
    v_pk_mul_f32 v[210:211], v[210:211], v[130:131]
    v_pk_mul_f32 v[212:213], v[212:213], v[132:133]
    v_pk_mul_f32 v[214:215], v[214:215], v[134:135]
    v_pk_mul_f32 v[216:217], v[216:217], v[136:137]
    v_pk_mul_f32 v[218:219], v[218:219], v[138:139]
    v_pk_mul_f32 v[220:221], v[220:221], v[140:141]
    v_pk_mul_f32 v[222:223], v[222:223], v[142:143]
    v_exp_f32 v208, v208
    v_exp_f32 v209, v209
    v_exp_f32 v210, v210
    v_exp_f32 v211, v211
    v_exp_f32 v212, v212
    v_exp_f32 v213, v213
    v_exp_f32 v214, v214
    v_exp_f32 v215, v215
    v_exp_f32 v216, v216
    v_exp_f32 v217, v217
    v_exp_f32 v218, v218
    v_exp_f32 v219, v219
    v_exp_f32 v220, v220
    v_exp_f32 v221, v221
    v_exp_f32 v222, v222
    v_exp_f32 v223, v223
    v_pk_fma_f32 v[208:209], v[208:209], v[20:21], v[20:21] op_sel:[0,1,1] op_sel_hi:[1,1,1]
    v_pk_fma_f32 v[210:211], v[210:211], v[20:21], v[20:21] op_sel:[0,1,1] op_sel_hi:[1,1,1]
    v_pk_fma_f32 v[212:213], v[212:213], v[24:25], v[24:25] op_sel:[0,1,1] op_sel_hi:[1,1,1]
    v_pk_fma_f32 v[214:215], v[214:215], v[24:25], v[24:25] op_sel:[0,1,1] op_sel_hi:[1,1,1]
    v_pk_fma_f32 v[216:217], v[216:217], v[28:29], v[28:29] op_sel:[0,1,1] op_sel_hi:[1,1,1]
    v_pk_fma_f32 v[218:219], v[218:219], v[28:29], v[28:29] op_sel:[0,1,1] op_sel_hi:[1,1,1]
    v_pk_fma_f32 v[220:221], v[220:221], v[32:33], v[32:33] op_sel:[0,1,1] op_sel_hi:[1,1,1]
    v_pk_fma_f32 v[222:223], v[222:223], v[32:33], v[32:33] op_sel:[0,1,1] op_sel_hi:[1,1,1]
    v_rcp_f32 v208, v208
    v_rcp_f32 v209, v209
    v_rcp_f32 v210, v210
    v_rcp_f32 v211, v211
    v_rcp_f32 v212, v212
    v_rcp_f32 v213, v213
    v_rcp_f32 v214, v214
    v_rcp_f32 v215, v215
    v_rcp_f32 v216, v216
    v_rcp_f32 v217, v217
    v_rcp_f32 v218, v218
    v_rcp_f32 v219, v219
    v_rcp_f32 v220, v220
    v_rcp_f32 v221, v221
    v_rcp_f32 v222, v222
    v_rcp_f32 v223, v223
    v_pk_mul_f32 v[128:129], v[128:129], v[208:209]
    v_pk_mul_f32 v[130:131], v[130:131], v[210:211]
    v_pk_mul_f32 v[132:133], v[132:133], v[212:213]
    v_pk_mul_f32 v[134:135], v[134:135], v[214:215]
    v_pk_mul_f32 v[136:137], v[136:137], v[216:217]
    v_pk_mul_f32 v[138:139], v[138:139], v[218:219]
    v_pk_mul_f32 v[140:141], v[140:141], v[220:221]
    v_pk_mul_f32 v[142:143], v[142:143], v[222:223]
    v_cvt_pk_bf16_f32 v224, v128, v129
    v_cvt_pk_bf16_f32 v225, v130, v131
    v_cvt_pk_bf16_f32 v226, v132, v133
    v_cvt_pk_bf16_f32 v227, v134, v135
    v_cvt_pk_bf16_f32 v228, v136, v137
    v_cvt_pk_bf16_f32 v229, v138, v139
    v_cvt_pk_bf16_f32 v230, v140, v141
    v_cvt_pk_bf16_f32 v231, v142, v143
    ds_read_b128 v[56:59], v38 offset:768
    s_waitcnt lgkmcnt(1)
    v_pk_fma_f32 v[144:145], v[60:61], v[20:21], v[144:145] op_sel_hi:[1,0,1]
    v_pk_fma_f32 v[146:147], v[62:63], v[20:21], v[146:147] op_sel_hi:[1,0,1]
    v_pk_fma_f32 v[148:149], v[60:61], v[24:25], v[148:149] op_sel_hi:[1,0,1]
    v_pk_fma_f32 v[150:151], v[62:63], v[24:25], v[150:151] op_sel_hi:[1,0,1]
    v_pk_fma_f32 v[152:153], v[60:61], v[28:29], v[152:153] op_sel_hi:[1,0,1]
    v_pk_fma_f32 v[154:155], v[62:63], v[28:29], v[154:155] op_sel_hi:[1,0,1]
    v_pk_fma_f32 v[156:157], v[60:61], v[32:33], v[156:157] op_sel_hi:[1,0,1]
    v_pk_fma_f32 v[158:159], v[62:63], v[32:33], v[158:159] op_sel_hi:[1,0,1]
    v_pk_mul_f32 v[208:209], v[144:145], v[144:145]
    v_pk_mul_f32 v[210:211], v[146:147], v[146:147]
    v_pk_mul_f32 v[212:213], v[148:149], v[148:149]
    v_pk_mul_f32 v[214:215], v[150:151], v[150:151]
    v_pk_mul_f32 v[216:217], v[152:153], v[152:153]
    v_pk_mul_f32 v[218:219], v[154:155], v[154:155]
    v_pk_mul_f32 v[220:221], v[156:157], v[156:157]
    v_pk_mul_f32 v[222:223], v[158:159], v[158:159]
    v_pk_fma_f32 v[208:209], v[208:209], v[22:23], v[22:23] op_sel:[0,1,0] op_sel_hi:[1,1,0]
    v_pk_fma_f32 v[210:211], v[210:211], v[22:23], v[22:23] op_sel:[0,1,0] op_sel_hi:[1,1,0]
    v_pk_fma_f32 v[212:213], v[212:213], v[26:27], v[26:27] op_sel:[0,1,0] op_sel_hi:[1,1,0]
    v_pk_fma_f32 v[214:215], v[214:215], v[26:27], v[26:27] op_sel:[0,1,0] op_sel_hi:[1,1,0]
    v_pk_fma_f32 v[216:217], v[216:217], v[30:31], v[30:31] op_sel:[0,1,0] op_sel_hi:[1,1,0]
    v_pk_fma_f32 v[218:219], v[218:219], v[30:31], v[30:31] op_sel:[0,1,0] op_sel_hi:[1,1,0]
    v_pk_fma_f32 v[220:221], v[220:221], v[34:35], v[34:35] op_sel:[0,1,0] op_sel_hi:[1,1,0]
    v_pk_fma_f32 v[222:223], v[222:223], v[34:35], v[34:35] op_sel:[0,1,0] op_sel_hi:[1,1,0]
    v_pk_mul_f32 v[208:209], v[208:209], v[144:145]
    v_pk_mul_f32 v[210:211], v[210:211], v[146:147]
    v_pk_mul_f32 v[212:213], v[212:213], v[148:149]
    v_pk_mul_f32 v[214:215], v[214:215], v[150:151]
    v_pk_mul_f32 v[216:217], v[216:217], v[152:153]
    v_pk_mul_f32 v[218:219], v[218:219], v[154:155]
    v_pk_mul_f32 v[220:221], v[220:221], v[156:157]
    v_pk_mul_f32 v[222:223], v[222:223], v[158:159]
    v_exp_f32 v208, v208
    v_exp_f32 v209, v209
    v_exp_f32 v210, v210
    v_exp_f32 v211, v211
    v_exp_f32 v212, v212
    v_exp_f32 v213, v213
    v_exp_f32 v214, v214
    v_exp_f32 v215, v215
    v_exp_f32 v216, v216
    v_exp_f32 v217, v217
    v_exp_f32 v218, v218
    v_exp_f32 v219, v219
    v_exp_f32 v220, v220
    v_exp_f32 v221, v221
    v_exp_f32 v222, v222
    v_exp_f32 v223, v223
    v_pk_fma_f32 v[208:209], v[208:209], v[20:21], v[20:21] op_sel:[0,1,1] op_sel_hi:[1,1,1]
    v_pk_fma_f32 v[210:211], v[210:211], v[20:21], v[20:21] op_sel:[0,1,1] op_sel_hi:[1,1,1]
    v_pk_fma_f32 v[212:213], v[212:213], v[24:25], v[24:25] op_sel:[0,1,1] op_sel_hi:[1,1,1]
    v_pk_fma_f32 v[214:215], v[214:215], v[24:25], v[24:25] op_sel:[0,1,1] op_sel_hi:[1,1,1]
    v_pk_fma_f32 v[216:217], v[216:217], v[28:29], v[28:29] op_sel:[0,1,1] op_sel_hi:[1,1,1]
    v_pk_fma_f32 v[218:219], v[218:219], v[28:29], v[28:29] op_sel:[0,1,1] op_sel_hi:[1,1,1]
    v_pk_fma_f32 v[220:221], v[220:221], v[32:33], v[32:33] op_sel:[0,1,1] op_sel_hi:[1,1,1]
    v_pk_fma_f32 v[222:223], v[222:223], v[32:33], v[32:33] op_sel:[0,1,1] op_sel_hi:[1,1,1]
    v_rcp_f32 v208, v208
    v_rcp_f32 v209, v209
    v_rcp_f32 v210, v210
    v_rcp_f32 v211, v211
    v_rcp_f32 v212, v212
    v_rcp_f32 v213, v213
    v_rcp_f32 v214, v214
    v_rcp_f32 v215, v215
    v_rcp_f32 v216, v216
    v_rcp_f32 v217, v217
    v_rcp_f32 v218, v218
    v_rcp_f32 v219, v219
    v_rcp_f32 v220, v220
    v_rcp_f32 v221, v221
    v_rcp_f32 v222, v222
    v_rcp_f32 v223, v223
    v_pk_mul_f32 v[144:145], v[144:145], v[208:209]
    v_pk_mul_f32 v[146:147], v[146:147], v[210:211]
    v_pk_mul_f32 v[148:149], v[148:149], v[212:213]
    v_pk_mul_f32 v[150:151], v[150:151], v[214:215]
    v_pk_mul_f32 v[152:153], v[152:153], v[216:217]
    v_pk_mul_f32 v[154:155], v[154:155], v[218:219]
    v_pk_mul_f32 v[156:157], v[156:157], v[220:221]
    v_pk_mul_f32 v[158:159], v[158:159], v[222:223]
    v_cvt_pk_bf16_f32 v232, v144, v145
    v_cvt_pk_bf16_f32 v233, v146, v147
    v_cvt_pk_bf16_f32 v234, v148, v149
    v_cvt_pk_bf16_f32 v235, v150, v151
    v_cvt_pk_bf16_f32 v236, v152, v153
    v_cvt_pk_bf16_f32 v237, v154, v155
    v_cvt_pk_bf16_f32 v238, v156, v157
    v_cvt_pk_bf16_f32 v239, v158, v159
    s_mov_b32 s55, 300000
LD_poll:
    buffer_load_dwordx2 v[176:177], v16, s[4:7], s53 offen offset:0 sc1
    buffer_load_dwordx2 v[178:179], v16, s[4:7], s53 offen offset:256 sc1
    buffer_load_dwordx2 v[180:181], v16, s[4:7], s53 offen offset:512 sc1
    buffer_load_dwordx2 v[182:183], v16, s[4:7], s53 offen offset:768 sc1
    buffer_load_dwordx2 v[184:185], v16, s[4:7], s53 offen offset:1024 sc1
    buffer_load_dwordx2 v[186:187], v16, s[4:7], s53 offen offset:1280 sc1
    buffer_load_dwordx2 v[188:189], v16, s[4:7], s53 offen offset:1536 sc1
    buffer_load_dwordx2 v[190:191], v16, s[4:7], s53 offen offset:1792 sc1
    buffer_load_dwordx2 v[192:193], v16, s[4:7], s53 offen offset:2048 sc1
    buffer_load_dwordx2 v[194:195], v16, s[4:7], s53 offen offset:2304 sc1
    buffer_load_dwordx2 v[196:197], v16, s[4:7], s53 offen offset:2560 sc1
    buffer_load_dwordx2 v[198:199], v16, s[4:7], s53 offen offset:2816 sc1
    buffer_load_dwordx2 v[200:201], v16, s[4:7], s53 offen offset:3072 sc1
    buffer_load_dwordx2 v[202:203], v16, s[4:7], s53 offen offset:3328 sc1
    buffer_load_dwordx2 v[204:205], v16, s[4:7], s53 offen offset:3584 sc1
    buffer_load_dwordx2 v[206:207], v16, s[4:7], s53 offen offset:3840 sc1
LD_chk:
    s_sub_u32 s55, s55, 1
    s_waitcnt vmcnt(0)
    s_cbranch_scc1 LD_go
    v_max_u32 v48, v176, v177
    v_max_u32 v49, v192, v193
    v_max3_u32 v48, v48, v178, v179
    v_max3_u32 v49, v49, v194, v195
    v_max3_u32 v48, v48, v180, v181
    v_max3_u32 v49, v49, v196, v197
    v_max3_u32 v48, v48, v182, v183
    v_max3_u32 v49, v49, v198, v199
    v_max3_u32 v48, v48, v184, v185
    v_max3_u32 v49, v49, v200, v201
    v_max3_u32 v48, v48, v186, v187
    v_max3_u32 v49, v49, v202, v203
    v_max3_u32 v48, v48, v188, v189
    v_max3_u32 v49, v49, v204, v205
    v_max3_u32 v48, v48, v190, v191
    v_max3_u32 v49, v49, v206, v207
    v_max_u32 v48, v48, v49
    v_cmp_eq_u32 vcc, -1, v48
    s_nop 0
    s_cmp_lg_u64 vcc, 0
    s_cbranch_scc1 LD_poll
LD_go:
    v_pk_add_f32 v[176:177], v[176:177], v[178:179]
    v_pk_add_f32 v[180:181], v[180:181], v[182:183]
    v_pk_add_f32 v[184:185], v[184:185], v[186:187]
    v_pk_add_f32 v[188:189], v[188:189], v[190:191]
    v_pk_add_f32 v[192:193], v[192:193], v[194:195]
    v_pk_add_f32 v[196:197], v[196:197], v[198:199]
    v_pk_add_f32 v[200:201], v[200:201], v[202:203]
    v_pk_add_f32 v[204:205], v[204:205], v[206:207]
    v_pk_add_f32 v[176:177], v[176:177], v[180:181]
    v_pk_add_f32 v[184:185], v[184:185], v[188:189]
    v_pk_add_f32 v[192:193], v[192:193], v[196:197]
    v_pk_add_f32 v[200:201], v[200:201], v[204:205]
    v_pk_add_f32 v[176:177], v[176:177], v[184:185]
    v_pk_add_f32 v[192:193], v[192:193], v[200:201]
    v_pk_add_f32 v[176:177], v[176:177], v[192:193]
    v_mov_b32 v40, v176
    v_mov_b32 v41, v177
    v_mul_f32 v40, 0x3a124925, v40
    v_mul_f32 v36, v40, v40
    v_mov_b32 v37, 0x3a124925
    v_fma_f32 v41, v41, v37, -v36
    v_max_f32 v41, 0, v41
    v_cvt_pk_bf16_f32 v41, v41, v41
    v_lshlrev_b32 v41, 16, v41
    v_add_f32 v41, 0x3727c5ac, v41
    v_cvt_pk_bf16_f32 v41, v41, v41
    v_lshlrev_b32 v41, 16, v41
    v_sqrt_f32 v41, v41
    v_cvt_pk_bf16_f32 v40, v40, v40
    v_lshlrev_b32 v40, 16, v40
    v_cvt_pk_bf16_f32 v41, v41, v41
    v_lshlrev_b32 v41, 16, v41
    v_rcp_f32 v41, v41
    s_nop 0
    v_mul_f32 v40, v40, v41
    v_sub_f32 v40, 0, v40
    v_mov_b32 v45, v41
    v_mov_b32 v44, v40
    s_nop 0
    v_permlane32_swap_b32 v41, v45
    v_permlane32_swap_b32 v40, v44
    s_nop 0
    v_mov_b32 v43, v41
    v_mov_b32 v47, v45
    v_mov_b32 v42, v40
    v_mov_b32 v46, v44
    v_permlane16_swap_b32 v41, v43
    v_permlane16_swap_b32 v45, v47
    v_permlane16_swap_b32 v40, v42
    v_permlane16_swap_b32 v44, v46
    s_nop 0
    v_pk_fma_f32 v[64:65], v[64:65], v[40:41], v[40:41] op_sel:[0,1,0] op_sel_hi:[1,1,0]
    v_pk_fma_f32 v[66:67], v[66:67], v[40:41], v[40:41] op_sel:[0,1,0] op_sel_hi:[1,1,0]
    v_pk_fma_f32 v[68:69], v[68:69], v[42:43], v[42:43] op_sel:[0,1,0] op_sel_hi:[1,1,0]
    v_pk_fma_f32 v[70:71], v[70:71], v[42:43], v[42:43] op_sel:[0,1,0] op_sel_hi:[1,1,0]
    v_pk_fma_f32 v[72:73], v[72:73], v[44:45], v[44:45] op_sel:[0,1,0] op_sel_hi:[1,1,0]
    v_pk_fma_f32 v[74:75], v[74:75], v[44:45], v[44:45] op_sel:[0,1,0] op_sel_hi:[1,1,0]
    v_pk_fma_f32 v[76:77], v[76:77], v[46:47], v[46:47] op_sel:[0,1,0] op_sel_hi:[1,1,0]
    v_pk_fma_f32 v[78:79], v[78:79], v[46:47], v[46:47] op_sel:[0,1,0] op_sel_hi:[1,1,0]
    v_cvt_pk_bf16_f32 v176, v64, v65
    v_cvt_pk_bf16_f32 v177, v66, v67
    v_cvt_pk_bf16_f32 v178, v68, v69
    v_cvt_pk_bf16_f32 v179, v70, v71
    v_cvt_pk_bf16_f32 v180, v72, v73
    v_cvt_pk_bf16_f32 v181, v74, v75
    v_cvt_pk_bf16_f32 v182, v76, v77
    v_cvt_pk_bf16_f32 v183, v78, v79
    v_permlane16_swap_b32 v176, v178
    v_permlane16_swap_b32 v177, v179
    v_permlane16_swap_b32 v180, v182
    v_permlane16_swap_b32 v181, v183
    buffer_store_dwordx4 v[176:179], v18, s[4:7], s44 offen sc1
    buffer_store_dwordx4 v[180:183], v19, s[4:7], s44 offen sc1
    v_pk_fma_f32 v[80:81], v[80:81], v[40:41], v[40:41] op_sel:[0,1,0] op_sel_hi:[1,1,0]
    v_pk_fma_f32 v[82:83], v[82:83], v[40:41], v[40:41] op_sel:[0,1,0] op_sel_hi:[1,1,0]
    v_pk_fma_f32 v[84:85], v[84:85], v[42:43], v[42:43] op_sel:[0,1,0] op_sel_hi:[1,1,0]
    v_pk_fma_f32 v[86:87], v[86:87], v[42:43], v[42:43] op_sel:[0,1,0] op_sel_hi:[1,1,0]
    v_pk_fma_f32 v[88:89], v[88:89], v[44:45], v[44:45] op_sel:[0,1,0] op_sel_hi:[1,1,0]
    v_pk_fma_f32 v[90:91], v[90:91], v[44:45], v[44:45] op_sel:[0,1,0] op_sel_hi:[1,1,0]
    v_pk_fma_f32 v[92:93], v[92:93], v[46:47], v[46:47] op_sel:[0,1,0] op_sel_hi:[1,1,0]
    v_pk_fma_f32 v[94:95], v[94:95], v[46:47], v[46:47] op_sel:[0,1,0] op_sel_hi:[1,1,0]
    v_cvt_pk_bf16_f32 v184, v80, v81
    v_cvt_pk_bf16_f32 v185, v82, v83
    v_cvt_pk_bf16_f32 v186, v84, v85
    v_cvt_pk_bf16_f32 v187, v86, v87
    v_cvt_pk_bf16_f32 v188, v88, v89
    v_cvt_pk_bf16_f32 v189, v90, v91
    v_cvt_pk_bf16_f32 v190, v92, v93
    v_cvt_pk_bf16_f32 v191, v94, v95
    v_permlane16_swap_b32 v184, v186
    v_permlane16_swap_b32 v185, v187
    v_permlane16_swap_b32 v188, v190
    v_permlane16_swap_b32 v189, v191
    buffer_store_dwordx4 v[184:187], v18, s[4:7], s45 offen sc1
    buffer_store_dwordx4 v[188:191], v19, s[4:7], s45 offen sc1
    v_pk_fma_f32 v[96:97], v[96:97], v[40:41], v[40:41] op_sel:[0,1,0] op_sel_hi:[1,1,0]
    v_pk_fma_f32 v[98:99], v[98:99], v[40:41], v[40:41] op_sel:[0,1,0] op_sel_hi:[1,1,0]
    v_pk_fma_f32 v[100:101], v[100:101], v[42:43], v[42:43] op_sel:[0,1,0] op_sel_hi:[1,1,0]
    v_pk_fma_f32 v[102:103], v[102:103], v[42:43], v[42:43] op_sel:[0,1,0] op_sel_hi:[1,1,0]
    v_pk_fma_f32 v[104:105], v[104:105], v[44:45], v[44:45] op_sel:[0,1,0] op_sel_hi:[1,1,0]
    v_pk_fma_f32 v[106:107], v[106:107], v[44:45], v[44:45] op_sel:[0,1,0] op_sel_hi:[1,1,0]
    v_pk_fma_f32 v[108:109], v[108:109], v[46:47], v[46:47] op_sel:[0,1,0] op_sel_hi:[1,1,0]
    v_pk_fma_f32 v[110:111], v[110:111], v[46:47], v[46:47] op_sel:[0,1,0] op_sel_hi:[1,1,0]
    v_cvt_pk_bf16_f32 v192, v96, v97
    v_cvt_pk_bf16_f32 v193, v98, v99
    v_cvt_pk_bf16_f32 v194, v100, v101
    v_cvt_pk_bf16_f32 v195, v102, v103
    v_cvt_pk_bf16_f32 v196, v104, v105
    v_cvt_pk_bf16_f32 v197, v106, v107
    v_cvt_pk_bf16_f32 v198, v108, v109
    v_cvt_pk_bf16_f32 v199, v110, v111
    v_permlane16_swap_b32 v192, v194
    v_permlane16_swap_b32 v193, v195
    v_permlane16_swap_b32 v196, v198
    v_permlane16_swap_b32 v197, v199
    buffer_store_dwordx4 v[192:195], v18, s[4:7], s46 offen sc1
    buffer_store_dwordx4 v[196:199], v19, s[4:7], s46 offen sc1
    s_cmp_eq_u32 s31, 0
    s_cbranch_scc1 LD_nn
    v_pk_fma_f32 v[112:113], v[112:113], v[40:41], v[40:41] op_sel:[0,1,0] op_sel_hi:[1,1,0]
    v_pk_fma_f32 v[114:115], v[114:115], v[40:41], v[40:41] op_sel:[0,1,0] op_sel_hi:[1,1,0]
    v_pk_fma_f32 v[116:117], v[116:117], v[42:43], v[42:43] op_sel:[0,1,0] op_sel_hi:[1,1,0]
    v_pk_fma_f32 v[118:119], v[118:119], v[42:43], v[42:43] op_sel:[0,1,0] op_sel_hi:[1,1,0]
    v_pk_fma_f32 v[120:121], v[120:121], v[44:45], v[44:45] op_sel:[0,1,0] op_sel_hi:[1,1,0]
    v_pk_fma_f32 v[122:123], v[122:123], v[44:45], v[44:45] op_sel:[0,1,0] op_sel_hi:[1,1,0]
    v_pk_fma_f32 v[124:125], v[124:125], v[46:47], v[46:47] op_sel:[0,1,0] op_sel_hi:[1,1,0]
    v_pk_fma_f32 v[126:127], v[126:127], v[46:47], v[46:47] op_sel:[0,1,0] op_sel_hi:[1,1,0]
LD_nn:
    v_cvt_pk_bf16_f32 v200, v112, v113
    v_cvt_pk_bf16_f32 v201, v114, v115
    v_cvt_pk_bf16_f32 v202, v116, v117
    v_cvt_pk_bf16_f32 v203, v118, v119
    v_cvt_pk_bf16_f32 v204, v120, v121
    v_cvt_pk_bf16_f32 v205, v122, v123
    v_cvt_pk_bf16_f32 v206, v124, v125
    v_cvt_pk_bf16_f32 v207, v126, v127
    v_permlane16_swap_b32 v200, v202
    v_permlane16_swap_b32 v201, v203
    v_permlane16_swap_b32 v204, v206
    v_permlane16_swap_b32 v205, v207
    buffer_store_dwordx4 v[200:203], v10, s[4:7], s47 offen sc1
    buffer_store_dwordx4 v[204:207], v11, s[4:7], s47 offen sc1
    s_waitcnt lgkmcnt(0)
    v_pk_fma_f32 v[160:161], v[56:57], v[20:21], v[160:161] op_sel_hi:[1,0,1]
    v_pk_fma_f32 v[162:163], v[58:59], v[20:21], v[162:163] op_sel_hi:[1,0,1]
    v_pk_fma_f32 v[164:165], v[56:57], v[24:25], v[164:165] op_sel_hi:[1,0,1]
    v_pk_fma_f32 v[166:167], v[58:59], v[24:25], v[166:167] op_sel_hi:[1,0,1]
    v_pk_fma_f32 v[168:169], v[56:57], v[28:29], v[168:169] op_sel_hi:[1,0,1]
    v_pk_fma_f32 v[170:171], v[58:59], v[28:29], v[170:171] op_sel_hi:[1,0,1]
    v_pk_fma_f32 v[172:173], v[56:57], v[32:33], v[172:173] op_sel_hi:[1,0,1]
    v_pk_fma_f32 v[174:175], v[58:59], v[32:33], v[174:175] op_sel_hi:[1,0,1]
    v_pk_mul_f32 v[208:209], v[160:161], v[160:161]
    v_pk_mul_f32 v[210:211], v[162:163], v[162:163]
    v_pk_mul_f32 v[212:213], v[164:165], v[164:165]
    v_pk_mul_f32 v[214:215], v[166:167], v[166:167]
    v_pk_mul_f32 v[216:217], v[168:169], v[168:169]
    v_pk_mul_f32 v[218:219], v[170:171], v[170:171]
    v_pk_mul_f32 v[220:221], v[172:173], v[172:173]
    v_pk_mul_f32 v[222:223], v[174:175], v[174:175]
    v_pk_fma_f32 v[208:209], v[208:209], v[22:23], v[22:23] op_sel:[0,1,0] op_sel_hi:[1,1,0]
    v_pk_fma_f32 v[210:211], v[210:211], v[22:23], v[22:23] op_sel:[0,1,0] op_sel_hi:[1,1,0]
    v_pk_fma_f32 v[212:213], v[212:213], v[26:27], v[26:27] op_sel:[0,1,0] op_sel_hi:[1,1,0]
    v_pk_fma_f32 v[214:215], v[214:215], v[26:27], v[26:27] op_sel:[0,1,0] op_sel_hi:[1,1,0]
    v_pk_fma_f32 v[216:217], v[216:217], v[30:31], v[30:31] op_sel:[0,1,0] op_sel_hi:[1,1,0]
    v_pk_fma_f32 v[218:219], v[218:219], v[30:31], v[30:31] op_sel:[0,1,0] op_sel_hi:[1,1,0]
    v_pk_fma_f32 v[220:221], v[220:221], v[34:35], v[34:35] op_sel:[0,1,0] op_sel_hi:[1,1,0]
    v_pk_fma_f32 v[222:223], v[222:223], v[34:35], v[34:35] op_sel:[0,1,0] op_sel_hi:[1,1,0]
    v_pk_mul_f32 v[208:209], v[208:209], v[160:161]
    v_pk_mul_f32 v[210:211], v[210:211], v[162:163]
    v_pk_mul_f32 v[212:213], v[212:213], v[164:165]
    v_pk_mul_f32 v[214:215], v[214:215], v[166:167]
    v_pk_mul_f32 v[216:217], v[216:217], v[168:169]
    v_pk_mul_f32 v[218:219], v[218:219], v[170:171]
    v_pk_mul_f32 v[220:221], v[220:221], v[172:173]
    v_pk_mul_f32 v[222:223], v[222:223], v[174:175]
    v_exp_f32 v208, v208
    v_exp_f32 v209, v209
    v_exp_f32 v210, v210
    v_exp_f32 v211, v211
    v_exp_f32 v212, v212
    v_exp_f32 v213, v213
    v_exp_f32 v214, v214
    v_exp_f32 v215, v215
    v_exp_f32 v216, v216
    v_exp_f32 v217, v217
    v_exp_f32 v218, v218
    v_exp_f32 v219, v219
    v_exp_f32 v220, v220
    v_exp_f32 v221, v221
    v_exp_f32 v222, v222
    v_exp_f32 v223, v223
    v_pk_fma_f32 v[208:209], v[208:209], v[20:21], v[20:21] op_sel:[0,1,1] op_sel_hi:[1,1,1]
    v_pk_fma_f32 v[210:211], v[210:211], v[20:21], v[20:21] op_sel:[0,1,1] op_sel_hi:[1,1,1]
    v_pk_fma_f32 v[212:213], v[212:213], v[24:25], v[24:25] op_sel:[0,1,1] op_sel_hi:[1,1,1]
    v_pk_fma_f32 v[214:215], v[214:215], v[24:25], v[24:25] op_sel:[0,1,1] op_sel_hi:[1,1,1]
    v_pk_fma_f32 v[216:217], v[216:217], v[28:29], v[28:29] op_sel:[0,1,1] op_sel_hi:[1,1,1]
    v_pk_fma_f32 v[218:219], v[218:219], v[28:29], v[28:29] op_sel:[0,1,1] op_sel_hi:[1,1,1]
    v_pk_fma_f32 v[220:221], v[220:221], v[32:33], v[32:33] op_sel:[0,1,1] op_sel_hi:[1,1,1]
    v_pk_fma_f32 v[222:223], v[222:223], v[32:33], v[32:33] op_sel:[0,1,1] op_sel_hi:[1,1,1]
    v_rcp_f32 v208, v208
    v_rcp_f32 v209, v209
    v_rcp_f32 v210, v210
    v_rcp_f32 v211, v211
    v_rcp_f32 v212, v212
    v_rcp_f32 v213, v213
    v_rcp_f32 v214, v214
    v_rcp_f32 v215, v215
    v_rcp_f32 v216, v216
    v_rcp_f32 v217, v217
    v_rcp_f32 v218, v218
    v_rcp_f32 v219, v219
    v_rcp_f32 v220, v220
    v_rcp_f32 v221, v221
    v_rcp_f32 v222, v222
    v_rcp_f32 v223, v223
    v_pk_mul_f32 v[160:161], v[160:161], v[208:209]
    v_pk_mul_f32 v[162:163], v[162:163], v[210:211]
    v_pk_mul_f32 v[164:165], v[164:165], v[212:213]
    v_pk_mul_f32 v[166:167], v[166:167], v[214:215]
    v_pk_mul_f32 v[168:169], v[168:169], v[216:217]
    v_pk_mul_f32 v[170:171], v[170:171], v[218:219]
    v_pk_mul_f32 v[172:173], v[172:173], v[220:221]
    v_pk_mul_f32 v[174:175], v[174:175], v[222:223]
    v_cvt_pk_bf16_f32 v240, v160, v161
    v_cvt_pk_bf16_f32 v241, v162, v163
    v_cvt_pk_bf16_f32 v242, v164, v165
    v_cvt_pk_bf16_f32 v243, v166, v167
    v_cvt_pk_bf16_f32 v244, v168, v169
    v_cvt_pk_bf16_f32 v245, v170, v171
    v_cvt_pk_bf16_f32 v246, v172, v173
    v_cvt_pk_bf16_f32 v247, v174, v175
    s_cmp_lg_u32 s32, 0
    s_cbranch_scc1 LE_start
    v_swap_b32 v224, v232
    v_swap_b32 v225, v233
    v_swap_b32 v226, v234
    v_swap_b32 v227, v235
    v_swap_b32 v228, v236
    v_swap_b32 v229, v237
    v_swap_b32 v230, v238
    v_swap_b32 v231, v239
    v_swap_b32 v232, v240
    v_swap_b32 v233, v241
    v_swap_b32 v234, v242
    v_swap_b32 v235, v243
    v_swap_b32 v236, v244
    v_swap_b32 v237, v245
    v_swap_b32 v238, v246
    v_swap_b32 v239, v247
LE_start:
    s_mov_b32 s51, s32
    s_xor_b32 s32, s32, s31
    s_mul_i32 s42, s30, 7
    s_lshl_b32 s29, s30, 1
    s_add_u32 s29, s29, s32
    s_mov_b32 s30, s52
    s_and_b32 s52, s3, 3
    s_cmp_lt_u32 s3, 4
    s_cbranch_scc1 LE_comp
    s_mov_b32 s12, s78
    s_and_b32 s13, s79, 0xffff
    s_mov_b32 s14, 0x800000
    s_mov_b32 s15, 0x20000
    v_lshrrev_b32 v10, 3, v0
    v_mul_u32_u24 v4, 4096, v10
    v_lshrrev_b32 v10, 4, v0
    v_and_b32 v11, 7, v0
    v_xor_b32 v10, v10, v11
    v_lshl_add_u32 v4, v10, 4, v4
    v_xor_b32 v5, 64, v4
    v_add_u32 v5, 31744, v5
    v_add_u32 v6, 63488, v4
    v_xor_b32 v7, 64, v4
    v_add_u32 v7, 95232, v7
    s_lshl_b32 s40, s30, 17
    s_and_b32 s42, s52, 1
    s_mul_i32 s41, s42, 114688
    s_mul_i32 s31, s29, 7168
    s_add_u32 s41, s41, s31
    s_lshr_b32 s31, s52, 1
    s_lshl_b32 s31, s31, 12
    s_add_u32 s41, s41, s31
    s_add_u32 s41, s41, 25165824
    s_lshl_b32 s43, s52, 12
    s_mul_i32 s38, s42, 7168
    s_add_u32 s38, s38, s31
    s_add_u32 s38, s38, 16384
    s_and_b32 s44, s2, 7
    s_mul_i32 s44, s44, 4
    s_and_b32 s44, s44, 31
    s_mov_b32 s45, s44
    s_add_u32 m0, 0x0, s43
    s_lshl_b32 s46, s44, 7
    s_add_u32 s46, s46, s40
    buffer_load_dwordx4 v4, s[12:15], s46 offen offset:0  lds
    buffer_load_dwordx4 v5, s[12:15], s46 offen offset:1024  lds
    buffer_load_dwordx4 v6, s[12:15], s46 offen offset:2048  lds
    buffer_load_dwordx4 v7, s[12:15], s46 offen offset:3072  lds
    s_add_u32 s44, s44, 1
    s_and_b32 s44, s44, 31
    s_waitcnt vmcnt(4)
    s_add_u32 m0, 0x7800, s43
    s_lshl_b32 s46, s44, 7
    s_add_u32 s46, s46, s40
    buffer_load_dwordx4 v4, s[12:15], s46 offen offset:0  lds
    buffer_load_dwordx4 v5, s[12:15], s46 offen offset:1024  lds
    buffer_load_dwordx4 v6, s[12:15], s46 offen offset:2048  lds
    buffer_load_dwordx4 v7, s[12:15], s46 offen offset:3072  lds
    s_add_u32 s44, s44, 1
    s_and_b32 s44, s44, 31
    s_waitcnt vmcnt(4)
    s_add_u32 m0, 0xf000, s43
    s_lshl_b32 s46, s44, 7
    s_add_u32 s46, s46, s40
    buffer_load_dwordx4 v4, s[12:15], s46 offen offset:0  lds
    buffer_load_dwordx4 v5, s[12:15], s46 offen offset:1024  lds
    buffer_load_dwordx4 v6, s[12:15], s46 offen offset:2048  lds
    buffer_load_dwordx4 v7, s[12:15], s46 offen offset:3072  lds
    s_add_u32 s44, s44, 1
    s_and_b32 s44, s44, 31
    s_waitcnt vmcnt(4)
    s_add_u32 m0, 0x16800, s43
    s_lshl_b32 s46, s44, 7
    s_add_u32 s46, s46, s40
    buffer_load_dwordx4 v4, s[12:15], s46 offen offset:0  lds
    buffer_load_dwordx4 v5, s[12:15], s46 offen offset:1024  lds
    buffer_load_dwordx4 v6, s[12:15], s46 offen offset:2048  lds
    buffer_load_dwordx4 v7, s[12:15], s46 offen offset:3072  lds
    s_add_u32 s44, s44, 1
    s_and_b32 s44, s44, 31
    s_waitcnt vmcnt(4)
    s_add_u32 m0, 0x1e000, s43
    s_lshl_b32 s46, s44, 7
    s_add_u32 s46, s46, s40
    buffer_load_dwordx4 v4, s[12:15], s46 offen offset:0  lds
    buffer_load_dwordx4 v5, s[12:15], s46 offen offset:1024  lds
    buffer_load_dwordx4 v6, s[12:15], s46 offen offset:2048  lds
    buffer_load_dwordx4 v7, s[12:15], s46 offen offset:3072  lds
    s_add_u32 s44, s44, 1
    s_and_b32 s44, s44, 31
    s_waitcnt vmcnt(4)
    s_lshl_b32 s33, s52, 11
    v_add_u32 v23, s33, v1
    v_add_u32 v24, 0x10000, v23
    v_add_u32 v25, 0x20000, v23
    s_barrier
    s_mov_b32 s47, s38
    s_mov_b32 s38, s47
    s_barrier
    s_cmp_ge_u32 s3, 6
    s_cbranch_scc1 LE_ld3
LE_ld4:
    s_add_u32 m0, 0x0, s38
    s_mul_i32 s46, s45, 229376
    s_add_u32 s46, s46, s41
    buffer_load_dwordx4 v1, s[4:7], s46 offen offset:0 sc1 lds
    buffer_load_dwordx4 v1, s[4:7], s46 offen offset:1024 sc1 lds
    buffer_load_dwordx4 v1, s[4:7], s46 offen offset:2048 sc1 lds
    buffer_load_dwordx4 v1, s[4:7], s46 offen offset:3072 sc1 lds
    s_add_u32 s45, s45, 1
    s_and_b32 s45, s45, 31
    s_add_u32 m0, 0x7800, s38
    s_mul_i32 s46, s45, 229376
    s_add_u32 s46, s46, s41
    buffer_load_dwordx4 v1, s[4:7], s46 offen offset:0 sc1 lds
    buffer_load_dwordx4 v1, s[4:7], s46 offen offset:1024 sc1 lds
    buffer_load_dwordx4 v1, s[4:7], s46 offen offset:2048 sc1 lds
    buffer_load_dwordx4 v1, s[4:7], s46 offen offset:3072 sc1 lds
    s_add_u32 s45, s45, 1
    s_and_b32 s45, s45, 31
    s_add_u32 m0, 0xf000, s38
    s_mul_i32 s46, s45, 229376
    s_add_u32 s46, s46, s41
    buffer_load_dwordx4 v1, s[4:7], s46 offen offset:0 sc1 lds
    buffer_load_dwordx4 v1, s[4:7], s46 offen offset:1024 sc1 lds
    buffer_load_dwordx4 v1, s[4:7], s46 offen offset:2048 sc1 lds
    buffer_load_dwordx4 v1, s[4:7], s46 offen offset:3072 sc1 lds
    s_add_u32 s45, s45, 1
    s_and_b32 s45, s45, 31
    s_add_u32 m0, 0x16800, s38
    s_mul_i32 s46, s45, 229376
    s_add_u32 s46, s46, s41
    buffer_load_dwordx4 v1, s[4:7], s46 offen offset:0 sc1 lds
    buffer_load_dwordx4 v1, s[4:7], s46 offen offset:1024 sc1 lds
    buffer_load_dwordx4 v1, s[4:7], s46 offen offset:2048 sc1 lds
    buffer_load_dwordx4 v1, s[4:7], s46 offen offset:3072 sc1 lds
    s_add_u32 s45, s45, 1
    s_and_b32 s45, s45, 31
    s_add_u32 m0, 0x1e000, s38
    s_mul_i32 s46, s45, 229376
    s_add_u32 s46, s46, s41
    buffer_load_dwordx4 v1, s[4:7], s46 offen offset:0 sc1 lds
    buffer_load_dwordx4 v1, s[4:7], s46 offen offset:1024 sc1 lds
    buffer_load_dwordx4 v1, s[4:7], s46 offen offset:2048 sc1 lds
    buffer_load_dwordx4 v1, s[4:7], s46 offen offset:3072 sc1 lds
    s_add_u32 s45, s45, 1
    s_and_b32 s45, s45, 31
    s_waitcnt vmcnt(16)
    s_barrier
    s_waitcnt vmcnt(12)
    s_barrier
    s_waitcnt vmcnt(8)
    s_barrier
    s_add_u32 m0, 0x0, s38
    s_mul_i32 s46, s45, 229376
    s_add_u32 s46, s46, s41
    buffer_load_dwordx4 v1, s[4:7], s46 offen offset:0 sc1 lds
    buffer_load_dwordx4 v1, s[4:7], s46 offen offset:1024 sc1 lds
    buffer_load_dwordx4 v1, s[4:7], s46 offen offset:2048 sc1 lds
    buffer_load_dwordx4 v1, s[4:7], s46 offen offset:3072 sc1 lds
    s_add_u32 s45, s45, 1
    s_and_b32 s45, s45, 31
    s_add_u32 m0, 0x0, s43
    s_lshl_b32 s46, s44, 7
    s_add_u32 s46, s46, s40
    buffer_load_dwordx4 v4, s[12:15], s46 offen offset:0  lds
    buffer_load_dwordx4 v5, s[12:15], s46 offen offset:1024  lds
    buffer_load_dwordx4 v6, s[12:15], s46 offen offset:2048  lds
    buffer_load_dwordx4 v7, s[12:15], s46 offen offset:3072  lds
    s_add_u32 s44, s44, 1
    s_and_b32 s44, s44, 31
    s_waitcnt vmcnt(12)
    s_barrier
    s_add_u32 m0, 0x7800, s38
    s_mul_i32 s46, s45, 229376
    s_add_u32 s46, s46, s41
    buffer_load_dwordx4 v1, s[4:7], s46 offen offset:0 sc1 lds
    buffer_load_dwordx4 v1, s[4:7], s46 offen offset:1024 sc1 lds
    buffer_load_dwordx4 v1, s[4:7], s46 offen offset:2048 sc1 lds
    buffer_load_dwordx4 v1, s[4:7], s46 offen offset:3072 sc1 lds
    s_add_u32 s45, s45, 1
    s_and_b32 s45, s45, 31
    s_add_u32 m0, 0x7800, s43
    s_lshl_b32 s46, s44, 7
    s_add_u32 s46, s46, s40
    buffer_load_dwordx4 v4, s[12:15], s46 offen offset:0  lds
    buffer_load_dwordx4 v5, s[12:15], s46 offen offset:1024  lds
    buffer_load_dwordx4 v6, s[12:15], s46 offen offset:2048  lds
    buffer_load_dwordx4 v7, s[12:15], s46 offen offset:3072  lds
    s_add_u32 s44, s44, 1
    s_and_b32 s44, s44, 31
    s_mov_b32 s36, 25
    s_mov_b32 s37, 61440
LE_l4:
    s_waitcnt vmcnt(16)
    s_barrier
    s_add_u32 m0, s37, s38
    s_mul_i32 s46, s45, 229376
    s_add_u32 s46, s46, s41
    buffer_load_dwordx4 v1, s[4:7], s46 offen offset:0 sc1 lds
    buffer_load_dwordx4 v1, s[4:7], s46 offen offset:1024 sc1 lds
    buffer_load_dwordx4 v1, s[4:7], s46 offen offset:2048 sc1 lds
    buffer_load_dwordx4 v1, s[4:7], s46 offen offset:3072 sc1 lds
    s_add_u32 s45, s45, 1
    s_and_b32 s45, s45, 31
    s_add_u32 m0, s37, s43
    s_lshl_b32 s46, s44, 7
    s_add_u32 s46, s46, s40
    buffer_load_dwordx4 v4, s[12:15], s46 offen offset:0  lds
    buffer_load_dwordx4 v5, s[12:15], s46 offen offset:1024  lds
    buffer_load_dwordx4 v6, s[12:15], s46 offen offset:2048  lds
    buffer_load_dwordx4 v7, s[12:15], s46 offen offset:3072  lds
    s_add_u32 s44, s44, 1
    s_and_b32 s44, s44, 31
    s_add_u32 s37, s37, 30720
    s_cmp_eq_u32 s37, 153600
    s_cselect_b32 s37, 0, s37
    s_sub_u32 s36, s36, 1
    s_cmp_lg_u32 s36, 0
    s_cbranch_scc1 LE_l4
    s_waitcnt vmcnt(16)
    s_barrier
    s_waitcnt vmcnt(8)
    s_barrier
    s_waitcnt vmcnt(0)
    s_barrier
    s_waitcnt vmcnt(0)
    s_barrier
    s_waitcnt vmcnt(0)
    s_barrier
    s_branch LE_put
LE_ld3:
    s_add_u32 m0, 0x0, s38
    s_mul_i32 s46, s45, 229376
    s_add_u32 s46, s46, s41
    buffer_load_dwordx4 v1, s[4:7], s46 offen offset:0 sc1 lds
    buffer_load_dwordx4 v1, s[4:7], s46 offen offset:1024 sc1 lds
    buffer_load_dwordx4 v1, s[4:7], s46 offen offset:2048 sc1 lds
    s_add_u32 s45, s45, 1
    s_and_b32 s45, s45, 31
    s_add_u32 m0, 0x7800, s38
    s_mul_i32 s46, s45, 229376
    s_add_u32 s46, s46, s41
    buffer_load_dwordx4 v1, s[4:7], s46 offen offset:0 sc1 lds
    buffer_load_dwordx4 v1, s[4:7], s46 offen offset:1024 sc1 lds
    buffer_load_dwordx4 v1, s[4:7], s46 offen offset:2048 sc1 lds
    s_add_u32 s45, s45, 1
    s_and_b32 s45, s45, 31
    s_add_u32 m0, 0xf000, s38
    s_mul_i32 s46, s45, 229376
    s_add_u32 s46, s46, s41
    buffer_load_dwordx4 v1, s[4:7], s46 offen offset:0 sc1 lds
    buffer_load_dwordx4 v1, s[4:7], s46 offen offset:1024 sc1 lds
    buffer_load_dwordx4 v1, s[4:7], s46 offen offset:2048 sc1 lds
    s_add_u32 s45, s45, 1
    s_and_b32 s45, s45, 31
    s_add_u32 m0, 0x16800, s38
    s_mul_i32 s46, s45, 229376
    s_add_u32 s46, s46, s41
    buffer_load_dwordx4 v1, s[4:7], s46 offen offset:0 sc1 lds
    buffer_load_dwordx4 v1, s[4:7], s46 offen offset:1024 sc1 lds
    buffer_load_dwordx4 v1, s[4:7], s46 offen offset:2048 sc1 lds
    s_add_u32 s45, s45, 1
    s_and_b32 s45, s45, 31
    s_add_u32 m0, 0x1e000, s38
    s_mul_i32 s46, s45, 229376
    s_add_u32 s46, s46, s41
    buffer_load_dwordx4 v1, s[4:7], s46 offen offset:0 sc1 lds
    buffer_load_dwordx4 v1, s[4:7], s46 offen offset:1024 sc1 lds
    buffer_load_dwordx4 v1, s[4:7], s46 offen offset:2048 sc1 lds
    s_add_u32 s45, s45, 1
    s_and_b32 s45, s45, 31
    s_waitcnt vmcnt(12)
    s_barrier
    s_waitcnt vmcnt(9)
    s_barrier
    s_waitcnt vmcnt(6)
    s_barrier
    s_add_u32 m0, 0x0, s38
    s_mul_i32 s46, s45, 229376
    s_add_u32 s46, s46, s41
    buffer_load_dwordx4 v1, s[4:7], s46 offen offset:0 sc1 lds
    buffer_load_dwordx4 v1, s[4:7], s46 offen offset:1024 sc1 lds
    buffer_load_dwordx4 v1, s[4:7], s46 offen offset:2048 sc1 lds
    s_add_u32 s45, s45, 1
    s_and_b32 s45, s45, 31
    s_add_u32 m0, 0x0, s43
    s_lshl_b32 s46, s44, 7
    s_add_u32 s46, s46, s40
    buffer_load_dwordx4 v4, s[12:15], s46 offen offset:0  lds
    buffer_load_dwordx4 v5, s[12:15], s46 offen offset:1024  lds
    buffer_load_dwordx4 v6, s[12:15], s46 offen offset:2048  lds
    buffer_load_dwordx4 v7, s[12:15], s46 offen offset:3072  lds
    s_add_u32 s44, s44, 1
    s_and_b32 s44, s44, 31
    s_waitcnt vmcnt(10)
    s_barrier
    s_add_u32 m0, 0x7800, s38
    s_mul_i32 s46, s45, 229376
    s_add_u32 s46, s46, s41
    buffer_load_dwordx4 v1, s[4:7], s46 offen offset:0 sc1 lds
    buffer_load_dwordx4 v1, s[4:7], s46 offen offset:1024 sc1 lds
    buffer_load_dwordx4 v1, s[4:7], s46 offen offset:2048 sc1 lds
    s_add_u32 s45, s45, 1
    s_and_b32 s45, s45, 31
    s_add_u32 m0, 0x7800, s43
    s_lshl_b32 s46, s44, 7
    s_add_u32 s46, s46, s40
    buffer_load_dwordx4 v4, s[12:15], s46 offen offset:0  lds
    buffer_load_dwordx4 v5, s[12:15], s46 offen offset:1024  lds
    buffer_load_dwordx4 v6, s[12:15], s46 offen offset:2048  lds
    buffer_load_dwordx4 v7, s[12:15], s46 offen offset:3072  lds
    s_add_u32 s44, s44, 1
    s_and_b32 s44, s44, 31
    s_mov_b32 s36, 25
    s_mov_b32 s37, 61440
LE_l3:
    s_waitcnt vmcnt(14)
    s_barrier
    s_add_u32 m0, s37, s38
    s_mul_i32 s46, s45, 229376
    s_add_u32 s46, s46, s41
    buffer_load_dwordx4 v1, s[4:7], s46 offen offset:0 sc1 lds
    buffer_load_dwordx4 v1, s[4:7], s46 offen offset:1024 sc1 lds
    buffer_load_dwordx4 v1, s[4:7], s46 offen offset:2048 sc1 lds
    s_add_u32 s45, s45, 1
    s_and_b32 s45, s45, 31
    s_add_u32 m0, s37, s43
    s_lshl_b32 s46, s44, 7
    s_add_u32 s46, s46, s40
    buffer_load_dwordx4 v4, s[12:15], s46 offen offset:0  lds
    buffer_load_dwordx4 v5, s[12:15], s46 offen offset:1024  lds
    buffer_load_dwordx4 v6, s[12:15], s46 offen offset:2048  lds
    buffer_load_dwordx4 v7, s[12:15], s46 offen offset:3072  lds
    s_add_u32 s44, s44, 1
    s_and_b32 s44, s44, 31
    s_add_u32 s37, s37, 30720
    s_cmp_eq_u32 s37, 153600
    s_cselect_b32 s37, 0, s37
    s_sub_u32 s36, s36, 1
    s_cmp_lg_u32 s36, 0
    s_cbranch_scc1 LE_l3
    s_waitcnt vmcnt(14)
    s_barrier
    s_waitcnt vmcnt(7)
    s_barrier
    s_waitcnt vmcnt(0)
    s_barrier
    s_waitcnt vmcnt(0)
    s_barrier
    s_waitcnt vmcnt(0)
    s_barrier
LE_put:
    ds_write_b128 v23, v[28:31] offset:0
    ds_write_b128 v23, v[32:35] offset:1024
    ds_write_b128 v23, v[36:39] offset:8192
    ds_write_b128 v23, v[40:43] offset:9216
    ds_write_b128 v23, v[44:47] offset:16384
    ds_write_b128 v23, v[48:51] offset:17408
    ds_write_b128 v23, v[52:55] offset:24576
    ds_write_b128 v23, v[56:59] offset:25600
    ds_write_b128 v23, v[60:63] offset:32768
    ds_write_b128 v23, v[64:67] offset:33792
    ds_write_b128 v23, v[68:71] offset:40960
    ds_write_b128 v23, v[72:75] offset:41984
    ds_write_b128 v23, v[76:79] offset:49152
    ds_write_b128 v23, v[80:83] offset:50176
    ds_write_b128 v23, v[84:87] offset:57344
    ds_write_b128 v23, v[88:91] offset:58368
    ds_write_b128 v24, v[92:95] offset:0
    ds_write_b128 v24, v[96:99] offset:1024
    ds_write_b128 v24, v[100:103] offset:8192
    ds_write_b128 v24, v[104:107] offset:9216
    ds_write_b128 v24, v[140:143] offset:16384
    ds_write_b128 v24, v[144:147] offset:17408
    ds_write_b128 v24, v[148:151] offset:24576
    ds_write_b128 v24, v[152:155] offset:25600
    ds_write_b128 v24, v[156:159] offset:32768
    ds_write_b128 v24, v[160:163] offset:33792
    ds_write_b128 v24, v[164:167] offset:40960
    ds_write_b128 v24, v[168:171] offset:41984
    ds_write_b128 v24, v[172:175] offset:49152
    ds_write_b128 v24, v[176:179] offset:50176
    ds_write_b128 v24, v[180:183] offset:57344
    ds_write_b128 v24, v[184:187] offset:58368
    ds_write_b128 v25, v[188:191] offset:0
    ds_write_b128 v25, v[192:195] offset:1024
    ds_write_b128 v25, v[196:199] offset:8192
    ds_write_b128 v25, v[200:203] offset:9216
    ds_write_b128 v25, v[204:207] offset:16384
    ds_write_b128 v25, v[208:211] offset:17408
    s_branch LF_go
LE_comp:
    v_bfe_u32 v26, v0, 1, 1
    v_mul_u32_u24 v27, 576, v26
    v_lshl_add_u32 v27, v12, 7, v27
    v_bfe_u32 v26, v0, 2, 2
    v_lshl_add_u32 v27, v26, 4, v27
    v_and_b32 v26, 1, v0
    v_lshl_add_u32 v27, v26, 3, v27
    s_add_u32 s35, s32, s34
    s_lshl_b32 s35, s35, 10
    s_add_u32 s35, s35, 16384
    s_mul_i32 s33, s34, 7168
    s_add_u32 s40, s35, s33
    s_sub_u32 s41, s35, s33
    s_add_u32 s41, s41, 7168
    s_cmp_eq_u32 s32, 0
    s_cselect_b32 s38, 6144, 0
    s_add_u32 s33, s33, s38
    s_add_u32 s33, s33, 16384
    v_add_u32 v48, s40, v27
    v_add_u32 v50, s41, v27
    v_add_u32 v52, s33, v27
    v_bfe_u32 v26, v0, 1, 3
    v_xor_b32 v26, v26, v12
    v_lshlrev_b32 v54, 7, v13
    v_lshl_add_u32 v54, v26, 4, v54
    s_lshl_b32 s33, s34, 6
    v_xor_b32 v54, s33, v54
    s_and_b32 s33, s3, 2
    s_lshl_b32 s33, s33, 12
    v_add_u32 v54, s33, v54
    v_lshlrev_b32 v28, 1, v13
    v_lshlrev_b32 v26, 9, v15
    v_lshl_add_u32 v26, v13, 4, v26
    v_and_b32 v27, 1, v12
    v_lshl_add_u32 v26, v27, 3, v26
    v_add_u32 v19, 114688, v1
    s_mul_i32 s43, s30, 114688
    s_mul_i32 s33, s29, 7168
    s_add_u32 s43, s43, s33
    s_add_u32 s48, s43, s35
    s_add_u32 s48, s48, 33538048
    s_add_u32 s49, s48, 4096
    s_add_u32 s43, s43, s38
    s_mul_i32 s33, s34, 114688
    s_add_u32 s43, s43, s33
    s_add_u32 s47, s43, 16777216
    s_add_u32 s43, s43, 33554432
    s_mov_b32 s37, 0
    v_xor_b32 v49, 64, v48
    v_xor_b32 v51, 64, v50
    v_xor_b32 v53, 64, v52
    v_xor_b32 v55, 64, v54
    v_mov_b32 v40, v48
    v_mov_b32 v41, v49
    v_mov_b32 v42, v50
    v_mov_b32 v43, v51
    v_mov_b32 v44, v52
    v_mov_b32 v45, v53
    v_mov_b32 v46, v54
    v_mov_b32 v47, v55
    s_mov_b32 s12, s80
    s_and_b32 s13, s81, 0xffff
    s_mov_b32 s14, 0x1000
    s_mov_b32 s15, 0x20000
    s_lshl_b32 s33, s30, 6
    buffer_load_ushort v30, v28, s[12:15], s33 offen offset:0
    buffer_load_ushort v32, v28, s[12:15], s33 offen offset:32
    buffer_load_ushort v34, v28, s[12:15], s33 offen offset:64
    buffer_load_ushort v36, v28, s[12:15], s33 offen offset:96
    s_mov_b32 s38, 0xffff0000
    v_and_b32 v189, s38, v224
    v_lshlrev_b32 v188, 16, v224
    v_and_b32 v191, s38, v225
    v_lshlrev_b32 v190, 16, v225
    v_and_b32 v193, s38, v226
    v_lshlrev_b32 v192, 16, v226
    v_and_b32 v195, s38, v227
    v_lshlrev_b32 v194, 16, v227
    v_and_b32 v197, s38, v228
    v_lshlrev_b32 v196, 16, v228
    v_and_b32 v199, s38, v229
    v_lshlrev_b32 v198, 16, v229
    v_and_b32 v201, s38, v230
    v_lshlrev_b32 v200, 16, v230
    v_and_b32 v203, s38, v231
    v_lshlrev_b32 v202, 16, v231
    v_and_b32 v205, s38, v232
    v_lshlrev_b32 v204, 16, v232
    v_and_b32 v207, s38, v233
    v_lshlrev_b32 v206, 16, v233
    v_and_b32 v209, s38, v234
    v_lshlrev_b32 v208, 16, v234
    v_and_b32 v211, s38, v235
    v_lshlrev_b32 v210, 16, v235
    v_and_b32 v213, s38, v236
    v_lshlrev_b32 v212, 16, v236
    v_and_b32 v215, s38, v237
    v_lshlrev_b32 v214, 16, v237
    v_and_b32 v217, s38, v238
    v_lshlrev_b32 v216, 16, v238
    v_and_b32 v219, s38, v239
    v_lshlrev_b32 v218, 16, v239
    v_and_b32 v221, s38, v240
    v_lshlrev_b32 v220, 16, v240
    v_and_b32 v223, s38, v241
    v_lshlrev_b32 v222, 16, v241
    v_and_b32 v225, s38, v242
    v_lshlrev_b32 v224, 16, v242
    v_and_b32 v227, s38, v243
    v_lshlrev_b32 v226, 16, v243
    v_and_b32 v229, s38, v244
    v_lshlrev_b32 v228, 16, v244
    v_and_b32 v231, s38, v245
    v_lshlrev_b32 v230, 16, v245
    v_and_b32 v233, s38, v246
    v_lshlrev_b32 v232, 16, v246
    v_and_b32 v235, s38, v247
    v_lshlrev_b32 v234, 16, v247
    v_mov_b32 v2, 1
    v_lshlrev_b32 v3, 7, v0
    s_waitcnt vmcnt(0) lgkmcnt(0)
    s_barrier
    s_cmp_lg_u32 s3, 0
    s_cbranch_scc1 Lho15f
    s_mov_b64 exec, 1
    buffer_store_dword v2, off, s[4:7], s39 sc1
    s_mov_b64 exec, -1
Lho15f:
    s_cmp_lg_u32 s3, 0
    s_cbranch_scc1 Lho15
    s_mov_b64 exec, 0xffffffff
    s_mov_b32 s92, 300000
Lpoll16:
    buffer_load_dword v2, v3, s[4:7], s61 offen sc1
    s_sub_u32 s92, s92, 1
    s_cbranch_scc1 Lpollx17
    s_waitcnt vmcnt(0)
    v_cmp_ne_u32 vcc, 1, v2
    s_nop 0
    s_cmp_eq_u64 vcc, 0
    s_cbranch_scc1 Lpollx17
    s_branch Lpoll16
Lpollx17:
    s_mov_b64 exec, -1
Lho15:
    s_barrier
    s_cmp_eq_u32 s34, 0
    s_cselect_b64 vcc, -1, 0
    v_lshlrev_b32 v30, 16, v30
    v_lshlrev_b32 v32, 16, v32
    v_lshlrev_b32 v34, 16, v34
    v_lshlrev_b32 v36, 16, v36
    v_pk_mul_f32 v[64:65], v[30:31], 1.0 op_sel_hi:[0,0]
    v_pk_mul_f32 v[66:67], v[30:31], 1.0 op_sel_hi:[0,0]
    v_pk_mul_f32 v[68:69], v[32:33], 1.0 op_sel_hi:[0,0]
    v_pk_mul_f32 v[70:71], v[32:33], 1.0 op_sel_hi:[0,0]
    v_pk_mul_f32 v[72:73], v[34:35], 1.0 op_sel_hi:[0,0]
    v_pk_mul_f32 v[74:75], v[34:35], 1.0 op_sel_hi:[0,0]
    v_pk_mul_f32 v[76:77], v[36:37], 1.0 op_sel_hi:[0,0]
    v_pk_mul_f32 v[78:79], v[36:37], 1.0 op_sel_hi:[0,0]
    v_pk_mul_f32 v[80:81], v[30:31], 1.0 op_sel_hi:[0,0]
    v_pk_mul_f32 v[82:83], v[30:31], 1.0 op_sel_hi:[0,0]
    v_pk_mul_f32 v[84:85], v[32:33], 1.0 op_sel_hi:[0,0]
    v_pk_mul_f32 v[86:87], v[32:33], 1.0 op_sel_hi:[0,0]
    v_pk_mul_f32 v[88:89], v[34:35], 1.0 op_sel_hi:[0,0]
    v_pk_mul_f32 v[90:91], v[34:35], 1.0 op_sel_hi:[0,0]
    v_pk_mul_f32 v[92:93], v[36:37], 1.0 op_sel_hi:[0,0]
    v_pk_mul_f32 v[94:95], v[36:37], 1.0 op_sel_hi:[0,0]
    v_pk_mul_f32 v[96:97], v[30:31], 1.0 op_sel_hi:[0,0]
    v_pk_mul_f32 v[98:99], v[30:31], 1.0 op_sel_hi:[0,0]
    v_pk_mul_f32 v[100:101], v[32:33], 1.0 op_sel_hi:[0,0]
    v_pk_mul_f32 v[102:103], v[32:33], 1.0 op_sel_hi:[0,0]
    v_pk_mul_f32 v[104:105], v[34:35], 1.0 op_sel_hi:[0,0]
    v_pk_mul_f32 v[106:107], v[34:35], 1.0 op_sel_hi:[0,0]
    v_pk_mul_f32 v[108:109], v[36:37], 1.0 op_sel_hi:[0,0]
    v_pk_mul_f32 v[110:111], v[36:37], 1.0 op_sel_hi:[0,0]
    v_cndmask_b32 v112, 0, v30, vcc
    v_cndmask_b32 v113, 0, v30, vcc
    v_cndmask_b32 v114, 0, v30, vcc
    v_cndmask_b32 v115, 0, v30, vcc
    v_cndmask_b32 v116, 0, v32, vcc
    v_cndmask_b32 v117, 0, v32, vcc
    v_cndmask_b32 v118, 0, v32, vcc
    v_cndmask_b32 v119, 0, v32, vcc
    v_cndmask_b32 v120, 0, v34, vcc
    v_cndmask_b32 v121, 0, v34, vcc
    v_cndmask_b32 v122, 0, v34, vcc
    v_cndmask_b32 v123, 0, v34, vcc
    v_cndmask_b32 v124, 0, v36, vcc
    v_cndmask_b32 v125, 0, v36, vcc
    v_cndmask_b32 v126, 0, v36, vcc
    v_cndmask_b32 v127, 0, v36, vcc
    s_lshl_b32 s39, s28, 4
    s_add_u32 s39, s39, s29
    s_lshl_b32 s39, s39, 7
    s_add_u32 s39, s39, 15826944
    s_lshl_b32 s33, s30, 6
    buffer_load_dwordx2 v[248:249], v26, s[4:7], s47 offen offset:0 sc1
    buffer_load_dwordx2 v[250:251], v26, s[4:7], s47 offen offset:256 sc1
    s_barrier
    ds_read_b64_tr_b16 v[128:129], v44 offset:0
    ds_read_b128 v[156:159], v46 offset:0
    ds_read_b64_tr_b16 v[130:131], v45 offset:0
    ds_read_b128 v[160:163], v46 offset:2048
    ds_read_b64_tr_b16 v[132:133], v40 offset:0
    ds_read_b128 v[164:167], v46 offset:4096
    ds_read_b64_tr_b16 v[134:135], v41 offset:0
    ds_read_b128 v[168:171], v46 offset:6144
    ds_read_b64_tr_b16 v[136:137], v40 offset:2048
    ds_read_b64_tr_b16 v[138:139], v41 offset:2048
    s_mov_b32 s36, 8
.p2align 4
Lrl18:
    s_waitcnt lgkmcnt(7)
    v_mfma_f32_16x16x32_bf16 v[112:115], v[128:131], v[156:159], v[112:115]
    ds_read_b64_tr_b16 v[140:141], v40 offset:4096
    s_waitcnt lgkmcnt(7)
    v_mfma_f32_16x16x32_bf16 v[116:119], v[128:131], v[160:163], v[116:119]
    s_add_u32 s37, s37, 30720
    s_cmp_eq_u32 s37, 153600
    s_cselect_b32 s37, 0, s37
    v_add_u32 v44, s37, v52
    s_waitcnt lgkmcnt(5)
    v_mfma_f32_16x16x32_bf16 v[120:123], v[128:131], v[164:167], v[120:123]
    ds_read_b64_tr_b16 v[142:143], v41 offset:4096
    s_waitcnt lgkmcnt(4)
    v_mfma_f32_16x16x32_bf16 v[124:127], v[128:131], v[168:171], v[124:127]
    v_add_u32 v45, s37, v53
    v_add_u32 v46, s37, v54
    v_mfma_f32_16x16x32_bf16 v[76:79], v[132:135], v[168:171], v[76:79]
    ds_read_b64_tr_b16 v[144:145], v42 offset:0
    v_mfma_f32_16x16x32_bf16 v[72:75], v[132:135], v[164:167], v[72:75]
    ds_read_b128 v[172:175], v47 offset:0
    v_mfma_f32_16x16x32_bf16 v[68:71], v[132:135], v[160:163], v[68:71]
    ds_read_b64_tr_b16 v[146:147], v43 offset:0
    v_mfma_f32_16x16x32_bf16 v[64:67], v[132:135], v[156:159], v[64:67]
    ds_read_b128 v[176:179], v47 offset:2048
    s_waitcnt lgkmcnt(6)
    v_mfma_f32_16x16x32_bf16 v[80:83], v[136:139], v[156:159], v[80:83]
    ds_read_b64_tr_b16 v[148:149], v42 offset:2048
    v_mfma_f32_16x16x32_bf16 v[84:87], v[136:139], v[160:163], v[84:87]
    ds_read_b128 v[180:183], v47 offset:4096
    v_mfma_f32_16x16x32_bf16 v[88:91], v[136:139], v[164:167], v[88:91]
    ds_read_b64_tr_b16 v[150:151], v43 offset:2048
    v_mfma_f32_16x16x32_bf16 v[92:95], v[136:139], v[168:171], v[92:95]
    ds_read_b128 v[184:187], v47 offset:6144
    s_waitcnt lgkmcnt(8)
    v_mfma_f32_16x16x32_bf16 v[108:111], v[140:143], v[168:171], v[108:111]
    ds_read_b64_tr_b16 v[152:153], v42 offset:4096
    v_mfma_f32_16x16x32_bf16 v[104:107], v[140:143], v[164:167], v[104:107]
    v_add_u32 v40, s37, v48
    v_add_u32 v41, s37, v49
    v_mfma_f32_16x16x32_bf16 v[100:103], v[140:143], v[160:163], v[100:103]
    ds_read_b64_tr_b16 v[154:155], v43 offset:4096
    v_mfma_f32_16x16x32_bf16 v[96:99], v[140:143], v[156:159], v[96:99]
    v_add_u32 v47, s37, v55
    s_waitcnt lgkmcnt(7)
    v_mfma_f32_16x16x32_bf16 v[64:67], v[144:147], v[172:175], v[64:67]
    s_barrier
    ds_read_b64_tr_b16 v[128:129], v44 offset:0
    s_waitcnt lgkmcnt(7)
    v_mfma_f32_16x16x32_bf16 v[68:71], v[144:147], v[176:179], v[68:71]
    ds_read_b128 v[156:159], v46 offset:0
    s_waitcnt lgkmcnt(6)
    v_mfma_f32_16x16x32_bf16 v[72:75], v[144:147], v[180:183], v[72:75]
    ds_read_b64_tr_b16 v[130:131], v45 offset:0
    s_waitcnt lgkmcnt(5)
    v_mfma_f32_16x16x32_bf16 v[76:79], v[144:147], v[184:187], v[76:79]
    ds_read_b128 v[160:163], v46 offset:2048
    v_mfma_f32_16x16x32_bf16 v[92:95], v[148:151], v[184:187], v[92:95]
    ds_read_b64_tr_b16 v[132:133], v40 offset:0
    v_mfma_f32_16x16x32_bf16 v[88:91], v[148:151], v[180:183], v[88:91]
    ds_read_b128 v[164:167], v46 offset:4096
    v_mfma_f32_16x16x32_bf16 v[84:87], v[148:151], v[176:179], v[84:87]
    ds_read_b64_tr_b16 v[134:135], v41 offset:0
    v_mfma_f32_16x16x32_bf16 v[80:83], v[148:151], v[172:175], v[80:83]
    ds_read_b128 v[168:171], v46 offset:6144
    s_waitcnt lgkmcnt(8)
    v_mfma_f32_16x16x32_bf16 v[96:99], v[152:155], v[172:175], v[96:99]
    ds_read_b64_tr_b16 v[136:137], v40 offset:2048
    v_mfma_f32_16x16x32_bf16 v[100:103], v[152:155], v[176:179], v[100:103]
    v_add_u32 v42, s37, v50
    v_add_u32 v43, s37, v51
    v_mfma_f32_16x16x32_bf16 v[104:107], v[152:155], v[180:183], v[104:107]
    ds_read_b64_tr_b16 v[138:139], v41 offset:2048
    v_mfma_f32_16x16x32_bf16 v[108:111], v[152:155], v[184:187], v[108:111]
    s_waitcnt lgkmcnt(7)
    v_mfma_f32_16x16x32_bf16 v[112:115], v[128:131], v[156:159], v[112:115]
    ds_read_b64_tr_b16 v[140:141], v40 offset:4096
    s_waitcnt lgkmcnt(7)
    v_mfma_f32_16x16x32_bf16 v[116:119], v[128:131], v[160:163], v[116:119]
    s_add_u32 s37, s37, 30720
    s_cmp_eq_u32 s37, 153600
    s_cselect_b32 s37, 0, s37
    v_add_u32 v44, s37, v52
    s_waitcnt lgkmcnt(5)
    v_mfma_f32_16x16x32_bf16 v[120:123], v[128:131], v[164:167], v[120:123]
    ds_read_b64_tr_b16 v[142:143], v41 offset:4096
    s_waitcnt lgkmcnt(4)
    v_mfma_f32_16x16x32_bf16 v[124:127], v[128:131], v[168:171], v[124:127]
    v_add_u32 v45, s37, v53
    v_add_u32 v46, s37, v54
    v_mfma_f32_16x16x32_bf16 v[76:79], v[132:135], v[168:171], v[76:79]
    ds_read_b64_tr_b16 v[144:145], v42 offset:0
    v_mfma_f32_16x16x32_bf16 v[72:75], v[132:135], v[164:167], v[72:75]
    ds_read_b128 v[172:175], v47 offset:0
    v_mfma_f32_16x16x32_bf16 v[68:71], v[132:135], v[160:163], v[68:71]
    ds_read_b64_tr_b16 v[146:147], v43 offset:0
    v_mfma_f32_16x16x32_bf16 v[64:67], v[132:135], v[156:159], v[64:67]
    ds_read_b128 v[176:179], v47 offset:2048
    s_waitcnt lgkmcnt(6)
    v_mfma_f32_16x16x32_bf16 v[80:83], v[136:139], v[156:159], v[80:83]
    ds_read_b64_tr_b16 v[148:149], v42 offset:2048
    v_mfma_f32_16x16x32_bf16 v[84:87], v[136:139], v[160:163], v[84:87]
    ds_read_b128 v[180:183], v47 offset:4096
    v_mfma_f32_16x16x32_bf16 v[88:91], v[136:139], v[164:167], v[88:91]
    ds_read_b64_tr_b16 v[150:151], v43 offset:2048
    v_mfma_f32_16x16x32_bf16 v[92:95], v[136:139], v[168:171], v[92:95]
    ds_read_b128 v[184:187], v47 offset:6144
    s_waitcnt lgkmcnt(8)
    v_mfma_f32_16x16x32_bf16 v[108:111], v[140:143], v[168:171], v[108:111]
    ds_read_b64_tr_b16 v[152:153], v42 offset:4096
    v_mfma_f32_16x16x32_bf16 v[104:107], v[140:143], v[164:167], v[104:107]
    v_add_u32 v40, s37, v48
    v_add_u32 v41, s37, v49
    v_mfma_f32_16x16x32_bf16 v[100:103], v[140:143], v[160:163], v[100:103]
    ds_read_b64_tr_b16 v[154:155], v43 offset:4096
    v_mfma_f32_16x16x32_bf16 v[96:99], v[140:143], v[156:159], v[96:99]
    v_add_u32 v47, s37, v55
    s_waitcnt lgkmcnt(7)
    v_mfma_f32_16x16x32_bf16 v[64:67], v[144:147], v[172:175], v[64:67]
    s_barrier
    ds_read_b64_tr_b16 v[128:129], v44 offset:0
    s_waitcnt lgkmcnt(7)
    v_mfma_f32_16x16x32_bf16 v[68:71], v[144:147], v[176:179], v[68:71]
    ds_read_b128 v[156:159], v46 offset:0
    s_waitcnt lgkmcnt(6)
    v_mfma_f32_16x16x32_bf16 v[72:75], v[144:147], v[180:183], v[72:75]
    ds_read_b64_tr_b16 v[130:131], v45 offset:0
    s_waitcnt lgkmcnt(5)
    v_mfma_f32_16x16x32_bf16 v[76:79], v[144:147], v[184:187], v[76:79]
    ds_read_b128 v[160:163], v46 offset:2048
    v_mfma_f32_16x16x32_bf16 v[92:95], v[148:151], v[184:187], v[92:95]
    ds_read_b64_tr_b16 v[132:133], v40 offset:0
    v_mfma_f32_16x16x32_bf16 v[88:91], v[148:151], v[180:183], v[88:91]
    ds_read_b128 v[164:167], v46 offset:4096
    v_mfma_f32_16x16x32_bf16 v[84:87], v[148:151], v[176:179], v[84:87]
    ds_read_b64_tr_b16 v[134:135], v41 offset:0
    v_mfma_f32_16x16x32_bf16 v[80:83], v[148:151], v[172:175], v[80:83]
    ds_read_b128 v[168:171], v46 offset:6144
    s_waitcnt lgkmcnt(8)
    v_mfma_f32_16x16x32_bf16 v[96:99], v[152:155], v[172:175], v[96:99]
    ds_read_b64_tr_b16 v[136:137], v40 offset:2048
    v_mfma_f32_16x16x32_bf16 v[100:103], v[152:155], v[176:179], v[100:103]
    v_add_u32 v42, s37, v50
    v_add_u32 v43, s37, v51
    v_mfma_f32_16x16x32_bf16 v[104:107], v[152:155], v[180:183], v[104:107]
    ds_read_b64_tr_b16 v[138:139], v41 offset:2048
    v_mfma_f32_16x16x32_bf16 v[108:111], v[152:155], v[184:187], v[108:111]
    s_waitcnt lgkmcnt(7)
    v_mfma_f32_16x16x32_bf16 v[112:115], v[128:131], v[156:159], v[112:115]
    ds_read_b64_tr_b16 v[140:141], v40 offset:4096
    s_waitcnt lgkmcnt(7)
    v_mfma_f32_16x16x32_bf16 v[116:119], v[128:131], v[160:163], v[116:119]
    s_add_u32 s37, s37, 30720
    s_cmp_eq_u32 s37, 153600
    s_cselect_b32 s37, 0, s37
    v_add_u32 v44, s37, v52
    s_waitcnt lgkmcnt(5)
    v_mfma_f32_16x16x32_bf16 v[120:123], v[128:131], v[164:167], v[120:123]
    ds_read_b64_tr_b16 v[142:143], v41 offset:4096
    s_waitcnt lgkmcnt(4)
    v_mfma_f32_16x16x32_bf16 v[124:127], v[128:131], v[168:171], v[124:127]
    v_add_u32 v45, s37, v53
    v_add_u32 v46, s37, v54
    v_mfma_f32_16x16x32_bf16 v[76:79], v[132:135], v[168:171], v[76:79]
    ds_read_b64_tr_b16 v[144:145], v42 offset:0
    v_mfma_f32_16x16x32_bf16 v[72:75], v[132:135], v[164:167], v[72:75]
    ds_read_b128 v[172:175], v47 offset:0
    v_mfma_f32_16x16x32_bf16 v[68:71], v[132:135], v[160:163], v[68:71]
    ds_read_b64_tr_b16 v[146:147], v43 offset:0
    v_mfma_f32_16x16x32_bf16 v[64:67], v[132:135], v[156:159], v[64:67]
    ds_read_b128 v[176:179], v47 offset:2048
    s_waitcnt lgkmcnt(6)
    v_mfma_f32_16x16x32_bf16 v[80:83], v[136:139], v[156:159], v[80:83]
    ds_read_b64_tr_b16 v[148:149], v42 offset:2048
    v_mfma_f32_16x16x32_bf16 v[84:87], v[136:139], v[160:163], v[84:87]
    ds_read_b128 v[180:183], v47 offset:4096
    v_mfma_f32_16x16x32_bf16 v[88:91], v[136:139], v[164:167], v[88:91]
    ds_read_b64_tr_b16 v[150:151], v43 offset:2048
    v_mfma_f32_16x16x32_bf16 v[92:95], v[136:139], v[168:171], v[92:95]
    ds_read_b128 v[184:187], v47 offset:6144
    s_waitcnt lgkmcnt(8)
    v_mfma_f32_16x16x32_bf16 v[108:111], v[140:143], v[168:171], v[108:111]
    ds_read_b64_tr_b16 v[152:153], v42 offset:4096
    v_mfma_f32_16x16x32_bf16 v[104:107], v[140:143], v[164:167], v[104:107]
    v_add_u32 v40, s37, v48
    v_add_u32 v41, s37, v49
    v_mfma_f32_16x16x32_bf16 v[100:103], v[140:143], v[160:163], v[100:103]
    ds_read_b64_tr_b16 v[154:155], v43 offset:4096
    v_mfma_f32_16x16x32_bf16 v[96:99], v[140:143], v[156:159], v[96:99]
    v_add_u32 v47, s37, v55
    s_waitcnt lgkmcnt(7)
    v_mfma_f32_16x16x32_bf16 v[64:67], v[144:147], v[172:175], v[64:67]
    s_barrier
    ds_read_b64_tr_b16 v[128:129], v44 offset:0
    s_waitcnt lgkmcnt(7)
    v_mfma_f32_16x16x32_bf16 v[68:71], v[144:147], v[176:179], v[68:71]
    ds_read_b128 v[156:159], v46 offset:0
    s_waitcnt lgkmcnt(6)
    v_mfma_f32_16x16x32_bf16 v[72:75], v[144:147], v[180:183], v[72:75]
    ds_read_b64_tr_b16 v[130:131], v45 offset:0
    s_waitcnt lgkmcnt(5)
    v_mfma_f32_16x16x32_bf16 v[76:79], v[144:147], v[184:187], v[76:79]
    ds_read_b128 v[160:163], v46 offset:2048
    v_mfma_f32_16x16x32_bf16 v[92:95], v[148:151], v[184:187], v[92:95]
    ds_read_b64_tr_b16 v[132:133], v40 offset:0
    v_mfma_f32_16x16x32_bf16 v[88:91], v[148:151], v[180:183], v[88:91]
    ds_read_b128 v[164:167], v46 offset:4096
    v_mfma_f32_16x16x32_bf16 v[84:87], v[148:151], v[176:179], v[84:87]
    ds_read_b64_tr_b16 v[134:135], v41 offset:0
    v_mfma_f32_16x16x32_bf16 v[80:83], v[148:151], v[172:175], v[80:83]
    ds_read_b128 v[168:171], v46 offset:6144
    s_waitcnt lgkmcnt(8)
    v_mfma_f32_16x16x32_bf16 v[96:99], v[152:155], v[172:175], v[96:99]
    ds_read_b64_tr_b16 v[136:137], v40 offset:2048
    v_mfma_f32_16x16x32_bf16 v[100:103], v[152:155], v[176:179], v[100:103]
    v_add_u32 v42, s37, v50
    v_add_u32 v43, s37, v51
    v_mfma_f32_16x16x32_bf16 v[104:107], v[152:155], v[180:183], v[104:107]
    ds_read_b64_tr_b16 v[138:139], v41 offset:2048
    v_mfma_f32_16x16x32_bf16 v[108:111], v[152:155], v[184:187], v[108:111]
    s_waitcnt lgkmcnt(7)
    v_mfma_f32_16x16x32_bf16 v[112:115], v[128:131], v[156:159], v[112:115]
    ds_read_b64_tr_b16 v[140:141], v40 offset:4096
    s_waitcnt lgkmcnt(7)
    v_mfma_f32_16x16x32_bf16 v[116:119], v[128:131], v[160:163], v[116:119]
    s_add_u32 s37, s37, 30720
    s_cmp_eq_u32 s37, 153600
    s_cselect_b32 s37, 0, s37
    v_add_u32 v44, s37, v52
    s_waitcnt lgkmcnt(5)
    v_mfma_f32_16x16x32_bf16 v[120:123], v[128:131], v[164:167], v[120:123]
    ds_read_b64_tr_b16 v[142:143], v41 offset:4096
    s_waitcnt lgkmcnt(4)
    v_mfma_f32_16x16x32_bf16 v[124:127], v[128:131], v[168:171], v[124:127]
    v_add_u32 v45, s37, v53
    v_add_u32 v46, s37, v54
    v_mfma_f32_16x16x32_bf16 v[76:79], v[132:135], v[168:171], v[76:79]
    ds_read_b64_tr_b16 v[144:145], v42 offset:0
    v_mfma_f32_16x16x32_bf16 v[72:75], v[132:135], v[164:167], v[72:75]
    ds_read_b128 v[172:175], v47 offset:0
    v_mfma_f32_16x16x32_bf16 v[68:71], v[132:135], v[160:163], v[68:71]
    ds_read_b64_tr_b16 v[146:147], v43 offset:0
    v_mfma_f32_16x16x32_bf16 v[64:67], v[132:135], v[156:159], v[64:67]
    ds_read_b128 v[176:179], v47 offset:2048
    s_waitcnt lgkmcnt(6)
    v_mfma_f32_16x16x32_bf16 v[80:83], v[136:139], v[156:159], v[80:83]
    ds_read_b64_tr_b16 v[148:149], v42 offset:2048
    v_mfma_f32_16x16x32_bf16 v[84:87], v[136:139], v[160:163], v[84:87]
    ds_read_b128 v[180:183], v47 offset:4096
    v_mfma_f32_16x16x32_bf16 v[88:91], v[136:139], v[164:167], v[88:91]
    ds_read_b64_tr_b16 v[150:151], v43 offset:2048
    v_mfma_f32_16x16x32_bf16 v[92:95], v[136:139], v[168:171], v[92:95]
    ds_read_b128 v[184:187], v47 offset:6144
    s_waitcnt lgkmcnt(8)
    v_mfma_f32_16x16x32_bf16 v[108:111], v[140:143], v[168:171], v[108:111]
    ds_read_b64_tr_b16 v[152:153], v42 offset:4096
    v_mfma_f32_16x16x32_bf16 v[104:107], v[140:143], v[164:167], v[104:107]
    v_add_u32 v40, s37, v48
    v_add_u32 v41, s37, v49
    v_mfma_f32_16x16x32_bf16 v[100:103], v[140:143], v[160:163], v[100:103]
    ds_read_b64_tr_b16 v[154:155], v43 offset:4096
    v_mfma_f32_16x16x32_bf16 v[96:99], v[140:143], v[156:159], v[96:99]
    v_add_u32 v47, s37, v55
    s_waitcnt lgkmcnt(7)
    v_mfma_f32_16x16x32_bf16 v[64:67], v[144:147], v[172:175], v[64:67]
    s_barrier
    ds_read_b64_tr_b16 v[128:129], v44 offset:0
    s_waitcnt lgkmcnt(7)
    v_mfma_f32_16x16x32_bf16 v[68:71], v[144:147], v[176:179], v[68:71]
    ds_read_b128 v[156:159], v46 offset:0
    s_waitcnt lgkmcnt(6)
    v_mfma_f32_16x16x32_bf16 v[72:75], v[144:147], v[180:183], v[72:75]
    ds_read_b64_tr_b16 v[130:131], v45 offset:0
    s_waitcnt lgkmcnt(5)
    v_mfma_f32_16x16x32_bf16 v[76:79], v[144:147], v[184:187], v[76:79]
    ds_read_b128 v[160:163], v46 offset:2048
    v_mfma_f32_16x16x32_bf16 v[92:95], v[148:151], v[184:187], v[92:95]
    ds_read_b64_tr_b16 v[132:133], v40 offset:0
    v_mfma_f32_16x16x32_bf16 v[88:91], v[148:151], v[180:183], v[88:91]
    ds_read_b128 v[164:167], v46 offset:4096
    v_mfma_f32_16x16x32_bf16 v[84:87], v[148:151], v[176:179], v[84:87]
    ds_read_b64_tr_b16 v[134:135], v41 offset:0
    v_mfma_f32_16x16x32_bf16 v[80:83], v[148:151], v[172:175], v[80:83]
    ds_read_b128 v[168:171], v46 offset:6144
    s_waitcnt lgkmcnt(8)
    v_mfma_f32_16x16x32_bf16 v[96:99], v[152:155], v[172:175], v[96:99]
    ds_read_b64_tr_b16 v[136:137], v40 offset:2048
    v_mfma_f32_16x16x32_bf16 v[100:103], v[152:155], v[176:179], v[100:103]
    v_add_u32 v42, s37, v50
    v_add_u32 v43, s37, v51
    v_mfma_f32_16x16x32_bf16 v[104:107], v[152:155], v[180:183], v[104:107]
    ds_read_b64_tr_b16 v[138:139], v41 offset:2048
    v_mfma_f32_16x16x32_bf16 v[108:111], v[152:155], v[184:187], v[108:111]
    s_sub_u32 s36, s36, 1
    s_cmp_lg_u32 s36, 0
    s_cbranch_scc1 Lrl18
    s_waitcnt lgkmcnt(0)
    s_lshl_b32 s33, s3, 11
    s_add_u32 s33, s33, 155648
    v_add_u32 v4, s33, v1
    s_xor_b32 s33, s33, 2048
    v_add_u32 v5, s33, v1
    s_cmp_eq_u32 s34, 0
    s_cbranch_scc1 LE_ns
    v_swap_b32 v112, v120
    v_swap_b32 v113, v121
    v_swap_b32 v114, v122
    v_swap_b32 v115, v123
    v_swap_b32 v116, v124
    v_swap_b32 v117, v125
    v_swap_b32 v118, v126
    v_swap_b32 v119, v127
LE_ns:
    ds_write_b128 v4, v[120:123] offset:0
    ds_write_b128 v4, v[124:127] offset:1024
    s_waitcnt vmcnt(0) lgkmcnt(0)
    s_barrier
    ds_read_b128 v[120:123], v5 offset:0
    ds_read_b128 v[124:127], v5 offset:1024
    v_pk_mul_f32 v[64:65], v[64:65], v[188:189]
    v_pk_mul_f32 v[66:67], v[66:67], v[190:191]
    v_pk_mul_f32 v[68:69], v[68:69], v[192:193]
    v_pk_mul_f32 v[70:71], v[70:71], v[194:195]
    v_cvt_pk_bf16_f32 v128, v64, v65
    v_cvt_pk_bf16_f32 v129, v66, v67
    v_cvt_pk_bf16_f32 v130, v68, v69
    v_cvt_pk_bf16_f32 v131, v70, v71
    v_min_u32 v128, -2, v128
    v_min_u32 v130, -2, v130
    v_min_u32 v129, -2, v129
    v_min_u32 v131, -2, v131
    v_permlane16_swap_b32 v128, v130
    s_nop 0
    v_permlane16_swap_b32 v129, v131
    buffer_store_dwordx4 v[128:131], v1, s[4:7], s48 offen offset:0 sc1
    v_pk_mul_f32 v[72:73], v[72:73], v[196:197]
    v_pk_mul_f32 v[74:75], v[74:75], v[198:199]
    v_pk_mul_f32 v[76:77], v[76:77], v[200:201]
    v_pk_mul_f32 v[78:79], v[78:79], v[202:203]
    v_cvt_pk_bf16_f32 v132, v72, v73
    v_cvt_pk_bf16_f32 v133, v74, v75
    v_cvt_pk_bf16_f32 v134, v76, v77
    v_cvt_pk_bf16_f32 v135, v78, v79
    v_min_u32 v132, -2, v132
    v_min_u32 v134, -2, v134
    v_min_u32 v133, -2, v133
    v_min_u32 v135, -2, v135
    v_permlane16_swap_b32 v132, v134
    s_nop 0
    v_permlane16_swap_b32 v133, v135
    buffer_store_dwordx4 v[132:135], v19, s[4:7], s48 offen offset:0 sc1
    v_pk_mul_f32 v[80:81], v[80:81], v[204:205]
    v_pk_mul_f32 v[82:83], v[82:83], v[206:207]
    v_pk_mul_f32 v[84:85], v[84:85], v[208:209]
    v_pk_mul_f32 v[86:87], v[86:87], v[210:211]
    v_cvt_pk_bf16_f32 v136, v80, v81
    v_cvt_pk_bf16_f32 v137, v82, v83
    v_cvt_pk_bf16_f32 v138, v84, v85
    v_cvt_pk_bf16_f32 v139, v86, v87
    v_min_u32 v136, -2, v136
    v_min_u32 v138, -2, v138
    v_min_u32 v137, -2, v137
    v_min_u32 v139, -2, v139
    v_permlane16_swap_b32 v136, v138
    s_nop 0
    v_permlane16_swap_b32 v137, v139
    buffer_store_dwordx4 v[136:139], v1, s[4:7], s48 offen offset:2048 sc1
    v_pk_mul_f32 v[88:89], v[88:89], v[212:213]
    v_pk_mul_f32 v[90:91], v[90:91], v[214:215]
    v_pk_mul_f32 v[92:93], v[92:93], v[216:217]
    v_pk_mul_f32 v[94:95], v[94:95], v[218:219]
    v_cvt_pk_bf16_f32 v140, v88, v89
    v_cvt_pk_bf16_f32 v141, v90, v91
    v_cvt_pk_bf16_f32 v142, v92, v93
    v_cvt_pk_bf16_f32 v143, v94, v95
    v_min_u32 v140, -2, v140
    v_min_u32 v142, -2, v142
    v_min_u32 v141, -2, v141
    v_min_u32 v143, -2, v143
    v_permlane16_swap_b32 v140, v142
    s_nop 0
    v_permlane16_swap_b32 v141, v143
    buffer_store_dwordx4 v[140:143], v19, s[4:7], s48 offen offset:2048 sc1
    v_pk_mul_f32 v[96:97], v[96:97], v[220:221]
    v_pk_mul_f32 v[98:99], v[98:99], v[222:223]
    v_pk_mul_f32 v[100:101], v[100:101], v[224:225]
    v_pk_mul_f32 v[102:103], v[102:103], v[226:227]
    v_cvt_pk_bf16_f32 v144, v96, v97
    v_cvt_pk_bf16_f32 v145, v98, v99
    v_cvt_pk_bf16_f32 v146, v100, v101
    v_cvt_pk_bf16_f32 v147, v102, v103
    v_min_u32 v144, -2, v144
    v_min_u32 v146, -2, v146
    v_min_u32 v145, -2, v145
    v_min_u32 v147, -2, v147
    v_permlane16_swap_b32 v144, v146
    s_nop 0
    v_permlane16_swap_b32 v145, v147
    buffer_store_dwordx4 v[144:147], v1, s[4:7], s49 offen offset:0 sc1
    v_pk_mul_f32 v[104:105], v[104:105], v[228:229]
    v_pk_mul_f32 v[106:107], v[106:107], v[230:231]
    v_pk_mul_f32 v[108:109], v[108:109], v[232:233]
    v_pk_mul_f32 v[110:111], v[110:111], v[234:235]
    v_cvt_pk_bf16_f32 v148, v104, v105
    v_cvt_pk_bf16_f32 v149, v106, v107
    v_cvt_pk_bf16_f32 v150, v108, v109
    v_cvt_pk_bf16_f32 v151, v110, v111
    v_min_u32 v148, -2, v148
    v_min_u32 v150, -2, v150
    v_min_u32 v149, -2, v149
    v_min_u32 v151, -2, v151
    v_permlane16_swap_b32 v148, v150
    s_nop 0
    v_permlane16_swap_b32 v149, v151
    buffer_store_dwordx4 v[148:151], v19, s[4:7], s49 offen offset:0 sc1
    v_lshlrev_b32 v236, 16, v248
    v_and_b32 v237, s38, v248
    v_lshlrev_b32 v238, 16, v249
    v_and_b32 v239, s38, v249
    v_lshlrev_b32 v240, 16, v250
    v_and_b32 v241, s38, v250
    v_lshlrev_b32 v242, 16, v251
    v_and_b32 v243, s38, v251
    s_waitcnt lgkmcnt(0)
    v_pk_add_f32 v[112:113], v[112:113], v[120:121]
    v_pk_add_f32 v[114:115], v[114:115], v[122:123]
    v_pk_add_f32 v[116:117], v[116:117], v[124:125]
    v_pk_add_f32 v[118:119], v[118:119], v[126:127]
    v_pk_mul_f32 v[112:113], v[112:113], v[236:237]
    v_pk_mul_f32 v[114:115], v[114:115], v[238:239]
    v_pk_mul_f32 v[116:117], v[116:117], v[240:241]
    v_pk_mul_f32 v[118:119], v[118:119], v[242:243]
    v_cvt_pk_bf16_f32 v152, v112, v113
    v_cvt_pk_bf16_f32 v153, v114, v115
    v_cvt_pk_bf16_f32 v154, v116, v117
    v_cvt_pk_bf16_f32 v155, v118, v119
    v_min_u32 v152, -2, v152
    v_min_u32 v154, -2, v154
    v_min_u32 v153, -2, v153
    v_min_u32 v155, -2, v155
    v_permlane16_swap_b32 v152, v154
    s_nop 0
    v_permlane16_swap_b32 v153, v155
    buffer_store_dwordx4 v[152:155], v1, s[4:7], s43 offen sc1
LF_go:
    v_mov_b32 v12, v23
    v_mov_b32 v13, v24
    v_mov_b32 v10, v25
    s_and_b32 s26, s2, 7
    s_lshr_b32 s27, s2, 3
    s_lshr_b32 s24, s26, 0
    s_mul_i32 s24, s24, 2
    s_lshr_b32 s25, s27, 4
    s_add_u32 s24, s24, s25
    s_and_b32 s25, s26, 0
    s_lshl_b32 s25, s25, 4
    s_and_b32 s27, s27, 15
    s_add_u32 s25, s25, s27
    s_and_b32 s18, s3, 3
    s_lshl_b32 s17, s24, 2
    s_add_u32 s18, s18, s17
    s_lshr_b32 s19, s3, 2
    s_lshl_b32 s22, s25, 1
    s_add_u32 s22, s22, s19
    s_lshl_b32 s23, s18, 5
    s_add_u32 s23, s23, s22
    s_lshl_b32 s20, s23, 11
    s_add_u32 s20, s20, 9437184
    v_lshrrev_b32 v4, 5, v0
    v_mul_u32_u24 v4, 1024, v4
    v_bfe_u32 v5, v0, 2, 2
    v_lshl_add_u32 v4, v5, 6, v4
    v_bfe_u32 v5, v0, 4, 1
    v_lshl_add_u32 v4, v5, 5, v4
    v_bfe_u32 v5, v0, 1, 1
    v_lshl_add_u32 v4, v5, 3, v4
    v_and_b32 v5, 1, v0
    v_lshl_add_u32 v4, v5, 4, v4
    s_mul_i32 s17, s19, 82432
    v_add_u32 v4, s17, v4
    v_xor_b32 v5, 512, v4
    v_add_u32 v6, 0x10000, v4
    v_add_u32 v7, 0x10000, v5
    s_waitcnt lgkmcnt(0)
    buffer_load_dwordx4 v[16:19], v1, s[4:7], s20 offen offset:0 sc1
    buffer_load_dwordx4 v[20:23], v1, s[4:7], s20 offen offset:1024 sc1
    s_mov_b32 s12, s84
    s_and_b32 s13, s85, 0xffff
    s_mov_b32 s14, 0x400000
    s_mov_b32 s15, 0x20000
    v_and_b32 v14, 31, v0
    v_lshrrev_b32 v15, 5, v0
    v_lshlrev_b32 v11, 11, v14
    v_lshl_add_u32 v11, v15, 4, v11
    s_lshl_b32 s21, s18, 16
    s_lshl_b32 s17, s22, 6
    s_add_u32 s21, s21, s17
    s_lshl_b32 s31, s18, 1
    s_add_u32 s31, s31, s19
    s_mul_i32 s16, s31, 57344
    s_add_u32 s16, s16, 33554432
    s_mov_b32 s61, s16
    s_mov_b32 s92, 300000
    s_waitcnt vmcnt(0) lgkmcnt(0)
    s_barrier
    s_cmp_lt_u32 s3, 4
    s_cbranch_scc1 LF_np
    ds_write_b128 v10, v[212:215] offset:24576
    ds_write_b128 v10, v[216:219] offset:25600
LF_np:
    ds_read_b64_tr_b16 v[64:65], v4 offset:0
    ds_read_b64_tr_b16 v[66:67], v4 offset:256
    ds_read_b64_tr_b16 v[68:69], v5 offset:0
    ds_read_b64_tr_b16 v[70:71], v5 offset:256
    ds_read_b64_tr_b16 v[72:73], v4 offset:2048
    ds_read_b64_tr_b16 v[74:75], v4 offset:2304
    ds_read_b64_tr_b16 v[76:77], v5 offset:2048
    ds_read_b64_tr_b16 v[78:79], v5 offset:2304
    buffer_load_dwordx4 v[144:147], v1, s[4:7], s16 offen offset:0 sc1
    buffer_load_dwordx4 v[148:151], v1, s[4:7], s16 offen offset:1024 sc1
    buffer_load_dwordx4 v[152:155], v1, s[4:7], s16 offen offset:2048 sc1
    buffer_load_dwordx4 v[156:159], v1, s[4:7], s16 offen offset:3072 sc1
    s_add_u32 s16, s16, 4096
    buffer_load_dwordx4 v[160:163], v1, s[4:7], s16 offen offset:0 sc1
    buffer_load_dwordx4 v[164:167], v1, s[4:7], s16 offen offset:1024 sc1
    buffer_load_dwordx4 v[168:171], v1, s[4:7], s16 offen offset:2048 sc1
    buffer_load_dwordx4 v[172:175], v1, s[4:7], s16 offen offset:3072 sc1
    s_add_u32 s16, s16, 4096
    s_waitcnt vmcnt(6) lgkmcnt(0)
Lpo19:
    v_max3_u32 v8, v144, v145, v146
    v_max3_u32 v9, v148, v149, v150
    v_max3_u32 v8, v8, v147, v151
    v_max_u32 v8, v8, v9
    v_cmp_eq_u32 vcc, -1, v8
    s_nop 0
    s_cmp_lg_u64 vcc, 0
    s_cbranch_scc1 Lpo19r
Lpo19b:
    v_mfma_f32_32x32x16_bf16 v[32:47], v[64:67], v[144:147], 0
    ds_read_b64_tr_b16 v[80:81], v4 offset:4096
    ds_read_b64_tr_b16 v[82:83], v4 offset:4352
    ds_read_b64_tr_b16 v[84:85], v5 offset:4096
    ds_read_b64_tr_b16 v[86:87], v5 offset:4352
    v_mfma_f32_32x32x16_bf16 v[48:63], v[68:71], v[144:147], 0
    ds_read_b64_tr_b16 v[88:89], v4 offset:6144
    ds_read_b64_tr_b16 v[90:91], v4 offset:6400
    ds_read_b64_tr_b16 v[92:93], v5 offset:6144
    ds_read_b64_tr_b16 v[94:95], v5 offset:6400
    v_mfma_f32_32x32x16_bf16 v[32:47], v[72:75], v[148:151], v[32:47]
    v_mfma_f32_32x32x16_bf16 v[48:63], v[76:79], v[148:151], v[48:63]
    buffer_load_dwordx4 v[144:147], v1, s[4:7], s16 offen offset:0 sc1
    buffer_load_dwordx4 v[148:151], v1, s[4:7], s16 offen offset:1024 sc1
    s_waitcnt vmcnt(6) lgkmcnt(0)
Lpo20:
    v_max3_u32 v8, v152, v153, v154
    v_max3_u32 v9, v156, v157, v158
    v_max3_u32 v8, v8, v155, v159
    v_max_u32 v8, v8, v9
    v_cmp_eq_u32 vcc, -1, v8
    s_nop 0
    s_cmp_lg_u64 vcc, 0
    s_cbranch_scc1 Lpo20r
Lpo20b:
    v_mfma_f32_32x32x16_bf16 v[32:47], v[80:83], v[152:155], v[32:47]
    ds_read_b64_tr_b16 v[64:65], v4 offset:8192
    ds_read_b64_tr_b16 v[66:67], v4 offset:8448
    ds_read_b64_tr_b16 v[68:69], v5 offset:8192
    ds_read_b64_tr_b16 v[70:71], v5 offset:8448
    v_mfma_f32_32x32x16_bf16 v[48:63], v[84:87], v[152:155], v[48:63]
    ds_read_b64_tr_b16 v[72:73], v4 offset:10240
    ds_read_b64_tr_b16 v[74:75], v4 offset:10496
    ds_read_b64_tr_b16 v[76:77], v5 offset:10240
    ds_read_b64_tr_b16 v[78:79], v5 offset:10496
    v_mfma_f32_32x32x16_bf16 v[32:47], v[88:91], v[156:159], v[32:47]
    v_mfma_f32_32x32x16_bf16 v[48:63], v[92:95], v[156:159], v[48:63]
    buffer_load_dwordx4 v[152:155], v1, s[4:7], s16 offen offset:2048 sc1
    buffer_load_dwordx4 v[156:159], v1, s[4:7], s16 offen offset:3072 sc1
    s_add_u32 s16, s16, 4096
    s_waitcnt vmcnt(6) lgkmcnt(0)
Lpo21:
    v_max3_u32 v8, v160, v161, v162
    v_max3_u32 v9, v164, v165, v166
    v_max3_u32 v8, v8, v163, v167
    v_max_u32 v8, v8, v9
    v_cmp_eq_u32 vcc, -1, v8
    s_nop 0
    s_cmp_lg_u64 vcc, 0
    s_cbranch_scc1 Lpo21r
Lpo21b:
    v_mfma_f32_32x32x16_bf16 v[32:47], v[64:67], v[160:163], v[32:47]
    ds_read_b64_tr_b16 v[80:81], v4 offset:12288
    ds_read_b64_tr_b16 v[82:83], v4 offset:12544
    ds_read_b64_tr_b16 v[84:85], v5 offset:12288
    ds_read_b64_tr_b16 v[86:87], v5 offset:12544
    v_mfma_f32_32x32x16_bf16 v[48:63], v[68:71], v[160:163], v[48:63]
    ds_read_b64_tr_b16 v[88:89], v4 offset:14336
    ds_read_b64_tr_b16 v[90:91], v4 offset:14592
    ds_read_b64_tr_b16 v[92:93], v5 offset:14336
    ds_read_b64_tr_b16 v[94:95], v5 offset:14592
    v_mfma_f32_32x32x16_bf16 v[32:47], v[72:75], v[164:167], v[32:47]
    v_mfma_f32_32x32x16_bf16 v[48:63], v[76:79], v[164:167], v[48:63]
    buffer_load_dwordx4 v[160:163], v1, s[4:7], s16 offen offset:0 sc1
    buffer_load_dwordx4 v[164:167], v1, s[4:7], s16 offen offset:1024 sc1
    s_waitcnt vmcnt(6) lgkmcnt(0)
Lpo22:
    v_max3_u32 v8, v168, v169, v170
    v_max3_u32 v9, v172, v173, v174
    v_max3_u32 v8, v8, v171, v175
    v_max_u32 v8, v8, v9
    v_cmp_eq_u32 vcc, -1, v8
    s_nop 0
    s_cmp_lg_u64 vcc, 0
    s_cbranch_scc1 Lpo22r
Lpo22b:
    v_mfma_f32_32x32x16_bf16 v[32:47], v[80:83], v[168:171], v[32:47]
    ds_read_b64_tr_b16 v[64:65], v4 offset:16384
    ds_read_b64_tr_b16 v[66:67], v4 offset:16640
    ds_read_b64_tr_b16 v[68:69], v5 offset:16384
    ds_read_b64_tr_b16 v[70:71], v5 offset:16640
    v_mfma_f32_32x32x16_bf16 v[48:63], v[84:87], v[168:171], v[48:63]
    ds_read_b64_tr_b16 v[72:73], v4 offset:18432
    ds_read_b64_tr_b16 v[74:75], v4 offset:18688
    ds_read_b64_tr_b16 v[76:77], v5 offset:18432
    ds_read_b64_tr_b16 v[78:79], v5 offset:18688
    v_mfma_f32_32x32x16_bf16 v[32:47], v[88:91], v[172:175], v[32:47]
    v_mfma_f32_32x32x16_bf16 v[48:63], v[92:95], v[172:175], v[48:63]
    buffer_load_dwordx4 v[168:171], v1, s[4:7], s16 offen offset:2048 sc1
    buffer_load_dwordx4 v[172:175], v1, s[4:7], s16 offen offset:3072 sc1
    s_add_u32 s16, s16, 4096
    s_waitcnt vmcnt(6) lgkmcnt(0)
Lpo23:
    v_max3_u32 v8, v144, v145, v146
    v_max3_u32 v9, v148, v149, v150
    v_max3_u32 v8, v8, v147, v151
    v_max_u32 v8, v8, v9
    v_cmp_eq_u32 vcc, -1, v8
    s_nop 0
    s_cmp_lg_u64 vcc, 0
    s_cbranch_scc1 Lpo23r
Lpo23b:
    v_mfma_f32_32x32x16_bf16 v[32:47], v[64:67], v[144:147], v[32:47]
    ds_read_b64_tr_b16 v[80:81], v4 offset:20480
    ds_read_b64_tr_b16 v[82:83], v4 offset:20736
    ds_read_b64_tr_b16 v[84:85], v5 offset:20480
    ds_read_b64_tr_b16 v[86:87], v5 offset:20736
    v_mfma_f32_32x32x16_bf16 v[48:63], v[68:71], v[144:147], v[48:63]
    ds_read_b64_tr_b16 v[88:89], v4 offset:22528
    ds_read_b64_tr_b16 v[90:91], v4 offset:22784
    ds_read_b64_tr_b16 v[92:93], v5 offset:22528
    ds_read_b64_tr_b16 v[94:95], v5 offset:22784
    v_mfma_f32_32x32x16_bf16 v[32:47], v[72:75], v[148:151], v[32:47]
    v_mfma_f32_32x32x16_bf16 v[48:63], v[76:79], v[148:151], v[48:63]
    buffer_load_dwordx4 v[144:147], v1, s[4:7], s16 offen offset:0 sc1
    buffer_load_dwordx4 v[148:151], v1, s[4:7], s16 offen offset:1024 sc1
    s_waitcnt vmcnt(6) lgkmcnt(0)
Lpo24:
    v_max3_u32 v8, v152, v153, v154
    v_max3_u32 v9, v156, v157, v158
    v_max3_u32 v8, v8, v155, v159
    v_max_u32 v8, v8, v9
    v_cmp_eq_u32 vcc, -1, v8
    s_nop 0
    s_cmp_lg_u64 vcc, 0
    s_cbranch_scc1 Lpo24r
Lpo24b:
    v_mfma_f32_32x32x16_bf16 v[32:47], v[80:83], v[152:155], v[32:47]
    ds_read_b64_tr_b16 v[64:65], v4 offset:24576
    ds_read_b64_tr_b16 v[66:67], v4 offset:24832
    ds_read_b64_tr_b16 v[68:69], v5 offset:24576
    ds_read_b64_tr_b16 v[70:71], v5 offset:24832
    v_mfma_f32_32x32x16_bf16 v[48:63], v[84:87], v[152:155], v[48:63]
    ds_read_b64_tr_b16 v[72:73], v4 offset:26624
    ds_read_b64_tr_b16 v[74:75], v4 offset:26880
    ds_read_b64_tr_b16 v[76:77], v5 offset:26624
    ds_read_b64_tr_b16 v[78:79], v5 offset:26880
    v_mfma_f32_32x32x16_bf16 v[32:47], v[88:91], v[156:159], v[32:47]
    v_mfma_f32_32x32x16_bf16 v[48:63], v[92:95], v[156:159], v[48:63]
    buffer_load_dwordx4 v[152:155], v1, s[4:7], s16 offen offset:2048 sc1
    buffer_load_dwordx4 v[156:159], v1, s[4:7], s16 offen offset:3072 sc1
    s_add_u32 s16, s16, 4096
    s_waitcnt vmcnt(6) lgkmcnt(0)
Lpo25:
    v_max3_u32 v8, v160, v161, v162
    v_max3_u32 v9, v164, v165, v166
    v_max3_u32 v8, v8, v163, v167
    v_max_u32 v8, v8, v9
    v_cmp_eq_u32 vcc, -1, v8
    s_nop 0
    s_cmp_lg_u64 vcc, 0
    s_cbranch_scc1 Lpo25r
Lpo25b:
    v_mfma_f32_32x32x16_bf16 v[32:47], v[64:67], v[160:163], v[32:47]
    ds_read_b64_tr_b16 v[80:81], v4 offset:28672
    ds_read_b64_tr_b16 v[82:83], v4 offset:28928
    ds_read_b64_tr_b16 v[84:85], v5 offset:28672
    ds_read_b64_tr_b16 v[86:87], v5 offset:28928
    v_mfma_f32_32x32x16_bf16 v[48:63], v[68:71], v[160:163], v[48:63]
    ds_read_b64_tr_b16 v[88:89], v4 offset:30720
    ds_read_b64_tr_b16 v[90:91], v4 offset:30976
    ds_read_b64_tr_b16 v[92:93], v5 offset:30720
    ds_read_b64_tr_b16 v[94:95], v5 offset:30976
    v_mfma_f32_32x32x16_bf16 v[32:47], v[72:75], v[164:167], v[32:47]
    v_mfma_f32_32x32x16_bf16 v[48:63], v[76:79], v[164:167], v[48:63]
    buffer_load_dwordx4 v[160:163], v1, s[4:7], s16 offen offset:0 sc1
    buffer_load_dwordx4 v[164:167], v1, s[4:7], s16 offen offset:1024 sc1
    s_waitcnt vmcnt(6) lgkmcnt(0)
Lpo26:
    v_max3_u32 v8, v168, v169, v170
    v_max3_u32 v9, v172, v173, v174
    v_max3_u32 v8, v8, v171, v175
    v_max_u32 v8, v8, v9
    v_cmp_eq_u32 vcc, -1, v8
    s_nop 0
    s_cmp_lg_u64 vcc, 0
    s_cbranch_scc1 Lpo26r
Lpo26b:
    s_barrier
    s_cmp_lt_u32 s3, 4
    s_cbranch_scc1 Lrf27
    ds_write_b128 v12, v[108:111] offset:0
    ds_write_b128 v12, v[112:115] offset:1024
Lrf27:
    v_mfma_f32_32x32x16_bf16 v[32:47], v[80:83], v[168:171], v[32:47]
    ds_read_b64_tr_b16 v[64:65], v4 offset:32768
    ds_read_b64_tr_b16 v[66:67], v4 offset:33024
    ds_read_b64_tr_b16 v[68:69], v5 offset:32768
    ds_read_b64_tr_b16 v[70:71], v5 offset:33024
    v_mfma_f32_32x32x16_bf16 v[48:63], v[84:87], v[168:171], v[48:63]
    ds_read_b64_tr_b16 v[72:73], v4 offset:34816
    ds_read_b64_tr_b16 v[74:75], v4 offset:35072
    ds_read_b64_tr_b16 v[76:77], v5 offset:34816
    ds_read_b64_tr_b16 v[78:79], v5 offset:35072
    v_mfma_f32_32x32x16_bf16 v[32:47], v[88:91], v[172:175], v[32:47]
    v_mfma_f32_32x32x16_bf16 v[48:63], v[92:95], v[172:175], v[48:63]
    buffer_load_dwordx4 v[168:171], v1, s[4:7], s16 offen offset:2048 sc1
    buffer_load_dwordx4 v[172:175], v1, s[4:7], s16 offen offset:3072 sc1
    s_add_u32 s16, s16, 4096
    s_waitcnt vmcnt(6) lgkmcnt(0)
Lpo28:
    v_max3_u32 v8, v144, v145, v146
    v_max3_u32 v9, v148, v149, v150
    v_max3_u32 v8, v8, v147, v151
    v_max_u32 v8, v8, v9
    v_cmp_eq_u32 vcc, -1, v8
    s_nop 0
    s_cmp_lg_u64 vcc, 0
    s_cbranch_scc1 Lpo28r
Lpo28b:
    s_cmp_lt_u32 s3, 4
    s_cbranch_scc1 Lrf29
    ds_write_b128 v12, v[116:119] offset:8192
    ds_write_b128 v12, v[120:123] offset:9216
Lrf29:
    v_mfma_f32_32x32x16_bf16 v[32:47], v[64:67], v[144:147], v[32:47]
    ds_read_b64_tr_b16 v[80:81], v4 offset:36864
    ds_read_b64_tr_b16 v[82:83], v4 offset:37120
    ds_read_b64_tr_b16 v[84:85], v5 offset:36864
    ds_read_b64_tr_b16 v[86:87], v5 offset:37120
    v_mfma_f32_32x32x16_bf16 v[48:63], v[68:71], v[144:147], v[48:63]
    ds_read_b64_tr_b16 v[88:89], v4 offset:38912
    ds_read_b64_tr_b16 v[90:91], v4 offset:39168
    ds_read_b64_tr_b16 v[92:93], v5 offset:38912
    ds_read_b64_tr_b16 v[94:95], v5 offset:39168
    v_mfma_f32_32x32x16_bf16 v[32:47], v[72:75], v[148:151], v[32:47]
    v_mfma_f32_32x32x16_bf16 v[48:63], v[76:79], v[148:151], v[48:63]
    buffer_load_dwordx4 v[144:147], v1, s[4:7], s16 offen offset:0 sc1
    buffer_load_dwordx4 v[148:151], v1, s[4:7], s16 offen offset:1024 sc1
    s_waitcnt vmcnt(6) lgkmcnt(0)
Lpo30:
    v_max3_u32 v8, v152, v153, v154
    v_max3_u32 v9, v156, v157, v158
    v_max3_u32 v8, v8, v155, v159
    v_max_u32 v8, v8, v9
    v_cmp_eq_u32 vcc, -1, v8
    s_nop 0
    s_cmp_lg_u64 vcc, 0
    s_cbranch_scc1 Lpo30r
Lpo30b:
    s_cmp_lt_u32 s3, 4
    s_cbranch_scc1 Lrf31
    ds_write_b128 v12, v[124:127] offset:16384
    ds_write_b128 v12, v[128:131] offset:17408
Lrf31:
    v_mfma_f32_32x32x16_bf16 v[32:47], v[80:83], v[152:155], v[32:47]
    ds_read_b64_tr_b16 v[64:65], v4 offset:40960
    ds_read_b64_tr_b16 v[66:67], v4 offset:41216
    ds_read_b64_tr_b16 v[68:69], v5 offset:40960
    ds_read_b64_tr_b16 v[70:71], v5 offset:41216
    v_mfma_f32_32x32x16_bf16 v[48:63], v[84:87], v[152:155], v[48:63]
    ds_read_b64_tr_b16 v[72:73], v4 offset:43008
    ds_read_b64_tr_b16 v[74:75], v4 offset:43264
    ds_read_b64_tr_b16 v[76:77], v5 offset:43008
    ds_read_b64_tr_b16 v[78:79], v5 offset:43264
    v_mfma_f32_32x32x16_bf16 v[32:47], v[88:91], v[156:159], v[32:47]
    v_mfma_f32_32x32x16_bf16 v[48:63], v[92:95], v[156:159], v[48:63]
    buffer_load_dwordx4 v[152:155], v1, s[4:7], s16 offen offset:2048 sc1
    buffer_load_dwordx4 v[156:159], v1, s[4:7], s16 offen offset:3072 sc1
    s_add_u32 s16, s16, 4096
    s_waitcnt vmcnt(6) lgkmcnt(0)
Lpo32:
    v_max3_u32 v8, v160, v161, v162
    v_max3_u32 v9, v164, v165, v166
    v_max3_u32 v8, v8, v163, v167
    v_max_u32 v8, v8, v9
    v_cmp_eq_u32 vcc, -1, v8
    s_nop 0
    s_cmp_lg_u64 vcc, 0
    s_cbranch_scc1 Lpo32r
Lpo32b:
    s_cmp_lt_u32 s3, 4
    s_cbranch_scc1 Lrf33
    ds_write_b128 v12, v[132:135] offset:24576
    ds_write_b128 v12, v[136:139] offset:25600
Lrf33:
    v_mfma_f32_32x32x16_bf16 v[32:47], v[64:67], v[160:163], v[32:47]
    ds_read_b64_tr_b16 v[80:81], v4 offset:45056
    ds_read_b64_tr_b16 v[82:83], v4 offset:45312
    ds_read_b64_tr_b16 v[84:85], v5 offset:45056
    ds_read_b64_tr_b16 v[86:87], v5 offset:45312
    v_mfma_f32_32x32x16_bf16 v[48:63], v[68:71], v[160:163], v[48:63]
    ds_read_b64_tr_b16 v[88:89], v4 offset:47104
    ds_read_b64_tr_b16 v[90:91], v4 offset:47360
    ds_read_b64_tr_b16 v[92:93], v5 offset:47104
    ds_read_b64_tr_b16 v[94:95], v5 offset:47360
    v_mfma_f32_32x32x16_bf16 v[32:47], v[72:75], v[164:167], v[32:47]
    v_mfma_f32_32x32x16_bf16 v[48:63], v[76:79], v[164:167], v[48:63]
    buffer_load_dwordx4 v[160:163], v1, s[4:7], s16 offen offset:0 sc1
    buffer_load_dwordx4 v[164:167], v1, s[4:7], s16 offen offset:1024 sc1
    s_waitcnt vmcnt(6) lgkmcnt(0)
Lpo34:
    v_max3_u32 v8, v168, v169, v170
    v_max3_u32 v9, v172, v173, v174
    v_max3_u32 v8, v8, v171, v175
    v_max_u32 v8, v8, v9
    v_cmp_eq_u32 vcc, -1, v8
    s_nop 0
    s_cmp_lg_u64 vcc, 0
    s_cbranch_scc1 Lpo34r
Lpo34b:
    s_cmp_lt_u32 s3, 4
    s_cbranch_scc1 Lrf35
    ds_write_b128 v13, v[220:223] offset:16384
    ds_write_b128 v13, v[224:227] offset:17408
Lrf35:
    v_mfma_f32_32x32x16_bf16 v[32:47], v[80:83], v[168:171], v[32:47]
    ds_read_b64_tr_b16 v[64:65], v4 offset:49152
    ds_read_b64_tr_b16 v[66:67], v4 offset:49408
    ds_read_b64_tr_b16 v[68:69], v5 offset:49152
    ds_read_b64_tr_b16 v[70:71], v5 offset:49408
    v_mfma_f32_32x32x16_bf16 v[48:63], v[84:87], v[168:171], v[48:63]
    ds_read_b64_tr_b16 v[72:73], v4 offset:51200
    ds_read_b64_tr_b16 v[74:75], v4 offset:51456
    ds_read_b64_tr_b16 v[76:77], v5 offset:51200
    ds_read_b64_tr_b16 v[78:79], v5 offset:51456
    v_mfma_f32_32x32x16_bf16 v[32:47], v[88:91], v[172:175], v[32:47]
    v_mfma_f32_32x32x16_bf16 v[48:63], v[92:95], v[172:175], v[48:63]
    buffer_load_dwordx4 v[168:171], v1, s[4:7], s16 offen offset:2048 sc1
    buffer_load_dwordx4 v[172:175], v1, s[4:7], s16 offen offset:3072 sc1
    s_add_u32 s16, s16, 4096
    s_waitcnt vmcnt(6) lgkmcnt(0)
Lpo36:
    v_max3_u32 v8, v144, v145, v146
    v_max3_u32 v9, v148, v149, v150
    v_max3_u32 v8, v8, v147, v151
    v_max_u32 v8, v8, v9
    v_cmp_eq_u32 vcc, -1, v8
    s_nop 0
    s_cmp_lg_u64 vcc, 0
    s_cbranch_scc1 Lpo36r
Lpo36b:
    s_cmp_lt_u32 s3, 4
    s_cbranch_scc1 Lrf37
    ds_write_b128 v13, v[228:231] offset:24576
    ds_write_b128 v13, v[232:235] offset:25600
Lrf37:
    v_mfma_f32_32x32x16_bf16 v[32:47], v[64:67], v[144:147], v[32:47]
    ds_read_b64_tr_b16 v[80:81], v4 offset:53248
    ds_read_b64_tr_b16 v[82:83], v4 offset:53504
    ds_read_b64_tr_b16 v[84:85], v5 offset:53248
    ds_read_b64_tr_b16 v[86:87], v5 offset:53504
    v_mfma_f32_32x32x16_bf16 v[48:63], v[68:71], v[144:147], v[48:63]
    ds_read_b64_tr_b16 v[88:89], v4 offset:55296
    ds_read_b64_tr_b16 v[90:91], v4 offset:55552
    ds_read_b64_tr_b16 v[92:93], v5 offset:55296
    ds_read_b64_tr_b16 v[94:95], v5 offset:55552
    v_mfma_f32_32x32x16_bf16 v[32:47], v[72:75], v[148:151], v[32:47]
    v_mfma_f32_32x32x16_bf16 v[48:63], v[76:79], v[148:151], v[48:63]
    buffer_load_dwordx4 v[144:147], v1, s[4:7], s16 offen offset:0 sc1
    buffer_load_dwordx4 v[148:151], v1, s[4:7], s16 offen offset:1024 sc1
    s_waitcnt vmcnt(6) lgkmcnt(0)
Lpo38:
    v_max3_u32 v8, v152, v153, v154
    v_max3_u32 v9, v156, v157, v158
    v_max3_u32 v8, v8, v155, v159
    v_max_u32 v8, v8, v9
    v_cmp_eq_u32 vcc, -1, v8
    s_nop 0
    s_cmp_lg_u64 vcc, 0
    s_cbranch_scc1 Lpo38r
Lpo38b:
    s_cmp_lt_u32 s3, 4
    s_cbranch_scc1 Lrf39
    ds_write_b128 v13, v[236:239] offset:32768
    ds_write_b128 v13, v[240:243] offset:33792
Lrf39:
    v_mfma_f32_32x32x16_bf16 v[32:47], v[80:83], v[152:155], v[32:47]
    ds_read_b64_tr_b16 v[64:65], v4 offset:57344
    ds_read_b64_tr_b16 v[66:67], v4 offset:57600
    ds_read_b64_tr_b16 v[68:69], v5 offset:57344
    ds_read_b64_tr_b16 v[70:71], v5 offset:57600
    v_mfma_f32_32x32x16_bf16 v[48:63], v[84:87], v[152:155], v[48:63]
    ds_read_b64_tr_b16 v[72:73], v4 offset:59392
    ds_read_b64_tr_b16 v[74:75], v4 offset:59648
    ds_read_b64_tr_b16 v[76:77], v5 offset:59392
    ds_read_b64_tr_b16 v[78:79], v5 offset:59648
    v_mfma_f32_32x32x16_bf16 v[32:47], v[88:91], v[156:159], v[32:47]
    v_mfma_f32_32x32x16_bf16 v[48:63], v[92:95], v[156:159], v[48:63]
    buffer_load_dwordx4 v[152:155], v1, s[4:7], s16 offen offset:2048 sc1
    buffer_load_dwordx4 v[156:159], v1, s[4:7], s16 offen offset:3072 sc1
    s_add_u32 s16, s16, 4096
    s_waitcnt vmcnt(6) lgkmcnt(0)
Lpo40:
    v_max3_u32 v8, v160, v161, v162
    v_max3_u32 v9, v164, v165, v166
    v_max3_u32 v8, v8, v163, v167
    v_max_u32 v8, v8, v9
    v_cmp_eq_u32 vcc, -1, v8
    s_nop 0
    s_cmp_lg_u64 vcc, 0
    s_cbranch_scc1 Lpo40r
Lpo40b:
    s_cmp_lt_u32 s3, 4
    s_cbranch_scc1 Lrf41
    ds_write_b128 v13, v[244:247] offset:40960
    ds_write_b128 v13, v[248:251] offset:41984
Lrf41:
    v_mfma_f32_32x32x16_bf16 v[32:47], v[64:67], v[160:163], v[32:47]
    ds_read_b64_tr_b16 v[80:81], v4 offset:61440
    ds_read_b64_tr_b16 v[82:83], v4 offset:61696
    ds_read_b64_tr_b16 v[84:85], v5 offset:61440
    ds_read_b64_tr_b16 v[86:87], v5 offset:61696
    v_mfma_f32_32x32x16_bf16 v[48:63], v[68:71], v[160:163], v[48:63]
    ds_read_b64_tr_b16 v[88:89], v4 offset:63488
    ds_read_b64_tr_b16 v[90:91], v4 offset:63744
    ds_read_b64_tr_b16 v[92:93], v5 offset:63488
    ds_read_b64_tr_b16 v[94:95], v5 offset:63744
    v_mfma_f32_32x32x16_bf16 v[32:47], v[72:75], v[164:167], v[32:47]
    v_mfma_f32_32x32x16_bf16 v[48:63], v[76:79], v[164:167], v[48:63]
    buffer_load_dwordx4 v[160:163], v1, s[4:7], s16 offen offset:0 sc1
    buffer_load_dwordx4 v[164:167], v1, s[4:7], s16 offen offset:1024 sc1
    s_waitcnt vmcnt(6) lgkmcnt(0)
Lpo42:
    v_max3_u32 v8, v168, v169, v170
    v_max3_u32 v9, v172, v173, v174
    v_max3_u32 v8, v8, v171, v175
    v_max_u32 v8, v8, v9
    v_cmp_eq_u32 vcc, -1, v8
    s_nop 0
    s_cmp_lg_u64 vcc, 0
    s_cbranch_scc1 Lpo42r
Lpo42b:
    v_mfma_f32_32x32x16_bf16 v[32:47], v[80:83], v[168:171], v[32:47]
    ds_read_b64_tr_b16 v[64:65], v6 offset:0
    ds_read_b64_tr_b16 v[66:67], v6 offset:256
    ds_read_b64_tr_b16 v[68:69], v7 offset:0
    ds_read_b64_tr_b16 v[70:71], v7 offset:256
    v_mfma_f32_32x32x16_bf16 v[48:63], v[84:87], v[168:171], v[48:63]
    ds_read_b64_tr_b16 v[72:73], v6 offset:2048
    ds_read_b64_tr_b16 v[74:75], v6 offset:2304
    ds_read_b64_tr_b16 v[76:77], v7 offset:2048
    ds_read_b64_tr_b16 v[78:79], v7 offset:2304
    v_mfma_f32_32x32x16_bf16 v[32:47], v[88:91], v[172:175], v[32:47]
    v_mfma_f32_32x32x16_bf16 v[48:63], v[92:95], v[172:175], v[48:63]
    buffer_load_dwordx4 v[168:171], v1, s[4:7], s16 offen offset:2048 sc1
    buffer_load_dwordx4 v[172:175], v1, s[4:7], s16 offen offset:3072 sc1
    s_add_u32 s16, s16, 4096
    s_waitcnt vmcnt(6) lgkmcnt(0)
Lpo43:
    v_max3_u32 v8, v144, v145, v146
    v_max3_u32 v9, v148, v149, v150
    v_max3_u32 v8, v8, v147, v151
    v_max_u32 v8, v8, v9
    v_cmp_eq_u32 vcc, -1, v8
    s_nop 0
    s_cmp_lg_u64 vcc, 0
    s_cbranch_scc1 Lpo43r
Lpo43b:
    v_mfma_f32_32x32x16_bf16 v[32:47], v[64:67], v[144:147], v[32:47]
    ds_read_b64_tr_b16 v[80:81], v6 offset:4096
    ds_read_b64_tr_b16 v[82:83], v6 offset:4352
    ds_read_b64_tr_b16 v[84:85], v7 offset:4096
    ds_read_b64_tr_b16 v[86:87], v7 offset:4352
    v_mfma_f32_32x32x16_bf16 v[48:63], v[68:71], v[144:147], v[48:63]
    ds_read_b64_tr_b16 v[88:89], v6 offset:6144
    ds_read_b64_tr_b16 v[90:91], v6 offset:6400
    ds_read_b64_tr_b16 v[92:93], v7 offset:6144
    ds_read_b64_tr_b16 v[94:95], v7 offset:6400
    v_mfma_f32_32x32x16_bf16 v[32:47], v[72:75], v[148:151], v[32:47]
    v_mfma_f32_32x32x16_bf16 v[48:63], v[76:79], v[148:151], v[48:63]
    buffer_load_dwordx4 v[144:147], v1, s[4:7], s16 offen offset:0 sc1
    buffer_load_dwordx4 v[148:151], v1, s[4:7], s16 offen offset:1024 sc1
    s_waitcnt vmcnt(6) lgkmcnt(0)
Lpo44:
    v_max3_u32 v8, v152, v153, v154
    v_max3_u32 v9, v156, v157, v158
    v_max3_u32 v8, v8, v155, v159
    v_max_u32 v8, v8, v9
    v_cmp_eq_u32 vcc, -1, v8
    s_nop 0
    s_cmp_lg_u64 vcc, 0
    s_cbranch_scc1 Lpo44r
Lpo44b:
    v_mfma_f32_32x32x16_bf16 v[32:47], v[80:83], v[152:155], v[32:47]
    ds_read_b64_tr_b16 v[64:65], v6 offset:8192
    ds_read_b64_tr_b16 v[66:67], v6 offset:8448
    ds_read_b64_tr_b16 v[68:69], v7 offset:8192
    ds_read_b64_tr_b16 v[70:71], v7 offset:8448
    v_mfma_f32_32x32x16_bf16 v[48:63], v[84:87], v[152:155], v[48:63]
    ds_read_b64_tr_b16 v[72:73], v6 offset:10240
    ds_read_b64_tr_b16 v[74:75], v6 offset:10496
    ds_read_b64_tr_b16 v[76:77], v7 offset:10240
    ds_read_b64_tr_b16 v[78:79], v7 offset:10496
    v_mfma_f32_32x32x16_bf16 v[32:47], v[88:91], v[156:159], v[32:47]
    v_mfma_f32_32x32x16_bf16 v[48:63], v[92:95], v[156:159], v[48:63]
    buffer_load_dwordx4 v[152:155], v1, s[4:7], s16 offen offset:2048 sc1
    buffer_load_dwordx4 v[156:159], v1, s[4:7], s16 offen offset:3072 sc1
    s_add_u32 s16, s16, 4096
    s_waitcnt vmcnt(6) lgkmcnt(0)
Lpo45:
    v_max3_u32 v8, v160, v161, v162
    v_max3_u32 v9, v164, v165, v166
    v_max3_u32 v8, v8, v163, v167
    v_max_u32 v8, v8, v9
    v_cmp_eq_u32 vcc, -1, v8
    s_nop 0
    s_cmp_lg_u64 vcc, 0
    s_cbranch_scc1 Lpo45r
Lpo45b:
    v_mfma_f32_32x32x16_bf16 v[32:47], v[64:67], v[160:163], v[32:47]
    ds_read_b64_tr_b16 v[80:81], v6 offset:12288
    ds_read_b64_tr_b16 v[82:83], v6 offset:12544
    ds_read_b64_tr_b16 v[84:85], v7 offset:12288
    ds_read_b64_tr_b16 v[86:87], v7 offset:12544
    v_mfma_f32_32x32x16_bf16 v[48:63], v[68:71], v[160:163], v[48:63]
    ds_read_b64_tr_b16 v[88:89], v6 offset:14336
    ds_read_b64_tr_b16 v[90:91], v6 offset:14592
    ds_read_b64_tr_b16 v[92:93], v7 offset:14336
    ds_read_b64_tr_b16 v[94:95], v7 offset:14592
    v_mfma_f32_32x32x16_bf16 v[32:47], v[72:75], v[164:167], v[32:47]
    v_mfma_f32_32x32x16_bf16 v[48:63], v[76:79], v[164:167], v[48:63]
    buffer_load_dwordx4 v[160:163], v1, s[4:7], s16 offen offset:0 sc1
    buffer_load_dwordx4 v[164:167], v1, s[4:7], s16 offen offset:1024 sc1
    s_waitcnt vmcnt(6) lgkmcnt(0)
Lpo46:
    v_max3_u32 v8, v168, v169, v170
    v_max3_u32 v9, v172, v173, v174
    v_max3_u32 v8, v8, v171, v175
    v_max_u32 v8, v8, v9
    v_cmp_eq_u32 vcc, -1, v8
    s_nop 0
    s_cmp_lg_u64 vcc, 0
    s_cbranch_scc1 Lpo46r
Lpo46b:
    s_barrier
    v_mfma_f32_32x32x16_bf16 v[32:47], v[80:83], v[168:171], v[32:47]
    ds_read_b64_tr_b16 v[64:65], v4 offset:0
    ds_read_b64_tr_b16 v[66:67], v4 offset:256
    ds_read_b64_tr_b16 v[68:69], v5 offset:0
    ds_read_b64_tr_b16 v[70:71], v5 offset:256
    v_mfma_f32_32x32x16_bf16 v[48:63], v[84:87], v[168:171], v[48:63]
    ds_read_b64_tr_b16 v[72:73], v4 offset:2048
    ds_read_b64_tr_b16 v[74:75], v4 offset:2304
    ds_read_b64_tr_b16 v[76:77], v5 offset:2048
    ds_read_b64_tr_b16 v[78:79], v5 offset:2304
    v_mfma_f32_32x32x16_bf16 v[32:47], v[88:91], v[172:175], v[32:47]
    v_mfma_f32_32x32x16_bf16 v[48:63], v[92:95], v[172:175], v[48:63]
    buffer_load_dwordx4 v[168:171], v1, s[4:7], s16 offen offset:2048 sc1
    buffer_load_dwordx4 v[172:175], v1, s[4:7], s16 offen offset:3072 sc1
    s_add_u32 s16, s16, 4096
    s_waitcnt vmcnt(6) lgkmcnt(0)
Lpo47:
    v_max3_u32 v8, v144, v145, v146
    v_max3_u32 v9, v148, v149, v150
    v_max3_u32 v8, v8, v147, v151
    v_max_u32 v8, v8, v9
    v_cmp_eq_u32 vcc, -1, v8
    s_nop 0
    s_cmp_lg_u64 vcc, 0
    s_cbranch_scc1 Lpo47r
Lpo47b:
    v_mfma_f32_32x32x16_bf16 v[32:47], v[64:67], v[144:147], v[32:47]
    ds_read_b64_tr_b16 v[80:81], v4 offset:4096
    ds_read_b64_tr_b16 v[82:83], v4 offset:4352
    ds_read_b64_tr_b16 v[84:85], v5 offset:4096
    ds_read_b64_tr_b16 v[86:87], v5 offset:4352
    v_mfma_f32_32x32x16_bf16 v[48:63], v[68:71], v[144:147], v[48:63]
    ds_read_b64_tr_b16 v[88:89], v4 offset:6144
    ds_read_b64_tr_b16 v[90:91], v4 offset:6400
    ds_read_b64_tr_b16 v[92:93], v5 offset:6144
    ds_read_b64_tr_b16 v[94:95], v5 offset:6400
    v_mfma_f32_32x32x16_bf16 v[32:47], v[72:75], v[148:151], v[32:47]
    v_mfma_f32_32x32x16_bf16 v[48:63], v[76:79], v[148:151], v[48:63]
    buffer_load_dwordx4 v[144:147], v1, s[4:7], s16 offen offset:0 sc1
    buffer_load_dwordx4 v[148:151], v1, s[4:7], s16 offen offset:1024 sc1
    s_waitcnt vmcnt(6) lgkmcnt(0)
Lpo48:
    v_max3_u32 v8, v152, v153, v154
    v_max3_u32 v9, v156, v157, v158
    v_max3_u32 v8, v8, v155, v159
    v_max_u32 v8, v8, v9
    v_cmp_eq_u32 vcc, -1, v8
    s_nop 0
    s_cmp_lg_u64 vcc, 0
    s_cbranch_scc1 Lpo48r
Lpo48b:
    v_mfma_f32_32x32x16_bf16 v[32:47], v[80:83], v[152:155], v[32:47]
    ds_read_b64_tr_b16 v[64:65], v4 offset:8192
    ds_read_b64_tr_b16 v[66:67], v4 offset:8448
    ds_read_b64_tr_b16 v[68:69], v5 offset:8192
    ds_read_b64_tr_b16 v[70:71], v5 offset:8448
    v_mfma_f32_32x32x16_bf16 v[48:63], v[84:87], v[152:155], v[48:63]
    ds_read_b64_tr_b16 v[72:73], v4 offset:10240
    ds_read_b64_tr_b16 v[74:75], v4 offset:10496
    ds_read_b64_tr_b16 v[76:77], v5 offset:10240
    ds_read_b64_tr_b16 v[78:79], v5 offset:10496
    v_mfma_f32_32x32x16_bf16 v[32:47], v[88:91], v[156:159], v[32:47]
    v_mfma_f32_32x32x16_bf16 v[48:63], v[92:95], v[156:159], v[48:63]
    buffer_load_dwordx4 v[152:155], v1, s[4:7], s16 offen offset:2048 sc1
    buffer_load_dwordx4 v[156:159], v1, s[4:7], s16 offen offset:3072 sc1
    s_add_u32 s16, s16, 4096
    s_waitcnt vmcnt(6) lgkmcnt(0)
Lpo49:
    v_max3_u32 v8, v160, v161, v162
    v_max3_u32 v9, v164, v165, v166
    v_max3_u32 v8, v8, v163, v167
    v_max_u32 v8, v8, v9
    v_cmp_eq_u32 vcc, -1, v8
    s_nop 0
    s_cmp_lg_u64 vcc, 0
    s_cbranch_scc1 Lpo49r
Lpo49b:
    v_mfma_f32_32x32x16_bf16 v[32:47], v[64:67], v[160:163], v[32:47]
    ds_read_b64_tr_b16 v[80:81], v4 offset:12288
    ds_read_b64_tr_b16 v[82:83], v4 offset:12544
    ds_read_b64_tr_b16 v[84:85], v5 offset:12288
    ds_read_b64_tr_b16 v[86:87], v5 offset:12544
    v_mfma_f32_32x32x16_bf16 v[48:63], v[68:71], v[160:163], v[48:63]
    ds_read_b64_tr_b16 v[88:89], v4 offset:14336
    ds_read_b64_tr_b16 v[90:91], v4 offset:14592
    ds_read_b64_tr_b16 v[92:93], v5 offset:14336
    ds_read_b64_tr_b16 v[94:95], v5 offset:14592
    v_mfma_f32_32x32x16_bf16 v[32:47], v[72:75], v[164:167], v[32:47]
    v_mfma_f32_32x32x16_bf16 v[48:63], v[76:79], v[164:167], v[48:63]
    buffer_load_dwordx4 v[160:163], v1, s[4:7], s16 offen offset:0 sc1
    buffer_load_dwordx4 v[164:167], v1, s[4:7], s16 offen offset:1024 sc1
    s_waitcnt vmcnt(6) lgkmcnt(0)
Lpo50:
    v_max3_u32 v8, v168, v169, v170
    v_max3_u32 v9, v172, v173, v174
    v_max3_u32 v8, v8, v171, v175
    v_max_u32 v8, v8, v9
    v_cmp_eq_u32 vcc, -1, v8
    s_nop 0
    s_cmp_lg_u64 vcc, 0
    s_cbranch_scc1 Lpo50r
Lpo50b:
    v_mfma_f32_32x32x16_bf16 v[32:47], v[80:83], v[168:171], v[32:47]
    ds_read_b64_tr_b16 v[64:65], v4 offset:16384
    ds_read_b64_tr_b16 v[66:67], v4 offset:16640
    ds_read_b64_tr_b16 v[68:69], v5 offset:16384
    ds_read_b64_tr_b16 v[70:71], v5 offset:16640
    v_mfma_f32_32x32x16_bf16 v[48:63], v[84:87], v[168:171], v[48:63]
    ds_read_b64_tr_b16 v[72:73], v4 offset:18432
    ds_read_b64_tr_b16 v[74:75], v4 offset:18688
    ds_read_b64_tr_b16 v[76:77], v5 offset:18432
    ds_read_b64_tr_b16 v[78:79], v5 offset:18688
    v_mfma_f32_32x32x16_bf16 v[32:47], v[88:91], v[172:175], v[32:47]
    v_mfma_f32_32x32x16_bf16 v[48:63], v[92:95], v[172:175], v[48:63]
    buffer_load_dwordx4 v[168:171], v1, s[4:7], s16 offen offset:2048 sc1
    buffer_load_dwordx4 v[172:175], v1, s[4:7], s16 offen offset:3072 sc1
    s_add_u32 s16, s16, 4096
    s_waitcnt vmcnt(6) lgkmcnt(0)
Lpo51:
    v_max3_u32 v8, v144, v145, v146
    v_max3_u32 v9, v148, v149, v150
    v_max3_u32 v8, v8, v147, v151
    v_max_u32 v8, v8, v9
    v_cmp_eq_u32 vcc, -1, v8
    s_nop 0
    s_cmp_lg_u64 vcc, 0
    s_cbranch_scc1 Lpo51r
Lpo51b:
    v_mfma_f32_32x32x16_bf16 v[32:47], v[64:67], v[144:147], v[32:47]
    ds_read_b64_tr_b16 v[80:81], v4 offset:20480
    ds_read_b64_tr_b16 v[82:83], v4 offset:20736
    ds_read_b64_tr_b16 v[84:85], v5 offset:20480
    ds_read_b64_tr_b16 v[86:87], v5 offset:20736
    v_mfma_f32_32x32x16_bf16 v[48:63], v[68:71], v[144:147], v[48:63]
    ds_read_b64_tr_b16 v[88:89], v4 offset:22528
    ds_read_b64_tr_b16 v[90:91], v4 offset:22784
    ds_read_b64_tr_b16 v[92:93], v5 offset:22528
    ds_read_b64_tr_b16 v[94:95], v5 offset:22784
    v_mfma_f32_32x32x16_bf16 v[32:47], v[72:75], v[148:151], v[32:47]
    v_mfma_f32_32x32x16_bf16 v[48:63], v[76:79], v[148:151], v[48:63]
    s_waitcnt vmcnt(4) lgkmcnt(0)
Lpo52:
    v_max3_u32 v8, v152, v153, v154
    v_max3_u32 v9, v156, v157, v158
    v_max3_u32 v8, v8, v155, v159
    v_max_u32 v8, v8, v9
    v_cmp_eq_u32 vcc, -1, v8
    s_nop 0
    s_cmp_lg_u64 vcc, 0
    s_cbranch_scc1 Lpo52r
Lpo52b:
    v_mfma_f32_32x32x16_bf16 v[32:47], v[80:83], v[152:155], v[32:47]
    ds_read_b64_tr_b16 v[64:65], v4 offset:24576
    ds_read_b64_tr_b16 v[66:67], v4 offset:24832
    ds_read_b64_tr_b16 v[68:69], v5 offset:24576
    ds_read_b64_tr_b16 v[70:71], v5 offset:24832
    v_mfma_f32_32x32x16_bf16 v[48:63], v[84:87], v[152:155], v[48:63]
    ds_read_b64_tr_b16 v[72:73], v4 offset:26624
    ds_read_b64_tr_b16 v[74:75], v4 offset:26880
    ds_read_b64_tr_b16 v[76:77], v5 offset:26624
    ds_read_b64_tr_b16 v[78:79], v5 offset:26880
    v_mfma_f32_32x32x16_bf16 v[32:47], v[88:91], v[156:159], v[32:47]
    v_mfma_f32_32x32x16_bf16 v[48:63], v[92:95], v[156:159], v[48:63]
    s_waitcnt vmcnt(2) lgkmcnt(0)
Lpo53:
    v_max3_u32 v8, v160, v161, v162
    v_max3_u32 v9, v164, v165, v166
    v_max3_u32 v8, v8, v163, v167
    v_max_u32 v8, v8, v9
    v_cmp_eq_u32 vcc, -1, v8
    s_nop 0
    s_cmp_lg_u64 vcc, 0
    s_cbranch_scc1 Lpo53r
Lpo53b:
    v_mfma_f32_32x32x16_bf16 v[32:47], v[64:67], v[160:163], v[32:47]
    ds_read_b64_tr_b16 v[80:81], v4 offset:28672
    ds_read_b64_tr_b16 v[82:83], v4 offset:28928
    ds_read_b64_tr_b16 v[84:85], v5 offset:28672
    ds_read_b64_tr_b16 v[86:87], v5 offset:28928
    v_mfma_f32_32x32x16_bf16 v[48:63], v[68:71], v[160:163], v[48:63]
    ds_read_b64_tr_b16 v[88:89], v4 offset:30720
    ds_read_b64_tr_b16 v[90:91], v4 offset:30976
    ds_read_b64_tr_b16 v[92:93], v5 offset:30720
    ds_read_b64_tr_b16 v[94:95], v5 offset:30976
    v_mfma_f32_32x32x16_bf16 v[32:47], v[72:75], v[164:167], v[32:47]
    v_mfma_f32_32x32x16_bf16 v[48:63], v[76:79], v[164:167], v[48:63]
    s_waitcnt vmcnt(0) lgkmcnt(0)
Lpo54:
    v_max3_u32 v8, v168, v169, v170
    v_max3_u32 v9, v172, v173, v174
    v_max3_u32 v8, v8, v171, v175
    v_max_u32 v8, v8, v9
    v_cmp_eq_u32 vcc, -1, v8
    s_nop 0
    s_cmp_lg_u64 vcc, 0
    s_cbranch_scc1 Lpo54r
Lpo54b:
    v_mfma_f32_32x32x16_bf16 v[32:47], v[80:83], v[168:171], v[32:47]
    v_mfma_f32_32x32x16_bf16 v[48:63], v[84:87], v[168:171], v[48:63]
    v_mfma_f32_32x32x16_bf16 v[32:47], v[88:91], v[172:175], v[32:47]
    v_mfma_f32_32x32x16_bf16 v[48:63], v[92:95], v[172:175], v[48:63]
    s_lshl_b32 s17, s3, 12
    s_add_u32 s17, s17, 32768
    v_add_u32 v4, s17, v1
    s_xor_b32 s17, s17, 0x4000
    v_add_u32 v5, s17, v1
    s_mov_b32 s60, 0xffff0000
    s_nop 5
    ds_write_b128 v4, v[48:51] offset:0
    ds_write_b128 v4, v[52:55] offset:1024
    ds_write_b128 v4, v[56:59] offset:2048
    ds_write_b128 v4, v[60:63] offset:3072
    v_lshlrev_b32 v64, 16, v16
    v_and_b32 v65, s60, v16
    v_lshlrev_b32 v66, 16, v17
    v_and_b32 v67, s60, v17
    v_lshlrev_b32 v68, 16, v18
    v_and_b32 v69, s60, v18
    v_lshlrev_b32 v70, 16, v19
    v_and_b32 v71, s60, v19
    v_lshlrev_b32 v72, 16, v20
    v_and_b32 v73, s60, v20
    v_lshlrev_b32 v74, 16, v21
    v_and_b32 v75, s60, v21
    v_lshlrev_b32 v76, 16, v22
    v_and_b32 v77, s60, v22
    v_lshlrev_b32 v78, 16, v23
    v_and_b32 v79, s60, v23
    v_pk_add_f32 v[32:33], v[32:33], v[64:65]
    v_pk_add_f32 v[34:35], v[34:35], v[66:67]
    v_pk_add_f32 v[36:37], v[36:37], v[68:69]
    v_pk_add_f32 v[38:39], v[38:39], v[70:71]
    v_pk_add_f32 v[40:41], v[40:41], v[72:73]
    v_pk_add_f32 v[42:43], v[42:43], v[74:75]
    v_pk_add_f32 v[44:45], v[44:45], v[76:77]
    v_pk_add_f32 v[46:47], v[46:47], v[78:79]
    s_waitcnt lgkmcnt(0)
    s_barrier
    ds_read_b128 v[64:67], v5 offset:0
    ds_read_b128 v[68:71], v5 offset:1024
    ds_read_b128 v[72:75], v5 offset:2048
    ds_read_b128 v[76:79], v5 offset:3072
    s_waitcnt lgkmcnt(3)
    v_pk_add_f32 v[32:33], v[32:33], v[64:65]
    v_pk_add_f32 v[34:35], v[34:35], v[66:67]
    v_cvt_pk_bf16_f32 v16, v32, v33
    v_cvt_pk_bf16_f32 v17, v34, v35
    s_waitcnt lgkmcnt(2)
    v_pk_add_f32 v[36:37], v[36:37], v[68:69]
    v_pk_add_f32 v[38:39], v[38:39], v[70:71]
    v_cvt_pk_bf16_f32 v18, v36, v37
    v_cvt_pk_bf16_f32 v19, v38, v39
    s_waitcnt lgkmcnt(1)
    v_pk_add_f32 v[40:41], v[40:41], v[72:73]
    v_pk_add_f32 v[42:43], v[42:43], v[74:75]
    v_cvt_pk_bf16_f32 v20, v40, v41
    v_cvt_pk_bf16_f32 v21, v42, v43
    s_waitcnt lgkmcnt(0)
    v_pk_add_f32 v[44:45], v[44:45], v[76:77]
    v_pk_add_f32 v[46:47], v[46:47], v[78:79]
    v_cvt_pk_bf16_f32 v22, v44, v45
    v_cvt_pk_bf16_f32 v23, v46, v47
    s_and_b32 s17, s3, 3
    s_mul_i32 s17, s17, 4608
    s_add_u32 s17, s17, 114688
    v_mul_u32_u24 v4, 144, v14
    v_lshl_add_u32 v4, v15, 4, v4
    s_lshl_b32 s60, s19, 6
    s_add_u32 s60, s60, s17
    v_add_u32 v4, s60, v4
    ds_write_b128 v4, v[16:19]
    ds_write_b128 v4, v[20:23] offset:32
    v_lshrrev_b32 v5, 3, v0
    v_and_b32 v6, 7, v0
    v_mul_u32_u24 v7, 144, v5
    v_lshl_add_u32 v7, v6, 4, v7
    s_mul_i32 s60, s19, 2304
    s_add_u32 s60, s60, s17
    v_add_u32 v7, s60, v7
    v_lshlrev_b32 v5, 11, v5
    v_lshl_add_u32 v5, v6, 4, v5
    s_lshl_b32 s21, s18, 16
    s_lshl_b32 s17, s25, 7
    s_add_u32 s21, s21, s17
    s_lshl_b32 s17, s19, 15
    s_add_u32 s21, s21, s17
    s_add_u32 s17, s21, 16384
    s_waitcnt lgkmcnt(0)
    s_barrier
    ds_read_b128 v[64:67], v7
    ds_read_b128 v[68:71], v7 offset:1152
    s_waitcnt lgkmcnt(1)
    buffer_store_dwordx4 v[64:67], v5, s[12:15], s21 offen sc1
    s_waitcnt lgkmcnt(0)
    buffer_store_dwordx4 v[68:71], v5, s[12:15], s17 offen sc1
    s_endpgm
LB_slow:
    s_waitcnt lgkmcnt(0)
    s_mov_b32 s39, 1
    s_mov_b32 s41, 4194304
    v_mov_b32 v14, 0xff800000
    s_cmp_eq_u32 s46, 0
    s_cbranch_scc1 LB_slow_a
    v_mov_b32 v16, v24
    v_mov_b32 v17, v25
    v_mov_b32 v18, v26
    v_mov_b32 v19, v27
    v_mov_b32 v20, v28
    v_mov_b32 v21, v29
    v_mov_b32 v22, v30
    v_mov_b32 v23, v31
LB_slow_a:
    buffer_load_dwordx4 v[144:147], v1, s[4:7], s41 offen sc1
    buffer_load_dwordx4 v[148:151], v1, s[4:7], s41 offen offset:1024 sc1
    s_waitcnt vmcnt(0)
    v_mfma_f32_32x32x16_bf16 v[64:79], v[144:147], v[16:19], 0
    v_mfma_f32_32x32x16_bf16 v[64:79], v[148:151], v[20:23], v[64:79]
    s_nop 11
    v_max3_f32 v14, v14, v64, v65
    v_max3_f32 v14, v14, v66, v67
    v_max3_f32 v14, v14, v68, v69
    v_max3_f32 v14, v14, v70, v71
    v_max3_f32 v14, v14, v72, v73
    v_max3_f32 v14, v14, v74, v75
    v_max3_f32 v14, v14, v76, v77
    v_max3_f32 v14, v14, v78, v79
    s_add_u32 s41, s41, 4096
    s_cmp_lt_u32 s41, 4456448
    s_cbranch_scc1 LB_slow_a
    v_mov_b32 v15, v14
    s_nop 1
    v_permlane32_swap_b32 v14, v15
    s_nop 1
    v_max_f32 v14, v14, v15
    v_pk_mul_f32 v[32:33], v[14:15], -1.0 op_sel_hi:[0,0]
    v_pk_mul_f32 v[34:35], v[14:15], -1.0 op_sel_hi:[0,0]
    v_pk_mul_f32 v[36:37], v[14:15], -1.0 op_sel_hi:[0,0]
    v_pk_mul_f32 v[38:39], v[14:15], -1.0 op_sel_hi:[0,0]
    v_pk_mul_f32 v[40:41], v[14:15], -1.0 op_sel_hi:[0,0]
    v_pk_mul_f32 v[42:43], v[14:15], -1.0 op_sel_hi:[0,0]
    v_pk_mul_f32 v[44:45], v[14:15], -1.0 op_sel_hi:[0,0]
    v_pk_mul_f32 v[46:47], v[14:15], -1.0 op_sel_hi:[0,0]
    v_mov_b32 v180, 0
    v_mov_b32 v181, 0
    v_mov_b32 v182, 0
    v_mov_b32 v183, 0
    v_mov_b32 v184, 0
    v_mov_b32 v185, 0
    v_mov_b32 v186, 0
    v_mov_b32 v187, 0
    v_mov_b32 v188, 0
    v_mov_b32 v189, 0
    v_mov_b32 v190, 0
    v_mov_b32 v191, 0
    v_mov_b32 v192, 0
    v_mov_b32 v193, 0
    v_mov_b32 v194, 0
    v_mov_b32 v195, 0
    v_mov_b32 v212, 0
    v_mov_b32 v213, 0
    v_mov_b32 v214, 0
    v_mov_b32 v215, 0
    s_mov_b32 s41, 4194304
LB_slow_b:
    buffer_load_dwordx4 v[144:147], v1, s[4:7], s41 offen offset:0 sc1
    buffer_load_dwordx4 v[148:151], v1, s[4:7], s41 offen offset:1024 sc1
    buffer_load_dwordx4 v[152:155], v1, s[4:7], s41 offen offset:2048 sc1
    buffer_load_dwordx4 v[156:159], v1, s[4:7], s41 offen offset:3072 sc1
    s_waitcnt vmcnt(0)
    v_mfma_f32_32x32x16_bf16 v[64:79], v[144:147], v[16:19], v[32:47]
    v_mfma_f32_32x32x16_bf16 v[64:79], v[148:151], v[20:23], v[64:79]
    s_nop 11
    v_exp_f32 v64, v64
    v_exp_f32 v65, v65
    v_exp_f32 v66, v66
    v_exp_f32 v67, v67
    v_exp_f32 v68, v68
    v_exp_f32 v69, v69
    v_exp_f32 v70, v70
    v_exp_f32 v71, v71
    v_exp_f32 v72, v72
    v_exp_f32 v73, v73
    v_exp_f32 v74, v74
    v_exp_f32 v75, v75
    v_exp_f32 v76, v76
    v_exp_f32 v77, v77
    v_exp_f32 v78, v78
    v_exp_f32 v79, v79
    s_nop 1
    v_smfmac_f32_32x32x32_bf16 v[180:195], v[152:155], v[64:71], v224
    v_smfmac_f32_16x16x64_bf16 v[212:215], v[220:223], v[64:71], v224
    v_smfmac_f32_32x32x32_bf16 v[180:195], v[156:159], v[72:79], v224
    v_smfmac_f32_16x16x64_bf16 v[212:215], v[220:223], v[72:79], v224
    s_nop 7
    s_add_u32 s41, s41, 4096
    s_cmp_lt_u32 s41, 4456448
    s_cbranch_scc1 LB_slow_b
    s_nop 3
    s_cmp_eq_u32 s46, 0
    s_cbranch_scc1 LB_fin0
    v_mov_b32 v196, v180
    v_mov_b32 v197, v181
    v_mov_b32 v198, v182
    v_mov_b32 v199, v183
    v_mov_b32 v200, v184
    v_mov_b32 v201, v185
    v_mov_b32 v202, v186
    v_mov_b32 v203, v187
    v_mov_b32 v204, v188
    v_mov_b32 v205, v189
    v_mov_b32 v206, v190
    v_mov_b32 v207, v191
    v_mov_b32 v208, v192
    v_mov_b32 v209, v193
    v_mov_b32 v210, v194
    v_mov_b32 v211, v195
    v_mov_b32 v216, v212
    s_branch LB_fin1
Lpo19r:
    s_sub_u32 s92, s92, 1
    s_cselect_b32 s92, 0, s92
    s_cbranch_scc1 Lpo19b
    s_add_u32 s17, s61, 0
    buffer_load_dwordx4 v[144:147], v1, s[4:7], s17 offen sc1
    buffer_load_dwordx4 v[148:151], v1, s[4:7], s17 offen offset:1024 sc1
    s_waitcnt vmcnt(0)
    s_branch Lpo19
Lpo20r:
    s_sub_u32 s92, s92, 1
    s_cselect_b32 s92, 0, s92
    s_cbranch_scc1 Lpo20b
    s_add_u32 s17, s61, 2048
    buffer_load_dwordx4 v[152:155], v1, s[4:7], s17 offen sc1
    buffer_load_dwordx4 v[156:159], v1, s[4:7], s17 offen offset:1024 sc1
    s_waitcnt vmcnt(0)
    s_branch Lpo20
Lpo21r:
    s_sub_u32 s92, s92, 1
    s_cselect_b32 s92, 0, s92
    s_cbranch_scc1 Lpo21b
    s_add_u32 s17, s61, 4096
    buffer_load_dwordx4 v[160:163], v1, s[4:7], s17 offen sc1
    buffer_load_dwordx4 v[164:167], v1, s[4:7], s17 offen offset:1024 sc1
    s_waitcnt vmcnt(0)
    s_branch Lpo21
Lpo22r:
    s_sub_u32 s92, s92, 1
    s_cselect_b32 s92, 0, s92
    s_cbranch_scc1 Lpo22b
    s_add_u32 s17, s61, 6144
    buffer_load_dwordx4 v[168:171], v1, s[4:7], s17 offen sc1
    buffer_load_dwordx4 v[172:175], v1, s[4:7], s17 offen offset:1024 sc1
    s_waitcnt vmcnt(0)
    s_branch Lpo22
Lpo23r:
    s_sub_u32 s92, s92, 1
    s_cselect_b32 s92, 0, s92
    s_cbranch_scc1 Lpo23b
    s_add_u32 s17, s61, 8192
    buffer_load_dwordx4 v[144:147], v1, s[4:7], s17 offen sc1
    buffer_load_dwordx4 v[148:151], v1, s[4:7], s17 offen offset:1024 sc1
    s_waitcnt vmcnt(0)
    s_branch Lpo23
Lpo24r:
    s_sub_u32 s92, s92, 1
    s_cselect_b32 s92, 0, s92
    s_cbranch_scc1 Lpo24b
    s_add_u32 s17, s61, 10240
    buffer_load_dwordx4 v[152:155], v1, s[4:7], s17 offen sc1
    buffer_load_dwordx4 v[156:159], v1, s[4:7], s17 offen offset:1024 sc1
    s_waitcnt vmcnt(0)
    s_branch Lpo24
Lpo25r:
    s_sub_u32 s92, s92, 1
    s_cselect_b32 s92, 0, s92
    s_cbranch_scc1 Lpo25b
    s_add_u32 s17, s61, 12288
    buffer_load_dwordx4 v[160:163], v1, s[4:7], s17 offen sc1
    buffer_load_dwordx4 v[164:167], v1, s[4:7], s17 offen offset:1024 sc1
    s_waitcnt vmcnt(0)
    s_branch Lpo25
Lpo26r:
    s_sub_u32 s92, s92, 1
    s_cselect_b32 s92, 0, s92
    s_cbranch_scc1 Lpo26b
    s_add_u32 s17, s61, 14336
    buffer_load_dwordx4 v[168:171], v1, s[4:7], s17 offen sc1
    buffer_load_dwordx4 v[172:175], v1, s[4:7], s17 offen offset:1024 sc1
    s_waitcnt vmcnt(0)
    s_branch Lpo26
Lpo28r:
    s_sub_u32 s92, s92, 1
    s_cselect_b32 s92, 0, s92
    s_cbranch_scc1 Lpo28b
    s_add_u32 s17, s61, 16384
    buffer_load_dwordx4 v[144:147], v1, s[4:7], s17 offen sc1
    buffer_load_dwordx4 v[148:151], v1, s[4:7], s17 offen offset:1024 sc1
    s_waitcnt vmcnt(0)
    s_branch Lpo28
Lpo30r:
    s_sub_u32 s92, s92, 1
    s_cselect_b32 s92, 0, s92
    s_cbranch_scc1 Lpo30b
    s_add_u32 s17, s61, 18432
    buffer_load_dwordx4 v[152:155], v1, s[4:7], s17 offen sc1
    buffer_load_dwordx4 v[156:159], v1, s[4:7], s17 offen offset:1024 sc1
    s_waitcnt vmcnt(0)
    s_branch Lpo30
Lpo32r:
    s_sub_u32 s92, s92, 1
    s_cselect_b32 s92, 0, s92
    s_cbranch_scc1 Lpo32b
    s_add_u32 s17, s61, 20480
    buffer_load_dwordx4 v[160:163], v1, s[4:7], s17 offen sc1
    buffer_load_dwordx4 v[164:167], v1, s[4:7], s17 offen offset:1024 sc1
    s_waitcnt vmcnt(0)
    s_branch Lpo32
Lpo34r:
    s_sub_u32 s92, s92, 1
    s_cselect_b32 s92, 0, s92
    s_cbranch_scc1 Lpo34b
    s_add_u32 s17, s61, 22528
    buffer_load_dwordx4 v[168:171], v1, s[4:7], s17 offen sc1
    buffer_load_dwordx4 v[172:175], v1, s[4:7], s17 offen offset:1024 sc1
    s_waitcnt vmcnt(0)
    s_branch Lpo34
Lpo36r:
    s_sub_u32 s92, s92, 1
    s_cselect_b32 s92, 0, s92
    s_cbranch_scc1 Lpo36b
    s_add_u32 s17, s61, 24576
    buffer_load_dwordx4 v[144:147], v1, s[4:7], s17 offen sc1
    buffer_load_dwordx4 v[148:151], v1, s[4:7], s17 offen offset:1024 sc1
    s_waitcnt vmcnt(0)
    s_branch Lpo36
Lpo38r:
    s_sub_u32 s92, s92, 1
    s_cselect_b32 s92, 0, s92
    s_cbranch_scc1 Lpo38b
    s_add_u32 s17, s61, 26624
    buffer_load_dwordx4 v[152:155], v1, s[4:7], s17 offen sc1
    buffer_load_dwordx4 v[156:159], v1, s[4:7], s17 offen offset:1024 sc1
    s_waitcnt vmcnt(0)
    s_branch Lpo38
Lpo40r:
    s_sub_u32 s92, s92, 1
    s_cselect_b32 s92, 0, s92
    s_cbranch_scc1 Lpo40b
    s_add_u32 s17, s61, 28672
    buffer_load_dwordx4 v[160:163], v1, s[4:7], s17 offen sc1
    buffer_load_dwordx4 v[164:167], v1, s[4:7], s17 offen offset:1024 sc1
    s_waitcnt vmcnt(0)
    s_branch Lpo40
Lpo42r:
    s_sub_u32 s92, s92, 1
    s_cselect_b32 s92, 0, s92
    s_cbranch_scc1 Lpo42b
    s_add_u32 s17, s61, 30720
    buffer_load_dwordx4 v[168:171], v1, s[4:7], s17 offen sc1
    buffer_load_dwordx4 v[172:175], v1, s[4:7], s17 offen offset:1024 sc1
    s_waitcnt vmcnt(0)
    s_branch Lpo42
Lpo43r:
    s_sub_u32 s92, s92, 1
    s_cselect_b32 s92, 0, s92
    s_cbranch_scc1 Lpo43b
    s_add_u32 s17, s61, 32768
    buffer_load_dwordx4 v[144:147], v1, s[4:7], s17 offen sc1
    buffer_load_dwordx4 v[148:151], v1, s[4:7], s17 offen offset:1024 sc1
    s_waitcnt vmcnt(0)
    s_branch Lpo43
Lpo44r:
    s_sub_u32 s92, s92, 1
    s_cselect_b32 s92, 0, s92
    s_cbranch_scc1 Lpo44b
    s_add_u32 s17, s61, 34816
    buffer_load_dwordx4 v[152:155], v1, s[4:7], s17 offen sc1
    buffer_load_dwordx4 v[156:159], v1, s[4:7], s17 offen offset:1024 sc1
    s_waitcnt vmcnt(0)
    s_branch Lpo44
Lpo45r:
    s_sub_u32 s92, s92, 1
    s_cselect_b32 s92, 0, s92
    s_cbranch_scc1 Lpo45b
    s_add_u32 s17, s61, 36864
    buffer_load_dwordx4 v[160:163], v1, s[4:7], s17 offen sc1
    buffer_load_dwordx4 v[164:167], v1, s[4:7], s17 offen offset:1024 sc1
    s_waitcnt vmcnt(0)
    s_branch Lpo45
Lpo46r:
    s_sub_u32 s92, s92, 1
    s_cselect_b32 s92, 0, s92
    s_cbranch_scc1 Lpo46b
    s_add_u32 s17, s61, 38912
    buffer_load_dwordx4 v[168:171], v1, s[4:7], s17 offen sc1
    buffer_load_dwordx4 v[172:175], v1, s[4:7], s17 offen offset:1024 sc1
    s_waitcnt vmcnt(0)
    s_branch Lpo46
Lpo47r:
    s_sub_u32 s92, s92, 1
    s_cselect_b32 s92, 0, s92
    s_cbranch_scc1 Lpo47b
    s_add_u32 s17, s61, 40960
    buffer_load_dwordx4 v[144:147], v1, s[4:7], s17 offen sc1
    buffer_load_dwordx4 v[148:151], v1, s[4:7], s17 offen offset:1024 sc1
    s_waitcnt vmcnt(0)
    s_branch Lpo47
Lpo48r:
    s_sub_u32 s92, s92, 1
    s_cselect_b32 s92, 0, s92
    s_cbranch_scc1 Lpo48b
    s_add_u32 s17, s61, 43008
    buffer_load_dwordx4 v[152:155], v1, s[4:7], s17 offen sc1
    buffer_load_dwordx4 v[156:159], v1, s[4:7], s17 offen offset:1024 sc1
    s_waitcnt vmcnt(0)
    s_branch Lpo48
Lpo49r:
    s_sub_u32 s92, s92, 1
    s_cselect_b32 s92, 0, s92
    s_cbranch_scc1 Lpo49b
    s_add_u32 s17, s61, 45056
    buffer_load_dwordx4 v[160:163], v1, s[4:7], s17 offen sc1
    buffer_load_dwordx4 v[164:167], v1, s[4:7], s17 offen offset:1024 sc1
    s_waitcnt vmcnt(0)
    s_branch Lpo49
Lpo50r:
    s_sub_u32 s92, s92, 1
    s_cselect_b32 s92, 0, s92
    s_cbranch_scc1 Lpo50b
    s_add_u32 s17, s61, 47104
    buffer_load_dwordx4 v[168:171], v1, s[4:7], s17 offen sc1
    buffer_load_dwordx4 v[172:175], v1, s[4:7], s17 offen offset:1024 sc1
    s_waitcnt vmcnt(0)
    s_branch Lpo50
Lpo51r:
    s_sub_u32 s92, s92, 1
    s_cselect_b32 s92, 0, s92
    s_cbranch_scc1 Lpo51b
    s_add_u32 s17, s61, 49152
    buffer_load_dwordx4 v[144:147], v1, s[4:7], s17 offen sc1
    buffer_load_dwordx4 v[148:151], v1, s[4:7], s17 offen offset:1024 sc1
    s_waitcnt vmcnt(0)
    s_branch Lpo51
Lpo52r:
    s_sub_u32 s92, s92, 1
    s_cselect_b32 s92, 0, s92
    s_cbranch_scc1 Lpo52b
    s_add_u32 s17, s61, 51200
    buffer_load_dwordx4 v[152:155], v1, s[4:7], s17 offen sc1
    buffer_load_dwordx4 v[156:159], v1, s[4:7], s17 offen offset:1024 sc1
    s_waitcnt vmcnt(0)
    s_branch Lpo52
Lpo53r:
    s_sub_u32 s92, s92, 1
    s_cselect_b32 s92, 0, s92
    s_cbranch_scc1 Lpo53b
    s_add_u32 s17, s61, 53248
    buffer_load_dwordx4 v[160:163], v1, s[4:7], s17 offen sc1
    buffer_load_dwordx4 v[164:167], v1, s[4:7], s17 offen offset:1024 sc1
    s_waitcnt vmcnt(0)
    s_branch Lpo53
Lpo54r:
    s_sub_u32 s92, s92, 1
    s_cselect_b32 s92, 0, s92
    s_cbranch_scc1 Lpo54b
    s_add_u32 s17, s61, 55296
    buffer_load_dwordx4 v[168:171], v1, s[4:7], s17 offen sc1
    buffer_load_dwordx4 v[172:175], v1, s[4:7], s17 offen offset:1024 sc1
    s_waitcnt vmcnt(0)
    s_branch Lpo54
L_end:
    s_endpgm

.section .rodata,"a"
.p2align 6
.amdhsa_kernel sequential_preLN__grouped_kv_mqa__mixer_gmlp__prompt_kernel
  .amdhsa_next_free_vgpr 256
  .amdhsa_next_free_sgpr 100
  .amdhsa_accum_offset 256
  .amdhsa_group_segment_fixed_size 0
  .amdhsa_kernarg_size 104
  .amdhsa_user_sgpr_count 2
  .amdhsa_user_sgpr_kernarg_segment_ptr 1
  .amdhsa_system_sgpr_workgroup_id_x 1
  .amdhsa_float_denorm_mode_32 3
.end_amdhsa_kernel
```
